```python
import torch

def _softmax(x, axis=-1):
    return torch.softmax(x, dim=axis)

def _gelu(x):
    return torch.nn.functional.gelu(x, approximate='tanh')

def _silu(x):
    return torch.nn.functional.silu(x)

def _sigmoid(x):
    return torch.sigmoid(x)

def _layernorm(x, axis=-1, eps=1e-05):
    m = x.mean(dim=axis, keepdim=True)
    v = x.var(dim=axis, keepdim=True, unbiased=False)
    return (x - m) / torch.sqrt(v + eps)

def _scatter_add(tgt, idx, src, axis=0):
    return tgt.clone().index_add_(axis, idx, src)

def _segment_sum(src, seg, n):
    out = torch.zeros((n,) + src.shape[1:], dtype=src.dtype)
    return out.index_add_(0, seg, src)

def _pad(x, pw):
    flat = tuple((v for pair in reversed(pw) for v in pair))
    return torch.nn.functional.pad(x, flat)
kernel_name = 'adaLN_cond__sliding_local_dilated__mixer_s_mlp__prompt'

def setup_inputs():

    _w = lambda a: (lambda t: t.to(torch.bfloat16) if t.is_floating_point() else t)(torch.as_tensor(a))

    def _A_setup():
        B, S, D = (1, 2048, 512)
        return {'x': _w((lambda *s: torch.randn(*s, dtype=torch.bfloat16) * 0.05)(B, S, D)), 'wqkv': _w((lambda *s: torch.randn(*s, dtype=torch.bfloat16) * 0.05)(D, 3 * D)), 'wo': _w((lambda *s: torch.randn(*s, dtype=torch.bfloat16) * 0.05)(D, D))}
    _A_in = _A_setup()

    def _B_setup():
        B, S, D, F = (1, 2048, 512, 1792)
        return {'x': _w((lambda *s: torch.randn(*s, dtype=torch.bfloat16) * 0.05)(B, S, D)), 'w1': _w((lambda *s: torch.randn(*s, dtype=torch.bfloat16) * 3.2)(D, D) * D ** (-0.5)), 'w2': _w((lambda *s: torch.randn(*s, dtype=torch.bfloat16) * 3.2)(D, D) * D ** (-0.5)), 'w3': _w((lambda *s: torch.randn(*s, dtype=torch.bfloat16) * 3.2)(D, F) * D ** (-0.5)), 'w4': _w((lambda *s: torch.randn(*s, dtype=torch.bfloat16) * 3.2)(F, D) * F ** (-0.5))}
    _B_in = _B_setup()
    return {'A_x': _A_in['x'], 'A_wqkv': _A_in['wqkv'], 'A_wo': _A_in['wo'], 'B_x': _B_in['x'], 'B_w1': _B_in['w1'], 'B_w2': _B_in['w2'], 'B_w3': _B_in['w3'], 'B_w4': _B_in['w4'], 'c': _w((lambda *s: torch.randn(*s, dtype=torch.bfloat16) * 0.1)(1, 512) * 8.0), 'w_mod': _w((lambda *s: torch.randn(*s, dtype=torch.bfloat16) * 0.1)(512, 6 * 512) * 512 ** (-0.5) * 8.0)}

def reference(A_x, A_wqkv, A_wo, B_x, B_w1, B_w2, B_w3, B_w4, c, w_mod):

    def _A_ref(x, wqkv, wo):
        B, S, D = x.shape
        H = 32
        Dh = D // H
        W, dil = (8, 2)
        qkv = (lambda x, *d: x.permute(*d))((x @ wqkv).reshape(B, S, 3, H, Dh), 2, 0, 3, 1, 4)
        q, k, v = (qkv[0], qkv[1], qkv[2])
        scale = Dh ** (-0.5)
        pos = torch.arange(S)
        off = torch.arange(W) * dil
        idx = pos[:, None] - off[None, :]
        mask = idx >= 0
        idx_c = torch.where(mask, idx, 0).reshape(-1)
        kg = k[:, :, idx_c, :].reshape(B, H, S, W, Dh)
        vg = v[:, :, idx_c, :].reshape(B, H, S, W, Dh)
        logits = torch.einsum('bhsd,bhswd->bhsw', q, kg) * scale
        logits = torch.where(mask[None, None, :, :], logits, -1000000000.0)
        attn = _softmax(logits, axis=-1)
        o = torch.einsum('bhsw,bhswd->bhsd', attn, vg)
        return (lambda x, *d: x.permute(*d))(o, 0, 2, 1, 3).reshape(B, S, D) @ wo

    def _B_ref(x, w1, w2, w3, w4):
        B, S, D = x.shape
        h = _gelu(_layernorm(x, axis=-1) @ w1)
        c = D // 4
        g0 = _pad(h[:, :, 0 * c:1 * c], ((0, 0), (1, 0), (0, 0)))[:, :S, :]
        g1 = _pad(h[:, :, 1 * c:2 * c], ((0, 0), (0, 1), (0, 0)))[:, 1:, :]
        g2 = _pad(h[:, :, 2 * c:3 * c], ((0, 0), (2, 0), (0, 0)))[:, :S, :]
        g3 = _pad(h[:, :, 3 * c:], ((0, 0), (0, 2), (0, 0)))[:, 2:, :]
        hs = torch.concatenate([g0, g1, g2, g3], axis=-1) @ w2
        x1 = x + hs
        h2 = _gelu(_layernorm(x1, axis=-1) @ w3) @ w4
        return x1 + h2
    x = A_x
    mod = (_silu(c) @ w_mod).reshape(c.shape[0], 6, 1, -1)
    sa, ca, ga, sb, cb, gb = (mod[:, 0].clone(), mod[:, 1].clone(), mod[:, 2].clone(), mod[:, 3].clone(), mod[:, 4].clone(), mod[:, 5].clone())
    h = _layernorm(x, axis=-1) * (1 + ca) + sa
    x = x + ga * _A_ref(h, A_wqkv, A_wo)
    h = _layernorm(x, axis=-1) * (1 + cb) + sb
    x = x + gb * _B_ref(h, B_w1, B_w2, B_w3, B_w4)
    return x
```

```asm
; @launch grid=(256,1,1) block=(512,1,1) lds=163840
.amdgcn_target "amdgcn-amd-amdhsa--gfx950"
.text
.globl adaLN_cond__sliding_local_dilated__mixer_s_mlp__prompt_kernel
.p2align 8
.type adaLN_cond__sliding_local_dilated__mixer_s_mlp__prompt_kernel,@function
adaLN_cond__sliding_local_dilated__mixer_s_mlp__prompt_kernel:
    s_cmp_ge_u32 s2, 256
    s_cbranch_scc1 L_exit
    s_getpc_b64 s[8:9]
    s_lshr_b32 s3, s2, 3
    s_lshl_b32 s3, s3, 11
    v_lshrrev_b32 v2, 6, v0
    v_lshl_add_u32 v2, v2, 8, s3
    v_and_b32 v3, 1, v0
    v_lshl_add_u32 v2, v3, 7, v2
    v_min_u32 v2, L_code_end-adaLN_cond__sliding_local_dilated__mixer_s_mlp__prompt_kernel-64, v2
    s_mov_b64 exec, 3
    global_load_dword v255, v2, s[8:9]
    s_mov_b64 exec, -1
    s_load_dwordx2 s[84:85], s[0:1], 96
    s_load_dwordx2 s[76:77], s[0:1], 72
    s_load_dwordx2 s[72:73], s[0:1], 64
    s_load_dwordx2 s[44:45], s[0:1], 0
    s_load_dwordx2 s[48:49], s[0:1], 8
    s_load_dwordx2 s[64:65], s[0:1], 48
    s_load_dwordx2 s[52:53], s[0:1], 16
    s_load_dwordx2 s[56:57], s[0:1], 32
    s_load_dwordx2 s[60:61], s[0:1], 40
    s_load_dwordx2 s[68:69], s[0:1], 56
    s_load_dwordx2 s[80:81], s[0:1], 80
    v_lshrrev_b32 v1, 6, v0
    v_and_b32 v0, 63, v0
    v_readfirstlane_b32 s6, v1
    s_and_b32 s4, s2, 7
    s_lshl_b32 s4, s4, 2
    s_lshr_b32 s3, s2, 6
    s_add_u32 s4, s4, s3
    s_lshr_b32 s5, s2, 3
    s_and_b32 s5, s5, 7
    v_lshlrev_b32 v1, 4, v0
    s_mov_b32 s46, 2097152
    s_mov_b32 s47, 0x20000
    s_mov_b32 s50, 1572864
    s_mov_b32 s51, 0x20000
    s_mov_b32 s54, 524288
    s_mov_b32 s55, 0x20000
    s_mov_b32 s58, 524288
    s_mov_b32 s59, 0x20000
    s_mov_b32 s62, 524288
    s_mov_b32 s63, 0x20000
    s_mov_b32 s66, 1835008
    s_mov_b32 s67, 0x20000
    s_mov_b32 s70, 1835008
    s_mov_b32 s71, 0x20000
    s_mov_b32 s74, 1024
    s_mov_b32 s75, 0x20000
    s_mov_b32 s78, 3145728
    s_mov_b32 s79, 0x20000
    s_mov_b32 s82, 2097152
    s_mov_b32 s83, 0x20000
    s_mov_b32 s86, 22020096
    s_mov_b32 s87, 0x20000
    s_cmp_ge_u32 s6, 4
    s_cbranch_scc1 L_helper
    s_lshr_b32 s13, s6, 1
    s_and_b32 s14, s6, 1
    v_lshrrev_b32 v2, 3, v0
    s_lshl_b32 s3, s6, 3
    v_add_u32 v4, s3, v2
    v_mul_u32_u24 v41, 6144, v4
    v_and_b32 v2, 2, v2
    s_lshl_b32 s3, s14, 2
    v_or_b32 v2, s3, v2
    v_and_b32 v3, 7, v0
    v_xor_b32 v2, v2, v3
    v_lshlrev_b32 v42, 4, v2
    v_add_u32 v41, v42, v41
    s_and_b32 s11, s2, 15
    s_lshl_b32 s11, s11, 7
    s_lshr_b32 s3, s2, 4
    s_mul_i32 s3, s3, 786432
    s_add_u32 s11, s11, s3
    s_lshl_b32 s12, s6, 10
    v_lshl_add_u32 v4, v0, 2, 0
    v_add_u32 v4, 159488, v4
    v_mov_b32 v5, 0
    ds_write_b32 v4, v5
    v_lshrrev_b32 v2, 3, v0
    s_lshl_b32 s3, s6, 3
    v_add_u32 v43, s3, v2
    v_mul_u32_u24 v43, 3072, v43
    v_add_u32 v43, v42, v43
    s_lshl_b32 s3, s5, 7
    v_add_u32 v43, s3, v43
    s_waitcnt lgkmcnt(0)
    s_cmp_ge_u32 s2, 64
    s_cbranch_scc1 LnoA_73
    s_add_u32 m0, s12, 0
    s_nop 0
    buffer_load_dwordx4 v41, s[76:79], s11 offen lds
    s_add_u32 s11, s11, 196608
    s_add_u32 m0, s12, 4096
    s_nop 0
    buffer_load_dwordx4 v41, s[76:79], s11 offen lds
    s_add_u32 s11, s11, 196608
    s_add_u32 m0, s12, 8192
    s_nop 0
    buffer_load_dwordx4 v41, s[76:79], s11 offen lds
    s_add_u32 s11, s11, 196608
    s_add_u32 m0, s12, 12288
    s_nop 0
    buffer_load_dwordx4 v41, s[76:79], s11 offen lds
LnoA_73:
    buffer_load_dwordx4 v[156:159], v1, s[72:75], 0 offen
    s_load_dword s7, s[84:85], 0
    s_barrier
    s_cmp_lt_u32 s2, 64
    s_cbranch_scc1 LisA_74
LisA_74:
    s_mul_i32 s40, s4, 524288
    s_add_u32 s40, s40, 4194304
    s_lshr_b32 s101, s4, 1
    s_mul_i32 s101, s101, 79104
    s_add_u32 s101, s101, 65536
    v_lshrrev_b32 v2, 4, v0
    v_lshrrev_b32 v3, 2, v0
    v_and_b32 v3, 3, v3
    v_lshl_add_u32 v40, v2, 3, v3
    v_lshlrev_b32 v40, 7, v40
    v_and_b32 v3, 2, v3
    v_and_b32 v4, 1, v2
    v_lshl_or_b32 v3, v4, 2, v3
    s_lshl_b32 s3, s6, 1
    v_xor_b32 v3, s3, v3
    v_lshl_add_u32 v40, v3, 4, v40
    v_and_b32 v3, 3, v0
    v_lshl_add_u32 v40, v3, 3, v40
    s_waitcnt vmcnt(0)
    v_lshlrev_b32 v168, 16, v156
    v_and_b32 v169, 0xffff0000, v156
    v_lshlrev_b32 v170, 16, v157
    v_and_b32 v171, 0xffff0000, v157
    v_lshlrev_b32 v172, 16, v158
    v_and_b32 v173, 0xffff0000, v158
    v_lshlrev_b32 v174, 16, v159
    v_and_b32 v175, 0xffff0000, v159
    v_mul_f32 v176, 0xbfb8aa3b, v168
    v_mul_f32 v177, 0xbfb8aa3b, v169
    v_mul_f32 v178, 0xbfb8aa3b, v170
    v_mul_f32 v179, 0xbfb8aa3b, v171
    v_mul_f32 v180, 0xbfb8aa3b, v172
    v_mul_f32 v181, 0xbfb8aa3b, v173
    v_mul_f32 v182, 0xbfb8aa3b, v174
    v_mul_f32 v183, 0xbfb8aa3b, v175
    v_exp_f32 v176, v176
    v_exp_f32 v177, v177
    v_exp_f32 v178, v178
    v_exp_f32 v179, v179
    v_exp_f32 v180, v180
    v_exp_f32 v181, v181
    v_exp_f32 v182, v182
    v_exp_f32 v183, v183
    v_add_f32 v176, 1.0, v176
    v_add_f32 v177, 1.0, v177
    v_add_f32 v178, 1.0, v178
    v_add_f32 v179, 1.0, v179
    v_add_f32 v180, 1.0, v180
    v_add_f32 v181, 1.0, v181
    v_add_f32 v182, 1.0, v182
    v_add_f32 v183, 1.0, v183
    v_rcp_f32 v176, v176
    v_rcp_f32 v177, v177
    v_rcp_f32 v178, v178
    v_rcp_f32 v179, v179
    v_rcp_f32 v180, v180
    v_rcp_f32 v181, v181
    v_rcp_f32 v182, v182
    v_rcp_f32 v183, v183
    v_mul_f32 v168, v168, v176
    v_mul_f32 v169, v169, v177
    v_mul_f32 v170, v170, v178
    v_mul_f32 v171, v171, v179
    v_mul_f32 v172, v172, v180
    v_mul_f32 v173, v173, v181
    v_mul_f32 v174, v174, v182
    v_mul_f32 v175, v175, v183
    v_cvt_pk_bf16_f32 v156, v168, v169
    v_cvt_pk_bf16_f32 v157, v170, v171
    v_cvt_pk_bf16_f32 v158, v172, v173
    v_cvt_pk_bf16_f32 v159, v174, v175
    v_add_u32 v2, 161792, v1
    ds_write_b128 v2, v[156:159]
    v_mov_b32 v3, 0x3f803f80
    s_lshl_b32 s3, s6, 8
    s_add_u32 s3, s3, 155648
    v_lshl_add_u32 v2, v0, 2, s3
    ds_write_b32 v2, v3
    s_waitcnt lgkmcnt(0)
    s_add_u32 s7, s7, 0x9e3779b9
    v_mov_b32_e64 v6, s7
    s_and_b32 s1, s7, 0xff
    s_bfe_u32 s47, s7, 0x80008
    s_bfe_u32 s66, s7, 0x80010
    s_lshr_b32 s67, s7, 24
    s_cmp_ge_u32 s2, 64
    s_cbranch_scc1 LnoA_75
    v_lshrrev_b32 v2, 4, v0
    v_lshlrev_b32 v2, 4, v2
    s_lshr_b32 s9, s2, 4
    s_lshl_b32 s3, s9, 8
    s_add_u32 s3, s3, 161792
    v_add_u32 v5, s3, v2
    ds_read_b128 v[184:187], v5 offset:0
    ds_read_b128 v[188:191], v5 offset:64
    ds_read_b128 v[192:195], v5 offset:128
    ds_read_b128 v[196:199], v5 offset:192
    s_mul_i32 s10, s9, 12288
    s_and_b32 s3, s2, 15
    s_lshl_b32 s11, s3, 6
    s_lshl_b32 s3, s3, 8
    s_add_u32 s10, s10, s3
    s_lshl_b32 s3, s6, 6
    s_add_u32 s10, s10, s3
    s_add_u32 s10, s10, 65536
    s_lshl_b32 s3, s9, 4
    s_add_u32 s11, s11, s3
    s_lshl_b32 s3, s6, 2
    s_add_u32 s11, s11, s3
    s_add_u32 s11, s11, 143360
    v_and_b32 v5, 15, v0
    v_mul_u32_u24 v45, 79104, v5
    v_add_u32 v2, v2, v45
    v_mov_b32 v4, 159488
    v_mov_b32 v3, 1
    s_mov_b64 exec, 1
    ds_add_u32 v4, v3 offset:0
    s_mov_b64 exec, -1
    s_movk_i32 s3, 0x7fff
Lsy_76:
    ds_read_b32 v3, v4 offset:0
    s_waitcnt lgkmcnt(0)
    v_readfirstlane_b32 s8, v3
    s_sub_u32 s3, s3, 1
    s_cselect_b32 s8, 4, s8
    s_cmp_lt_u32 s8, 4
    s_cbranch_scc1 Lsy_76
    ds_read_b64_tr_b16 v[200:201], v40 offset:0
    ds_read_b64_tr_b16 v[202:203], v40 offset:512
    ds_read_b64_tr_b16 v[204:205], v40 offset:4096
    ds_read_b64_tr_b16 v[206:207], v40 offset:4608
    ds_read_b64_tr_b16 v[208:209], v40 offset:8192
    ds_read_b64_tr_b16 v[210:211], v40 offset:8704
    ds_read_b64_tr_b16 v[212:213], v40 offset:12288
    ds_read_b64_tr_b16 v[214:215], v40 offset:12800
    s_waitcnt lgkmcnt(6)
    v_mfma_f32_16x16x32_bf16 v[168:171], v[200:203], v[184:187], 0
    s_waitcnt lgkmcnt(4)
    v_mfma_f32_16x16x32_bf16 v[168:171], v[204:207], v[188:191], v[168:171]
    s_waitcnt lgkmcnt(2)
    v_mfma_f32_16x16x32_bf16 v[168:171], v[208:211], v[192:195], v[168:171]
    s_waitcnt lgkmcnt(0)
    v_mfma_f32_16x16x32_bf16 v[168:171], v[212:215], v[196:199], v[168:171]
    s_mov_b32 s3, 0x7060500
    s_nop 6
    s_nop 0
    v_perm_b32 v168, v168, v6, s3
    s_mov_b32 s3, 0x7060501
    v_perm_b32 v169, v169, v6, s3
    s_mov_b32 s3, 0x7060502
    v_perm_b32 v170, v170, v6, s3
    s_mov_b32 s3, 0x7060503
    v_perm_b32 v171, v171, v6, s3
    buffer_store_dwordx4 v[168:171], v2, s[84:87], s10 offen sc1
    s_mov_b64 exec, 0xffff
    buffer_store_dword v6, v45, s[84:87], s11 offen sc1
    s_mov_b64 exec, -1
LnoA_75:
    s_and_b32 s3, s4, 3
    s_mov_b32 s9, s3
    s_mov_b32 s0, 7
Lsh_77:
    s_mul_i32 s8, s9, 12288
    s_add_u32 s8, s8, s12
    s_mul_i32 s10, s9, 98304
    s_add_u32 m0, s8, 20480
    s_nop 0
    buffer_load_dwordx4 v43, s[48:51], s10 offen offset:0 lds
    s_add_u32 m0, s8, 23552
    s_nop 0
    buffer_load_dwordx4 v43, s[48:51], s10 offen offset:1024 lds
    s_add_u32 m0, s8, 26624
    s_nop 0
    buffer_load_dwordx4 v43, s[48:51], s10 offen offset:2048 lds
    s_add_u32 s9, s9, 1
    s_cmp_eq_u32 s9, 7
    s_cselect_b32 s9, 0, s9
    s_sub_u32 s0, s0, 1
    s_cmp_lg_u32 s0, 0
    s_cbranch_scc1 Lsh_77
    s_lshl_b32 s15, s4, 1
    s_add_u32 s15, s15, s13
    v_and_b32 v16, 31, v0
    v_lshrrev_b32 v17, 5, v0
    v_add_u32 v8, 4096, v1
    v_and_b32 v9, 3, v0
    v_lshlrev_b32 v9, 2, v9
    v_add_u32 v9, 159488, v9
    v_lshrrev_b32 v2, 2, v0
    v_and_b32 v2, 3, v2
    v_lshrrev_b32 v3, 1, v2
    v_xor_b32 v3, s14, v3
    v_lshlrev_b32 v3, 6, v3
    v_lshl_add_u32 v3, v2, 7, v3
    v_lshrrev_b32 v2, 4, v0
    v_and_b32 v2, 1, v2
    v_lshl_add_u32 v3, v2, 5, v3
    v_and_b32 v2, 3, v0
    v_lshl_add_u32 v3, v2, 3, v3
    s_lshl_b32 s3, s14, 14
    v_add_u32 v3, s3, v3
    v_lshl_add_u32 v12, v17, 9, v3
    v_xor_b32_e64 v13, 64, v12
    v_add_u32 v14, 0x10000, v12
    v_add_u32 v15, 0x10000, v13
    s_lshl_b32 s3, s6, 12
    s_add_u32 s3, s3, 131072
    v_add_u32 v22, s3, v1
    v_xor_b32 v23, 4096, v22
    s_lshl_b32 s3, s14, 7
    s_add_u32 s3, s3, 147456
    v_lshl_add_u32 v18, v17, 4, s3
    v_mov_b32 v7, 0x7fffffff
    v_cmp_eq_u32 vcc, 0, v0
    s_nop 1
    v_cndmask_b32 v7, v7, v0, vcc
    s_lshl_b32 s3, s13, 15
    s_add_u32 s3, s3, s40
    s_lshl_b32 s8, s14, 14
    s_add_u32 s41, s3, s8
    s_lshl_b32 s8, s5, 12
    s_add_u32 s3, s3, s8
    s_lshl_b32 s8, s14, 11
    s_add_u32 s96, s3, s8
    s_lshl_b32 s3, s13, 7
    s_add_u32 s3, s3, s40
    s_add_u32 s98, s3, 319488
    s_lshl_b32 s3, s5, 3
    s_lshl_b32 s8, s14, 2
    s_add_u32 s3, s3, s8
    s_add_u32 s97, s98, s3
    s_lshl_b32 s3, s5, 12
    s_lshl_b32 s8, s6, 10
    s_add_u32 s3, s3, s8
    s_add_u32 s99, s3, s40
    v_lshrrev_b32 v2, 4, v0
    v_and_b32 v3, 15, v0
    v_xor_b32 v3, v3, v2
    v_lshlrev_b32 v160, 8, v2
    v_lshl_add_u32 v160, v3, 4, v160
    v_xor_b32_e64 v161, 64, v160
    v_xor_b32 v162, 128, v160
    v_xor_b32 v163, 192, v160
    v_and_b32 v2, 15, v0
    v_and_b32 v3, 1, v0
    v_cmp_eq_u32 s[88:89], 1, v3
    v_lshrrev_b32_e64 v4, 4, v0
    v_lshl_add_u32 v4, v4, 2, v3
    v_cmp_le_u32 s[90:91], v4, v2
    v_add_u32_e64 v4, 2, v4
    v_cmp_le_u32 s[94:95], v4, v2
    v_mov_b32 v2, 0x0c0c0100
    v_mov_b32 v3, 0x01000c0c
    v_cndmask_b32 v2, v2, v3, s[88:89]
    v_mov_b32 v4, 0x0c0c0302
    v_mov_b32 v3, 0x03020c0c
    v_cndmask_b32 v4, v4, v3, s[88:89]
    v_mov_b32 v3, 0x0c0c0c0c
    v_cndmask_b32 v164, v2, v3, s[90:91]
    v_cndmask_b32 v165, v4, v3, s[94:95]
    v_cndmask_b32 v166, v3, v2, s[90:91]
    v_cndmask_b32 v167, v3, v4, s[94:95]
    s_cmp_eq_u32 s4, 0
    s_cselect_b32 s92, 0xf149f2ca, 0
    v_mov_b32 v20, 0xc0135761
    s_lshl_b32 s3, s13, 10
    s_add_u32 s3, s3, 159744
    v_lshl_add_u32 v21, v16, 5, s3
    v_and_b32 v11, 15, v0
    s_lshl_b32 s3, s14, 6
    v_lshl_add_u32 v11, v11, 2, s3
    s_add_u32 s3, s2, 64
    s_and_b32 s3, s3, 255
    s_mul_i32 s93, s3, 147
    s_lshr_b32 s93, s93, 12
    s_mul_i32 s8, s93, 28
    s_sub_u32 s11, s3, s8
    s_cmp_lt_u32 s3, 112
    s_cselect_b32 s10, 2, 0
    s_sub_u32 s3, s2, 64
    s_and_b32 s8, s3, 31
    s_add_u32 s8, s8, 16
    s_lshr_b32 s9, s3, 5
    s_cmp_lt_u32 s3, 128
    s_cselect_b32 s10, 1, s10
    s_cselect_b32 s11, s8, s11
    s_cselect_b32 s93, s9, s93
    s_cmp_eq_u32 s10, 1
    s_cselect_b32 s68, s76, s64
    s_cselect_b32 s69, s77, s65
    s_cselect_b32 s70, s78, 1835008
    s_movk_i32 s46, 3584
    s_cselect_b32 s46, 6144, s46
    s_movk_i32 s8, 7168
    s_cselect_b32 s8, 12288, s8
    s_cselect_b32 s9, 0, 49152
    s_mul_i32 s8, s8, s93
    s_add_u32 s8, s8, s9
    s_lshl_b32 s3, s11, 8
    s_add_u32 s8, s8, s3
    s_lshl_b32 s3, s6, 6
    s_add_u32 s8, s8, s3
    s_add_u32 s44, s8, 65536
    v_lshrrev_b32 v2, 3, v0
    s_lshl_b32 s3, s6, 3
    v_add_u32 v2, s3, v2
    v_mul_lo_u32 v47, v2, s46
    v_add_u32 v47, v42, v47
    s_lshl_b32 s46, s46, 5
    s_mul_i32 s45, s46, s93
    s_lshl_b32 s45, s45, 2
    s_lshl_b32 s3, s11, 7
    s_add_u32 s45, s45, s3
    s_lshl_b32 s3, s93, 8
    s_add_u32 s3, s3, 161792
    s_cmp_eq_u32 s10, 1
    s_cselect_b32 s3, s3, 155648
    v_lshrrev_b32 v2, 4, v0
    v_lshlrev_b32 v2, 4, v2
    v_add_u32 v45, s3, v2
    v_and_b32 v3, 15, v0
    v_mul_u32_u24 v3, 79104, v3
    v_add_u32 v46, v2, v3
    s_cmp_eq_u32 s10, 0
    s_cselect_b32 s70, 0, s70
    s_cselect_b32 s44, 0x7fffffff, s44
    s_lshl_b64 s[64:65], 1, s6
    s_lshl_b32 s10, s6, 10
    s_add_u32 s11, s10, s101
    s_add_u32 s93, s11, 24576
    s_add_u32 s3, s10, 147456
    v_add_u32 v5, s3, v1
    s_lshl_b32 s3, s6, 8
    s_add_u32 s3, s3, s101
    s_add_u32 s100, s3, 77824
    s_cmp_ge_u32 s6, 2
    s_cselect_b32 s10, 1.0, 0
    v_lshlrev_b32 v172, 2, v0
    v_add_u32 v174, 20480, v40
    v_add_u32 v175, 12288, v1
    v_add_u32 v44, 81920, v40
    buffer_load_dword v173, v172, s[84:87], s100 offen sc1
    s_waitcnt vmcnt(0)
    v_cmp_ne_u32 vcc, s7, v173
    s_nop 0
    s_cmp_eq_u64 vcc, 0
    s_cbranch_scc0 Lslow_80
Lok_78:
    buffer_load_dwordx4 v[24:27], v1, s[84:87], s11 offen
    buffer_load_dwordx4 v[28:31], v175, s[84:87], s11 offen
    buffer_load_dwordx4 v[32:35], v1, s[84:87], s93 offen
    buffer_load_dwordx4 v[36:39], v175, s[84:87], s93 offen
    s_mov_b32 s59, s10
    s_add_u32 m0, s12, 106496
    s_mov_b32 s10, 688128
    buffer_load_dwordx4 v43, s[48:51], s10 offen lds
    s_add_u32 m0, s12, 110592
    s_mov_b32 s10, 689152
    buffer_load_dwordx4 v43, s[48:51], s10 offen lds
    s_add_u32 m0, s12, 114688
    s_mov_b32 s10, 690176
    buffer_load_dwordx4 v43, s[48:51], s10 offen lds
    s_add_u32 m0, s12, 118784
    s_mov_b32 s10, 786432
    buffer_load_dwordx4 v43, s[48:51], s10 offen lds
    s_add_u32 m0, s12, 122880
    s_mov_b32 s10, 787456
    buffer_load_dwordx4 v43, s[48:51], s10 offen lds
    s_add_u32 m0, s12, 126976
    s_mov_b32 s10, 788480
    buffer_load_dwordx4 v43, s[48:51], s10 offen lds
    s_add_u32 m0, s12, 131072
    s_nop 0
    buffer_load_dwordx4 v47, s[68:71], s45 offen lds
    s_add_u32 s45, s45, s46
    s_add_u32 m0, s12, 135168
    s_nop 0
    buffer_load_dwordx4 v47, s[68:71], s45 offen lds
    s_add_u32 s45, s45, s46
    s_add_u32 m0, s12, 139264
    s_nop 0
    buffer_load_dwordx4 v47, s[68:71], s45 offen lds
    s_add_u32 s45, s45, s46
    s_add_u32 m0, s12, 143360
    s_nop 0
    buffer_load_dwordx4 v47, s[68:71], s45 offen lds
    s_lshl_b32 s3, s2, 2
    s_add_u32 s3, s3, s6
    s_mul_i32 s8, s3, 672
    s_add_u32 s8, s8, 884736
    s_lshl_b32 s3, s3, 9
    v_lshlrev_b32 v2, 7, v0
    s_mov_b64 exec, 0x3f
    buffer_load_dword v255, v2, s[48:51], s8 offen
    s_mov_b64 exec, 0xf
    buffer_load_dword v255, v2, s[52:55], s3 offen
    s_mov_b64 exec, -1
    v_mov_b32 v4, 159488
    v_mov_b32 v3, 1
    s_mov_b64 exec, 1
    ds_add_u32 v4, v3 offset:8
    s_mov_b64 exec, -1
    s_movk_i32 s3, 0x7fff
Lsy_81:
    ds_read_b32 v3, v4 offset:8
    s_waitcnt lgkmcnt(0)
    v_readfirstlane_b32 s8, v3
    s_sub_u32 s3, s3, 1
    s_cselect_b32 s8, 4, s8
    s_cmp_lt_u32 s8, 4
    s_cbranch_scc1 Lsy_81
    ds_read_b64_tr_b16 v[48:49], v174 offset:0
    ds_read_b64_tr_b16 v[50:51], v174 offset:512
    ds_read_b64_tr_b16 v[52:53], v174 offset:4096
    ds_read_b64_tr_b16 v[54:55], v174 offset:4608
    ds_read_b64_tr_b16 v[56:57], v174 offset:8192
    ds_read_b64_tr_b16 v[58:59], v174 offset:8704
    s_waitcnt vmcnt(12)
    v_xor_b32 v24, s1, v24
    v_xor_b32 v25, s47, v25
    v_xor_b32 v26, s66, v26
    v_xor_b32 v27, s67, v27
    v_xor_b32 v28, s1, v28
    v_xor_b32 v29, s47, v29
    v_xor_b32 v30, s66, v30
    v_xor_b32 v31, s67, v31
    v_xor_b32 v32, s1, v32
    v_xor_b32 v33, s47, v33
    v_xor_b32 v34, s66, v34
    v_xor_b32 v35, s67, v35
    v_xor_b32 v36, s1, v36
    v_xor_b32 v37, s47, v37
    v_xor_b32 v38, s66, v38
    v_xor_b32 v39, s67, v39
    v_or_b32 v2, v24, v25
    v_or3_b32 v2, v2, v26, v27
    v_or3_b32 v2, v2, v28, v29
    v_or3_b32 v2, v2, v30, v31
    v_or3_b32 v2, v2, v32, v33
    v_or3_b32 v2, v2, v34, v35
    v_or3_b32 v2, v2, v36, v37
    v_or3_b32 v2, v2, v38, v39
    v_and_b32 v2, 0xff, v2
    v_cmp_ne_u32 vcc, 0, v2
    s_nop 0
    s_cmp_eq_u64 vcc, 0
    s_cbranch_scc0 Lslow_84
Lok_82:
    v_pk_add_f32 v[24:25], v[24:25], v[28:29]
    v_pk_add_f32 v[32:33], v[32:33], v[36:37]
    v_pk_add_f32 v[26:27], v[26:27], v[30:31]
    v_pk_add_f32 v[34:35], v[34:35], v[38:39]
    v_pk_add_f32 v[24:25], v[24:25], v[32:33]
    v_pk_add_f32 v[26:27], v[26:27], v[34:35]
    v_cvt_pk_bf16_f32 v28, v24, v25
    v_cvt_pk_bf16_f32 v29, v26, v27
    v_lshlrev_b32 v168, 16, v28
    v_and_b32 v169, 0xffff0000, v28
    v_lshlrev_b32 v170, 16, v29
    v_and_b32 v171, 0xffff0000, v29
    v_add_f32 v168, s59, v168
    v_add_f32 v169, s59, v169
    v_add_f32 v170, s59, v170
    v_add_f32 v171, s59, v171
    v_cvt_pk_bf16_f32 v24, v168, v169
    v_cvt_pk_bf16_f32 v26, v170, v171
    v_lshlrev_b32 v168, 16, v24
    v_and_b32 v169, 0xffff0000, v24
    v_lshlrev_b32 v170, 16, v26
    v_and_b32 v171, 0xffff0000, v26
    ds_write_b128 v5, v[168:171]
    s_waitcnt lgkmcnt(0)
    s_barrier
    ds_read_b64_tr_b16 v[60:61], v174 offset:12288
    ds_read_b64_tr_b16 v[62:63], v174 offset:12800
    ds_read_b64_tr_b16 v[64:65], v174 offset:16384
    ds_read_b64_tr_b16 v[66:67], v174 offset:16896
    ds_read_b64_tr_b16 v[68:69], v174 offset:20480
    ds_read_b64_tr_b16 v[70:71], v174 offset:20992
    ds_read_b64_tr_b16 v[72:73], v174 offset:24576
    ds_read_b64_tr_b16 v[74:75], v174 offset:25088
    ds_read_b64_tr_b16 v[76:77], v174 offset:28672
    ds_read_b64_tr_b16 v[78:79], v174 offset:29184
    ds_read_b64_tr_b16 v[80:81], v174 offset:32768
    ds_read_b64_tr_b16 v[82:83], v174 offset:33280
    s_waitcnt lgkmcnt(6)
    ds_read_b64_tr_b16 v[84:85], v174 offset:36864
    ds_read_b64_tr_b16 v[86:87], v174 offset:37376
    ds_read_b64_tr_b16 v[88:89], v174 offset:40960
    ds_read_b64_tr_b16 v[90:91], v174 offset:41472
    ds_read_b64_tr_b16 v[92:93], v174 offset:45056
    ds_read_b64_tr_b16 v[94:95], v174 offset:45568
    s_waitcnt lgkmcnt(6)
    ds_read_b64_tr_b16 v[96:97], v174 offset:49152
    ds_read_b64_tr_b16 v[98:99], v174 offset:49664
    ds_read_b64_tr_b16 v[100:101], v174 offset:53248
    ds_read_b64_tr_b16 v[102:103], v174 offset:53760
    ds_read_b64_tr_b16 v[104:105], v174 offset:57344
    ds_read_b64_tr_b16 v[106:107], v174 offset:57856
    s_waitcnt lgkmcnt(6)
    s_waitcnt lgkmcnt(0)
    s_barrier
    s_nop 0
    ds_read_b64_tr_b16 v[108:109], v44 offset:0
    ds_read_b64_tr_b16 v[110:111], v44 offset:512
    ds_read_b64_tr_b16 v[112:113], v44 offset:4096
    ds_read_b64_tr_b16 v[114:115], v44 offset:4608
    ds_read_b64_tr_b16 v[116:117], v44 offset:8192
    ds_read_b64_tr_b16 v[118:119], v44 offset:8704
    ds_read_b64_tr_b16 v[120:121], v44 offset:12288
    ds_read_b64_tr_b16 v[122:123], v44 offset:12800
    ds_read_b64_tr_b16 v[124:125], v44 offset:16384
    ds_read_b64_tr_b16 v[126:127], v44 offset:16896
    ds_read_b64_tr_b16 v[128:129], v44 offset:20480
    ds_read_b64_tr_b16 v[130:131], v44 offset:20992
    s_waitcnt lgkmcnt(6)
    s_waitcnt lgkmcnt(0)
    s_xor_b32 s3, s6, 1
    s_lshl_b64 s[50:51], 1, s3
    ds_read_b128 v[24:27], v45 offset:0
    ds_read_b128 v[28:31], v45 offset:64
    ds_read_b128 v[32:35], v45 offset:128
    ds_read_b128 v[36:39], v45 offset:192
    s_waitcnt vmcnt(2)
    v_mov_b32 v4, 159488
    v_mov_b32 v3, 1
    s_mov_b64 exec, 1
    ds_add_u32 v4, v3 offset:12
    s_mov_b64 exec, -1
    s_movk_i32 s3, 0x7fff
Lsy_85:
    ds_read_b32 v3, v4 offset:12
    s_waitcnt lgkmcnt(0)
    v_readfirstlane_b32 s8, v3
    s_sub_u32 s3, s3, 1
    s_cselect_b32 s8, 4, s8
    s_cmp_lt_u32 s8, 4
    s_cbranch_scc1 Lsy_85
    s_nop 0
    ds_read_b64_tr_b16 v[168:169], v44 offset:49152
    ds_read_b64_tr_b16 v[170:171], v44 offset:49664
    ds_read_b64_tr_b16 v[172:173], v44 offset:53248
    ds_read_b64_tr_b16 v[174:175], v44 offset:53760
    ds_read_b64_tr_b16 v[176:177], v44 offset:57344
    ds_read_b64_tr_b16 v[178:179], v44 offset:57856
    ds_read_b64_tr_b16 v[180:181], v44 offset:61440
    ds_read_b64_tr_b16 v[182:183], v44 offset:61952
    s_waitcnt lgkmcnt(6)
    v_mfma_f32_16x16x32_bf16 v[156:159], v[168:171], v[24:27], 0
    s_waitcnt lgkmcnt(4)
    v_mfma_f32_16x16x32_bf16 v[156:159], v[172:175], v[28:31], v[156:159]
    s_waitcnt lgkmcnt(2)
    v_mfma_f32_16x16x32_bf16 v[156:159], v[176:179], v[32:35], v[156:159]
    s_waitcnt lgkmcnt(0)
    v_mfma_f32_16x16x32_bf16 v[156:159], v[180:183], v[36:39], v[156:159]
    s_mov_b32 s3, 0x7060500
    s_nop 6
    s_nop 0
    v_perm_b32 v156, v156, v6, s3
    s_mov_b32 s3, 0x7060501
    v_perm_b32 v157, v157, v6, s3
    s_mov_b32 s3, 0x7060502
    v_perm_b32 v158, v158, v6, s3
    s_mov_b32 s3, 0x7060503
    v_perm_b32 v159, v159, v6, s3
    buffer_store_dwordx4 v[156:159], v46, s[84:87], s44 offen sc1
    ds_read_b64_tr_b16 v[132:133], v44 offset:24576
    ds_read_b64_tr_b16 v[134:135], v44 offset:25088
    ds_read_b64_tr_b16 v[136:137], v44 offset:28672
    ds_read_b64_tr_b16 v[138:139], v44 offset:29184
    ds_read_b64_tr_b16 v[140:141], v44 offset:32768
    ds_read_b64_tr_b16 v[142:143], v44 offset:33280
    ds_read_b64_tr_b16 v[144:145], v44 offset:36864
    ds_read_b64_tr_b16 v[146:147], v44 offset:37376
    ds_read_b64_tr_b16 v[148:149], v44 offset:40960
    ds_read_b64_tr_b16 v[150:151], v44 offset:41472
    ds_read_b64_tr_b16 v[152:153], v44 offset:45056
    ds_read_b64_tr_b16 v[154:155], v44 offset:45568
    s_waitcnt lgkmcnt(6)
    s_waitcnt lgkmcnt(0)
    s_barrier
    ds_read_b128 v[208:211], v160 offset:0
    ds_read_b128 v[212:215], v160 offset:1024
    ds_read_b128 v[216:219], v160 offset:2048
    ds_read_b128 v[220:223], v160 offset:3072
    ds_read_b128 v[224:227], v160 offset:4096
    s_waitcnt lgkmcnt(4)
    v_mfma_f32_16x16x32_bf16 v[168:171], v[52:55], v[208:211], 0
    s_waitcnt lgkmcnt(3)
    v_mfma_f32_16x16x32_bf16 v[172:175], v[52:55], v[212:215], 0
    ds_read_b128 v[228:231], v161 offset:5120
    v_mfma_f32_16x16x32_bf16 v[24:27], v[48:51], v[212:215], 0
    ds_read_b128 v[232:235], v161 offset:6144
    s_waitcnt lgkmcnt(4)
    v_mfma_f32_16x16x32_bf16 v[176:179], v[52:55], v[216:219], 0
    ds_read_b128 v[236:239], v161 offset:7168
    v_mfma_f32_16x16x32_bf16 v[28:31], v[48:51], v[216:219], 0
    ds_read_b128 v[240:243], v161 offset:8192
    s_waitcnt lgkmcnt(5)
    v_mfma_f32_16x16x32_bf16 v[180:183], v[52:55], v[220:223], 0
    ds_read_b128 v[244:247], v161 offset:9216
    v_mfma_f32_16x16x32_bf16 v[32:35], v[48:51], v[220:223], 0
    s_waitcnt lgkmcnt(5)
    v_mfma_f32_16x16x32_bf16 v[184:187], v[52:55], v[224:227], 0
    v_mfma_f32_16x16x32_bf16 v[36:39], v[48:51], v[224:227], 0
    v_mfma_f32_16x16x32_bf16 v[188:191], v[208:211], v[56:59], 0
    v_mfma_f32_16x16x32_bf16 v[192:195], v[212:215], v[56:59], 0
    v_mfma_f32_16x16x32_bf16 v[196:199], v[216:219], v[56:59], 0
    v_mfma_f32_16x16x32_bf16 v[200:203], v[220:223], v[56:59], 0
    v_mfma_f32_16x16x32_bf16 v[204:207], v[224:227], v[56:59], 0
    s_waitcnt lgkmcnt(4)
    v_mfma_f32_16x16x32_bf16 v[168:171], v[64:67], v[228:231], v[168:171]
    s_waitcnt lgkmcnt(3)
    v_mfma_f32_16x16x32_bf16 v[172:175], v[64:67], v[232:235], v[172:175]
    ds_read_b128 v[208:211], v162 offset:10240
    v_mfma_f32_16x16x32_bf16 v[24:27], v[60:63], v[232:235], v[24:27]
    ds_read_b128 v[212:215], v162 offset:11264
    s_waitcnt lgkmcnt(4)
    v_mfma_f32_16x16x32_bf16 v[176:179], v[64:67], v[236:239], v[176:179]
    ds_read_b128 v[216:219], v162 offset:12288
    v_mfma_f32_16x16x32_bf16 v[28:31], v[60:63], v[236:239], v[28:31]
    ds_read_b128 v[220:223], v162 offset:13312
    s_waitcnt lgkmcnt(5)
    v_mfma_f32_16x16x32_bf16 v[180:183], v[64:67], v[240:243], v[180:183]
    ds_read_b128 v[224:227], v162 offset:14336
    v_mfma_f32_16x16x32_bf16 v[32:35], v[60:63], v[240:243], v[32:35]
    s_waitcnt lgkmcnt(5)
    v_mfma_f32_16x16x32_bf16 v[184:187], v[64:67], v[244:247], v[184:187]
    v_mfma_f32_16x16x32_bf16 v[36:39], v[60:63], v[244:247], v[36:39]
    v_mfma_f32_16x16x32_bf16 v[188:191], v[228:231], v[68:71], v[188:191]
    v_mfma_f32_16x16x32_bf16 v[192:195], v[232:235], v[68:71], v[192:195]
    v_mfma_f32_16x16x32_bf16 v[196:199], v[236:239], v[68:71], v[196:199]
    v_mfma_f32_16x16x32_bf16 v[200:203], v[240:243], v[68:71], v[200:203]
    v_mfma_f32_16x16x32_bf16 v[204:207], v[244:247], v[68:71], v[204:207]
    s_waitcnt lgkmcnt(4)
    v_mfma_f32_16x16x32_bf16 v[168:171], v[76:79], v[208:211], v[168:171]
    s_waitcnt lgkmcnt(3)
    v_mfma_f32_16x16x32_bf16 v[172:175], v[76:79], v[212:215], v[172:175]
    ds_read_b128 v[228:231], v163 offset:15360
    v_mfma_f32_16x16x32_bf16 v[24:27], v[72:75], v[212:215], v[24:27]
    ds_read_b128 v[232:235], v163 offset:16384
    s_waitcnt lgkmcnt(4)
    v_mfma_f32_16x16x32_bf16 v[176:179], v[76:79], v[216:219], v[176:179]
    ds_read_b128 v[236:239], v163 offset:17408
    v_mfma_f32_16x16x32_bf16 v[28:31], v[72:75], v[216:219], v[28:31]
    ds_read_b128 v[240:243], v163 offset:18432
    s_waitcnt lgkmcnt(5)
    v_mfma_f32_16x16x32_bf16 v[180:183], v[76:79], v[220:223], v[180:183]
    ds_read_b128 v[244:247], v163 offset:19456
    v_mfma_f32_16x16x32_bf16 v[32:35], v[72:75], v[220:223], v[32:35]
    s_waitcnt lgkmcnt(5)
    v_mfma_f32_16x16x32_bf16 v[184:187], v[76:79], v[224:227], v[184:187]
    v_mfma_f32_16x16x32_bf16 v[36:39], v[72:75], v[224:227], v[36:39]
    v_mfma_f32_16x16x32_bf16 v[188:191], v[208:211], v[80:83], v[188:191]
    v_mfma_f32_16x16x32_bf16 v[192:195], v[212:215], v[80:83], v[192:195]
    v_mfma_f32_16x16x32_bf16 v[196:199], v[216:219], v[80:83], v[196:199]
    v_mfma_f32_16x16x32_bf16 v[200:203], v[220:223], v[80:83], v[200:203]
    v_mfma_f32_16x16x32_bf16 v[204:207], v[224:227], v[80:83], v[204:207]
    s_waitcnt lgkmcnt(4)
    v_mfma_f32_16x16x32_bf16 v[168:171], v[88:91], v[228:231], v[168:171]
    s_waitcnt lgkmcnt(3)
    v_mfma_f32_16x16x32_bf16 v[172:175], v[88:91], v[232:235], v[172:175]
    ds_read_b128 v[208:211], v160 offset:20480
    v_mfma_f32_16x16x32_bf16 v[24:27], v[84:87], v[232:235], v[24:27]
    ds_read_b128 v[212:215], v160 offset:21504
    s_waitcnt lgkmcnt(4)
    v_mfma_f32_16x16x32_bf16 v[176:179], v[88:91], v[236:239], v[176:179]
    ds_read_b128 v[216:219], v160 offset:22528
    v_mfma_f32_16x16x32_bf16 v[28:31], v[84:87], v[236:239], v[28:31]
    ds_read_b128 v[220:223], v160 offset:23552
    s_waitcnt lgkmcnt(5)
    v_mfma_f32_16x16x32_bf16 v[180:183], v[88:91], v[240:243], v[180:183]
    ds_read_b128 v[224:227], v160 offset:24576
    v_mfma_f32_16x16x32_bf16 v[32:35], v[84:87], v[240:243], v[32:35]
    s_waitcnt lgkmcnt(5)
    v_mfma_f32_16x16x32_bf16 v[184:187], v[88:91], v[244:247], v[184:187]
    v_mfma_f32_16x16x32_bf16 v[36:39], v[84:87], v[244:247], v[36:39]
    v_mfma_f32_16x16x32_bf16 v[188:191], v[228:231], v[92:95], v[188:191]
    v_mfma_f32_16x16x32_bf16 v[192:195], v[232:235], v[92:95], v[192:195]
    v_mfma_f32_16x16x32_bf16 v[196:199], v[236:239], v[92:95], v[196:199]
    v_mfma_f32_16x16x32_bf16 v[200:203], v[240:243], v[92:95], v[200:203]
    v_mfma_f32_16x16x32_bf16 v[204:207], v[244:247], v[92:95], v[204:207]
    s_waitcnt lgkmcnt(4)
    v_mfma_f32_16x16x32_bf16 v[168:171], v[100:103], v[208:211], v[168:171]
    s_waitcnt lgkmcnt(3)
    v_mfma_f32_16x16x32_bf16 v[172:175], v[100:103], v[212:215], v[172:175]
    s_waitcnt lgkmcnt(0)
    s_barrier
    ds_read_b128 v[228:231], v161 offset:25600
    v_mfma_f32_16x16x32_bf16 v[24:27], v[96:99], v[212:215], v[24:27]
    ds_read_b128 v[232:235], v161 offset:26624
    v_mfma_f32_16x16x32_bf16 v[176:179], v[100:103], v[216:219], v[176:179]
    ds_read_b128 v[236:239], v161 offset:27648
    v_mfma_f32_16x16x32_bf16 v[28:31], v[96:99], v[216:219], v[28:31]
    ds_read_b128 v[240:243], v161 offset:28672
    v_mfma_f32_16x16x32_bf16 v[180:183], v[100:103], v[220:223], v[180:183]
    ds_read_b128 v[244:247], v161 offset:29696
    v_mfma_f32_16x16x32_bf16 v[32:35], v[96:99], v[220:223], v[32:35]
    v_mfma_f32_16x16x32_bf16 v[184:187], v[100:103], v[224:227], v[184:187]
    v_mfma_f32_16x16x32_bf16 v[36:39], v[96:99], v[224:227], v[36:39]
    v_mfma_f32_16x16x32_bf16 v[188:191], v[208:211], v[104:107], v[188:191]
    v_mfma_f32_16x16x32_bf16 v[192:195], v[212:215], v[104:107], v[192:195]
    v_mfma_f32_16x16x32_bf16 v[196:199], v[216:219], v[104:107], v[196:199]
    v_mfma_f32_16x16x32_bf16 v[200:203], v[220:223], v[104:107], v[200:203]
    v_mfma_f32_16x16x32_bf16 v[204:207], v[224:227], v[104:107], v[204:207]
    s_waitcnt lgkmcnt(4)
    v_mfma_f32_16x16x32_bf16 v[168:171], v[112:115], v[228:231], v[168:171]
    s_waitcnt lgkmcnt(3)
    v_mfma_f32_16x16x32_bf16 v[172:175], v[112:115], v[232:235], v[172:175]
    ds_read_b128 v[208:211], v162 offset:30720
    v_mfma_f32_16x16x32_bf16 v[24:27], v[108:111], v[232:235], v[24:27]
    ds_read_b128 v[212:215], v162 offset:31744
    s_waitcnt lgkmcnt(4)
    v_mfma_f32_16x16x32_bf16 v[176:179], v[112:115], v[236:239], v[176:179]
    ds_read_b128 v[216:219], v162 offset:32768
    v_mfma_f32_16x16x32_bf16 v[28:31], v[108:111], v[236:239], v[28:31]
    ds_read_b128 v[220:223], v162 offset:33792
    s_waitcnt lgkmcnt(5)
    v_mfma_f32_16x16x32_bf16 v[180:183], v[112:115], v[240:243], v[180:183]
    ds_read_b128 v[224:227], v162 offset:34816
    v_mfma_f32_16x16x32_bf16 v[32:35], v[108:111], v[240:243], v[32:35]
    s_waitcnt lgkmcnt(5)
    v_mfma_f32_16x16x32_bf16 v[184:187], v[112:115], v[244:247], v[184:187]
    v_mfma_f32_16x16x32_bf16 v[36:39], v[108:111], v[244:247], v[36:39]
    v_mfma_f32_16x16x32_bf16 v[188:191], v[228:231], v[116:119], v[188:191]
    v_mfma_f32_16x16x32_bf16 v[192:195], v[232:235], v[116:119], v[192:195]
    v_and_b32 v3, 15, v0
    v_lshlrev_b32 v3, 7, v3
    v_lshrrev_b32 v255, 4, v0
    v_lshl_add_u32 v3, v255, 16, v3
    s_add_u32 s3, s96, 0
    s_mov_b32 s8, 65535
    s_mov_b32 s9, 0
    s_mov_b64 exec, s[8:9]
    buffer_load_dword v255, v3, s[84:87], s3 offen sc1
    s_mov_b64 exec, -1
    s_lshl_b32 s3, s5, 2
    s_add_u32 s3, s3, s6
    s_lshl_b32 s3, s3, 10
    s_add_u32 s3, s3, s40
    s_add_u32 s3, s3, 262144
    v_lshlrev_b32 v3, 7, v0
    s_mov_b64 exec, 0xff
    buffer_load_dword v255, v3, s[84:87], s3 offen sc1
    s_mov_b64 exec, -1
    v_mfma_f32_16x16x32_bf16 v[196:199], v[236:239], v[116:119], v[196:199]
    v_mfma_f32_16x16x32_bf16 v[200:203], v[240:243], v[116:119], v[200:203]
    v_mfma_f32_16x16x32_bf16 v[204:207], v[244:247], v[116:119], v[204:207]
    s_waitcnt lgkmcnt(4)
    v_mfma_f32_16x16x32_bf16 v[168:171], v[124:127], v[208:211], v[168:171]
    s_waitcnt lgkmcnt(3)
    v_mfma_f32_16x16x32_bf16 v[172:175], v[124:127], v[212:215], v[172:175]
    ds_read_b128 v[228:231], v163 offset:35840
    v_mfma_f32_16x16x32_bf16 v[24:27], v[120:123], v[212:215], v[24:27]
    ds_read_b128 v[232:235], v163 offset:36864
    s_waitcnt lgkmcnt(4)
    v_mfma_f32_16x16x32_bf16 v[176:179], v[124:127], v[216:219], v[176:179]
    ds_read_b128 v[236:239], v163 offset:37888
    v_mfma_f32_16x16x32_bf16 v[28:31], v[120:123], v[216:219], v[28:31]
    ds_read_b128 v[240:243], v163 offset:38912
    s_waitcnt lgkmcnt(5)
    v_mfma_f32_16x16x32_bf16 v[180:183], v[124:127], v[220:223], v[180:183]
    ds_read_b128 v[244:247], v163 offset:39936
    v_mfma_f32_16x16x32_bf16 v[32:35], v[120:123], v[220:223], v[32:35]
    s_waitcnt lgkmcnt(5)
    v_mfma_f32_16x16x32_bf16 v[184:187], v[124:127], v[224:227], v[184:187]
    v_mfma_f32_16x16x32_bf16 v[36:39], v[120:123], v[224:227], v[36:39]
    v_mfma_f32_16x16x32_bf16 v[188:191], v[208:211], v[128:131], v[188:191]
    v_mfma_f32_16x16x32_bf16 v[192:195], v[212:215], v[128:131], v[192:195]
    v_mfma_f32_16x16x32_bf16 v[196:199], v[216:219], v[128:131], v[196:199]
    v_mfma_f32_16x16x32_bf16 v[200:203], v[220:223], v[128:131], v[200:203]
    v_mfma_f32_16x16x32_bf16 v[204:207], v[224:227], v[128:131], v[204:207]
    s_waitcnt lgkmcnt(4)
    v_mfma_f32_16x16x32_bf16 v[168:171], v[136:139], v[228:231], v[168:171]
    s_waitcnt lgkmcnt(3)
    v_mfma_f32_16x16x32_bf16 v[172:175], v[136:139], v[232:235], v[172:175]
    v_add_u32 v160, 40960, v160
    v_add_u32 v161, 40960, v161
    v_add_u32 v162, 40960, v162
    v_add_u32 v163, 40960, v163
    v_mfma_f32_16x16x32_bf16 v[24:27], v[132:135], v[232:235], v[24:27]
    ds_read_b128 v[208:211], v160 offset:0
    s_waitcnt lgkmcnt(3)
    v_mfma_f32_16x16x32_bf16 v[176:179], v[136:139], v[236:239], v[176:179]
    ds_read_b128 v[212:215], v160 offset:1024
    v_mfma_f32_16x16x32_bf16 v[28:31], v[132:135], v[236:239], v[28:31]
    ds_read_b128 v[216:219], v160 offset:2048
    s_waitcnt lgkmcnt(4)
    v_mfma_f32_16x16x32_bf16 v[180:183], v[136:139], v[240:243], v[180:183]
    ds_read_b128 v[220:223], v160 offset:3072
    v_mfma_f32_16x16x32_bf16 v[32:35], v[132:135], v[240:243], v[32:35]
    ds_read_b128 v[224:227], v160 offset:4096
    s_waitcnt lgkmcnt(5)
    v_mfma_f32_16x16x32_bf16 v[184:187], v[136:139], v[244:247], v[184:187]
    v_mfma_f32_16x16x32_bf16 v[36:39], v[132:135], v[244:247], v[36:39]
    v_mfma_f32_16x16x32_bf16 v[188:191], v[228:231], v[140:143], v[188:191]
    v_mfma_f32_16x16x32_bf16 v[192:195], v[232:235], v[140:143], v[192:195]
    v_mfma_f32_16x16x32_bf16 v[196:199], v[236:239], v[140:143], v[196:199]
    v_mfma_f32_16x16x32_bf16 v[200:203], v[240:243], v[140:143], v[200:203]
    v_mfma_f32_16x16x32_bf16 v[204:207], v[244:247], v[140:143], v[204:207]
    s_waitcnt lgkmcnt(4)
    v_mfma_f32_16x16x32_bf16 v[168:171], v[148:151], v[208:211], v[168:171]
    s_waitcnt lgkmcnt(3)
    v_mfma_f32_16x16x32_bf16 v[172:175], v[148:151], v[212:215], v[172:175]
    s_waitcnt lgkmcnt(0)
    s_barrier
    s_nop 0
    ds_read_b64_tr_b16 v[52:53], v44 offset:4096
    ds_read_b64_tr_b16 v[54:55], v44 offset:4608
    v_mfma_f32_16x16x32_bf16 v[24:27], v[144:147], v[212:215], v[24:27]
    ds_read_b128 v[228:231], v161 offset:5120
    v_mfma_f32_16x16x32_bf16 v[176:179], v[148:151], v[216:219], v[176:179]
    ds_read_b128 v[232:235], v161 offset:6144
    v_mfma_f32_16x16x32_bf16 v[28:31], v[144:147], v[216:219], v[28:31]
    ds_read_b64_tr_b16 v[48:49], v44 offset:0
    ds_read_b64_tr_b16 v[50:51], v44 offset:512
    v_mfma_f32_16x16x32_bf16 v[180:183], v[148:151], v[220:223], v[180:183]
    ds_read_b128 v[236:239], v161 offset:7168
    v_mfma_f32_16x16x32_bf16 v[32:35], v[144:147], v[220:223], v[32:35]
    ds_read_b128 v[240:243], v161 offset:8192
    v_mfma_f32_16x16x32_bf16 v[184:187], v[148:151], v[224:227], v[184:187]
    ds_read_b128 v[244:247], v161 offset:9216
    v_mfma_f32_16x16x32_bf16 v[36:39], v[144:147], v[224:227], v[36:39]
    ds_read_b64_tr_b16 v[56:57], v44 offset:8192
    ds_read_b64_tr_b16 v[58:59], v44 offset:8704
    v_mfma_f32_16x16x32_bf16 v[188:191], v[208:211], v[152:155], v[188:191]
    v_mfma_f32_16x16x32_bf16 v[192:195], v[212:215], v[152:155], v[192:195]
    v_mfma_f32_16x16x32_bf16 v[196:199], v[216:219], v[152:155], v[196:199]
    v_mfma_f32_16x16x32_bf16 v[200:203], v[220:223], v[152:155], v[200:203]
    v_mfma_f32_16x16x32_bf16 v[204:207], v[224:227], v[152:155], v[204:207]
    s_waitcnt lgkmcnt(8)
    v_mfma_f32_16x16x32_bf16 v[168:171], v[52:55], v[228:231], v[168:171]
    s_waitcnt lgkmcnt(7)
    v_mfma_f32_16x16x32_bf16 v[172:175], v[52:55], v[232:235], v[172:175]
    ds_read_b64_tr_b16 v[64:65], v44 offset:16384
    ds_read_b64_tr_b16 v[66:67], v44 offset:16896
    s_waitcnt lgkmcnt(7)
    v_mfma_f32_16x16x32_bf16 v[24:27], v[48:51], v[232:235], v[24:27]
    ds_read_b128 v[208:211], v162 offset:10240
    s_waitcnt lgkmcnt(7)
    v_mfma_f32_16x16x32_bf16 v[176:179], v[52:55], v[236:239], v[176:179]
    ds_read_b128 v[212:215], v162 offset:11264
    v_mfma_f32_16x16x32_bf16 v[28:31], v[48:51], v[236:239], v[28:31]
    ds_read_b64_tr_b16 v[60:61], v44 offset:12288
    ds_read_b64_tr_b16 v[62:63], v44 offset:12800
    s_waitcnt lgkmcnt(9)
    v_mfma_f32_16x16x32_bf16 v[180:183], v[52:55], v[240:243], v[180:183]
    ds_read_b128 v[216:219], v162 offset:12288
    v_mfma_f32_16x16x32_bf16 v[32:35], v[48:51], v[240:243], v[32:35]
    ds_read_b128 v[220:223], v162 offset:13312
    s_waitcnt lgkmcnt(10)
    v_mfma_f32_16x16x32_bf16 v[184:187], v[52:55], v[244:247], v[184:187]
    ds_read_b128 v[224:227], v162 offset:14336
    v_mfma_f32_16x16x32_bf16 v[36:39], v[48:51], v[244:247], v[36:39]
    ds_read_b64_tr_b16 v[68:69], v44 offset:20480
    ds_read_b64_tr_b16 v[70:71], v44 offset:20992
    s_waitcnt lgkmcnt(11)
    v_mfma_f32_16x16x32_bf16 v[188:191], v[228:231], v[56:59], v[188:191]
    v_mfma_f32_16x16x32_bf16 v[192:195], v[232:235], v[56:59], v[192:195]
    v_mfma_f32_16x16x32_bf16 v[196:199], v[236:239], v[56:59], v[196:199]
    v_mfma_f32_16x16x32_bf16 v[200:203], v[240:243], v[56:59], v[200:203]
    v_mfma_f32_16x16x32_bf16 v[204:207], v[244:247], v[56:59], v[204:207]
    s_waitcnt lgkmcnt(8)
    v_mfma_f32_16x16x32_bf16 v[168:171], v[64:67], v[208:211], v[168:171]
    s_waitcnt lgkmcnt(7)
    v_mfma_f32_16x16x32_bf16 v[172:175], v[64:67], v[212:215], v[172:175]
    ds_read_b64_tr_b16 v[76:77], v44 offset:28672
    ds_read_b64_tr_b16 v[78:79], v44 offset:29184
    s_waitcnt lgkmcnt(7)
    v_mfma_f32_16x16x32_bf16 v[24:27], v[60:63], v[212:215], v[24:27]
    ds_read_b128 v[228:231], v163 offset:15360
    s_waitcnt lgkmcnt(7)
    v_mfma_f32_16x16x32_bf16 v[176:179], v[64:67], v[216:219], v[176:179]
    ds_read_b128 v[232:235], v163 offset:16384
    v_mfma_f32_16x16x32_bf16 v[28:31], v[60:63], v[216:219], v[28:31]
    ds_read_b64_tr_b16 v[72:73], v44 offset:24576
    ds_read_b64_tr_b16 v[74:75], v44 offset:25088
    s_waitcnt lgkmcnt(9)
    v_mfma_f32_16x16x32_bf16 v[180:183], v[64:67], v[220:223], v[180:183]
    ds_read_b128 v[236:239], v163 offset:17408
    v_mfma_f32_16x16x32_bf16 v[32:35], v[60:63], v[220:223], v[32:35]
    ds_read_b128 v[240:243], v163 offset:18432
    s_waitcnt lgkmcnt(10)
    v_mfma_f32_16x16x32_bf16 v[184:187], v[64:67], v[224:227], v[184:187]
    ds_read_b128 v[244:247], v163 offset:19456
    v_mfma_f32_16x16x32_bf16 v[36:39], v[60:63], v[224:227], v[36:39]
    ds_read_b64_tr_b16 v[80:81], v44 offset:32768
    ds_read_b64_tr_b16 v[82:83], v44 offset:33280
    s_waitcnt lgkmcnt(11)
    v_mfma_f32_16x16x32_bf16 v[188:191], v[208:211], v[68:71], v[188:191]
    v_mfma_f32_16x16x32_bf16 v[192:195], v[212:215], v[68:71], v[192:195]
    v_and_b32 v3, 15, v0
    v_lshlrev_b32 v3, 7, v3
    v_lshrrev_b32_e64 v255, 4, v0
    v_lshl_add_u32 v3, v255, 16, v3
    s_add_u32 s3, s96, 65536
    s_mov_b32 s8, 65535
    s_mov_b32 s9, 0
    s_mov_b64 exec, s[8:9]
    buffer_load_dword v255, v3, s[84:87], s3 offen sc1
    s_mov_b64 exec, -1
    v_mfma_f32_16x16x32_bf16 v[196:199], v[216:219], v[68:71], v[196:199]
    v_mfma_f32_16x16x32_bf16 v[200:203], v[220:223], v[68:71], v[200:203]
    v_mfma_f32_16x16x32_bf16 v[204:207], v[224:227], v[68:71], v[204:207]
    s_waitcnt lgkmcnt(8)
    v_mfma_f32_16x16x32_bf16 v[168:171], v[76:79], v[228:231], v[168:171]
    s_waitcnt lgkmcnt(7)
    v_mfma_f32_16x16x32_bf16 v[172:175], v[76:79], v[232:235], v[172:175]
    ds_read_b64_tr_b16 v[88:89], v44 offset:40960
    ds_read_b64_tr_b16 v[90:91], v44 offset:41472
    s_waitcnt lgkmcnt(7)
    v_mfma_f32_16x16x32_bf16 v[24:27], v[72:75], v[232:235], v[24:27]
    ds_read_b128 v[208:211], v160 offset:20480
    s_waitcnt lgkmcnt(7)
    v_mfma_f32_16x16x32_bf16 v[176:179], v[76:79], v[236:239], v[176:179]
    ds_read_b128 v[212:215], v160 offset:21504
    v_mfma_f32_16x16x32_bf16 v[28:31], v[72:75], v[236:239], v[28:31]
    ds_read_b64_tr_b16 v[84:85], v44 offset:36864
    ds_read_b64_tr_b16 v[86:87], v44 offset:37376
    s_waitcnt lgkmcnt(9)
    v_mfma_f32_16x16x32_bf16 v[180:183], v[76:79], v[240:243], v[180:183]
    ds_read_b128 v[216:219], v160 offset:22528
    v_mfma_f32_16x16x32_bf16 v[32:35], v[72:75], v[240:243], v[32:35]
    ds_read_b128 v[220:223], v160 offset:23552
    s_waitcnt lgkmcnt(10)
    v_mfma_f32_16x16x32_bf16 v[184:187], v[76:79], v[244:247], v[184:187]
    ds_read_b128 v[224:227], v160 offset:24576
    v_mfma_f32_16x16x32_bf16 v[36:39], v[72:75], v[244:247], v[36:39]
    ds_read_b64_tr_b16 v[92:93], v44 offset:45056
    ds_read_b64_tr_b16 v[94:95], v44 offset:45568
    s_waitcnt lgkmcnt(11)
    v_mfma_f32_16x16x32_bf16 v[188:191], v[228:231], v[80:83], v[188:191]
    v_mfma_f32_16x16x32_bf16 v[192:195], v[232:235], v[80:83], v[192:195]
    v_mfma_f32_16x16x32_bf16 v[196:199], v[236:239], v[80:83], v[196:199]
    v_mfma_f32_16x16x32_bf16 v[200:203], v[240:243], v[80:83], v[200:203]
    v_mfma_f32_16x16x32_bf16 v[204:207], v[244:247], v[80:83], v[204:207]
    s_waitcnt lgkmcnt(8)
    v_mfma_f32_16x16x32_bf16 v[168:171], v[88:91], v[208:211], v[168:171]
    s_waitcnt lgkmcnt(7)
    v_mfma_f32_16x16x32_bf16 v[172:175], v[88:91], v[212:215], v[172:175]
    ds_read_b64_tr_b16 v[100:101], v44 offset:53248
    ds_read_b64_tr_b16 v[102:103], v44 offset:53760
    s_waitcnt lgkmcnt(7)
    v_mfma_f32_16x16x32_bf16 v[24:27], v[84:87], v[212:215], v[24:27]
    ds_read_b128 v[228:231], v161 offset:25600
    s_waitcnt lgkmcnt(7)
    v_mfma_f32_16x16x32_bf16 v[176:179], v[88:91], v[216:219], v[176:179]
    ds_read_b128 v[232:235], v161 offset:26624
    v_mfma_f32_16x16x32_bf16 v[28:31], v[84:87], v[216:219], v[28:31]
    ds_read_b64_tr_b16 v[96:97], v44 offset:49152
    ds_read_b64_tr_b16 v[98:99], v44 offset:49664
    s_waitcnt lgkmcnt(9)
    v_mfma_f32_16x16x32_bf16 v[180:183], v[88:91], v[220:223], v[180:183]
    ds_read_b128 v[236:239], v161 offset:27648
    v_mfma_f32_16x16x32_bf16 v[32:35], v[84:87], v[220:223], v[32:35]
    ds_read_b128 v[240:243], v161 offset:28672
    s_waitcnt lgkmcnt(10)
    v_mfma_f32_16x16x32_bf16 v[184:187], v[88:91], v[224:227], v[184:187]
    ds_read_b128 v[244:247], v161 offset:29696
    v_mfma_f32_16x16x32_bf16 v[36:39], v[84:87], v[224:227], v[36:39]
    ds_read_b64_tr_b16 v[104:105], v44 offset:57344
    ds_read_b64_tr_b16 v[106:107], v44 offset:57856
    s_waitcnt lgkmcnt(11)
    v_mfma_f32_16x16x32_bf16 v[188:191], v[208:211], v[92:95], v[188:191]
    v_mfma_f32_16x16x32_bf16 v[192:195], v[212:215], v[92:95], v[192:195]
    v_mfma_f32_16x16x32_bf16 v[196:199], v[216:219], v[92:95], v[196:199]
    v_mfma_f32_16x16x32_bf16 v[200:203], v[220:223], v[92:95], v[200:203]
    v_mfma_f32_16x16x32_bf16 v[204:207], v[224:227], v[92:95], v[204:207]
    s_waitcnt lgkmcnt(8)
    v_mfma_f32_16x16x32_bf16 v[168:171], v[100:103], v[228:231], v[168:171]
    s_waitcnt lgkmcnt(7)
    v_mfma_f32_16x16x32_bf16 v[172:175], v[100:103], v[232:235], v[172:175]
    ds_read_b64_tr_b16 v[112:113], v40 offset:4096
    ds_read_b64_tr_b16 v[114:115], v40 offset:4608
    s_waitcnt lgkmcnt(7)
    v_mfma_f32_16x16x32_bf16 v[24:27], v[96:99], v[232:235], v[24:27]
    ds_read_b128 v[208:211], v162 offset:30720
    s_waitcnt lgkmcnt(7)
    v_mfma_f32_16x16x32_bf16 v[176:179], v[100:103], v[236:239], v[176:179]
    ds_read_b128 v[212:215], v162 offset:31744
    v_mfma_f32_16x16x32_bf16 v[28:31], v[96:99], v[236:239], v[28:31]
    ds_read_b64_tr_b16 v[108:109], v40 offset:0
    ds_read_b64_tr_b16 v[110:111], v40 offset:512
    s_waitcnt lgkmcnt(9)
    v_mfma_f32_16x16x32_bf16 v[180:183], v[100:103], v[240:243], v[180:183]
    ds_read_b128 v[216:219], v162 offset:32768
    v_mfma_f32_16x16x32_bf16 v[32:35], v[96:99], v[240:243], v[32:35]
    ds_read_b128 v[220:223], v162 offset:33792
    s_waitcnt lgkmcnt(10)
    v_mfma_f32_16x16x32_bf16 v[184:187], v[100:103], v[244:247], v[184:187]
    ds_read_b128 v[224:227], v162 offset:34816
    v_mfma_f32_16x16x32_bf16 v[36:39], v[96:99], v[244:247], v[36:39]
    ds_read_b64_tr_b16 v[116:117], v40 offset:8192
    ds_read_b64_tr_b16 v[118:119], v40 offset:8704
    s_waitcnt lgkmcnt(11)
    v_mfma_f32_16x16x32_bf16 v[188:191], v[228:231], v[104:107], v[188:191]
    v_mfma_f32_16x16x32_bf16 v[192:195], v[232:235], v[104:107], v[192:195]
    v_mfma_f32_16x16x32_bf16 v[196:199], v[236:239], v[104:107], v[196:199]
    v_mfma_f32_16x16x32_bf16 v[200:203], v[240:243], v[104:107], v[200:203]
    v_mfma_f32_16x16x32_bf16 v[204:207], v[244:247], v[104:107], v[204:207]
    s_waitcnt lgkmcnt(8)
    v_mfma_f32_16x16x32_bf16 v[168:171], v[112:115], v[208:211], v[168:171]
    s_waitcnt lgkmcnt(7)
    v_mfma_f32_16x16x32_bf16 v[172:175], v[112:115], v[212:215], v[172:175]
    v_mov_b32 v2, 159488
    ds_read_b32 v2, v2 offset:4
    ds_read_b64_tr_b16 v[124:125], v40 offset:16384
    ds_read_b64_tr_b16 v[126:127], v40 offset:16896
    s_waitcnt lgkmcnt(8)
    v_mfma_f32_16x16x32_bf16 v[24:27], v[108:111], v[212:215], v[24:27]
    ds_read_b128 v[228:231], v163 offset:35840
    s_waitcnt lgkmcnt(8)
    v_mfma_f32_16x16x32_bf16 v[176:179], v[112:115], v[216:219], v[176:179]
    ds_read_b128 v[232:235], v163 offset:36864
    v_mfma_f32_16x16x32_bf16 v[28:31], v[108:111], v[216:219], v[28:31]
    ds_read_b64_tr_b16 v[120:121], v40 offset:12288
    ds_read_b64_tr_b16 v[122:123], v40 offset:12800
    s_waitcnt lgkmcnt(10)
    v_mfma_f32_16x16x32_bf16 v[180:183], v[112:115], v[220:223], v[180:183]
    ds_read_b128 v[236:239], v163 offset:37888
    v_mfma_f32_16x16x32_bf16 v[32:35], v[108:111], v[220:223], v[32:35]
    ds_read_b128 v[240:243], v163 offset:38912
    s_waitcnt lgkmcnt(11)
    v_mfma_f32_16x16x32_bf16 v[184:187], v[112:115], v[224:227], v[184:187]
    ds_read_b128 v[244:247], v163 offset:39936
    v_mfma_f32_16x16x32_bf16 v[36:39], v[108:111], v[224:227], v[36:39]
    ds_read_b64_tr_b16 v[128:129], v40 offset:20480
    ds_read_b64_tr_b16 v[130:131], v40 offset:20992
    s_waitcnt lgkmcnt(12)
    v_mfma_f32_16x16x32_bf16 v[188:191], v[208:211], v[116:119], v[188:191]
    v_mfma_f32_16x16x32_bf16 v[192:195], v[212:215], v[116:119], v[192:195]
    v_mfma_f32_16x16x32_bf16 v[196:199], v[216:219], v[116:119], v[196:199]
    v_mfma_f32_16x16x32_bf16 v[200:203], v[220:223], v[116:119], v[200:203]
    s_waitcnt lgkmcnt(11)
    v_readfirstlane_b32 s3, v2
    s_mov_b32 s72, s84
    s_mov_b32 s73, s85
    s_mov_b32 s76, s84
    s_mov_b32 s77, s85
    s_cmp_eq_u32 s3, 1
    s_cselect_b32 s74, 22020096, 0
    s_cselect_b32 s78, 0, 22020096
    v_mfma_f32_16x16x32_bf16 v[204:207], v[224:227], v[116:119], v[204:207]
    s_waitcnt lgkmcnt(8)
    v_mfma_f32_16x16x32_bf16 v[168:171], v[124:127], v[228:231], v[168:171]
    s_waitcnt lgkmcnt(7)
    v_mfma_f32_16x16x32_bf16 v[172:175], v[124:127], v[232:235], v[172:175]
    v_mov_b32 v19, 1
    s_mov_b64 exec, s[64:65]
    ds_write_b32 v9, v19 offset:112
    s_mov_b64 exec, -1
    s_waitcnt lgkmcnt(6)
    v_mfma_f32_16x16x32_bf16 v[24:27], v[120:123], v[232:235], v[24:27]
    s_waitcnt lgkmcnt(5)
    v_mfma_f32_16x16x32_bf16 v[176:179], v[124:127], v[236:239], v[176:179]
    v_mfma_f32_16x16x32_bf16 v[28:31], v[120:123], v[236:239], v[28:31]
    s_waitcnt lgkmcnt(4)
    v_mfma_f32_16x16x32_bf16 v[180:183], v[124:127], v[240:243], v[180:183]
    v_mfma_f32_16x16x32_bf16 v[32:35], v[120:123], v[240:243], v[32:35]
    s_waitcnt lgkmcnt(3)
    v_mfma_f32_16x16x32_bf16 v[184:187], v[124:127], v[244:247], v[184:187]
    v_mfma_f32_16x16x32_bf16 v[36:39], v[120:123], v[244:247], v[36:39]
    s_waitcnt lgkmcnt(1)
    v_mfma_f32_16x16x32_bf16 v[188:191], v[228:231], v[128:131], v[188:191]
    v_mfma_f32_16x16x32_bf16 v[192:195], v[232:235], v[128:131], v[192:195]
    v_mfma_f32_16x16x32_bf16 v[196:199], v[236:239], v[128:131], v[196:199]
    v_mfma_f32_16x16x32_bf16 v[200:203], v[240:243], v[128:131], v[200:203]
    v_mfma_f32_16x16x32_bf16 v[204:207], v[244:247], v[128:131], v[204:207]
    v_cvt_pk_bf16_f32 v54, v168, v169
    v_cvt_pk_bf16_f32 v55, v170, v171
    v_cvt_pk_bf16_f32 v56, v172, v173
    v_cvt_pk_bf16_f32 v57, v174, v175
    v_cvt_pk_bf16_f32 v46, v24, v25
    v_cvt_pk_bf16_f32 v47, v26, v27
    v_cvt_pk_bf16_f32 v58, v176, v177
    v_cvt_pk_bf16_f32 v59, v178, v179
    v_cvt_pk_bf16_f32 v48, v28, v29
    v_cvt_pk_bf16_f32 v49, v30, v31
    v_cvt_pk_bf16_f32 v60, v180, v181
    v_cvt_pk_bf16_f32 v61, v182, v183
    v_cvt_pk_bf16_f32 v50, v32, v33
    v_cvt_pk_bf16_f32 v51, v34, v35
    v_cvt_pk_bf16_f32 v62, v184, v185
    v_cvt_pk_bf16_f32 v63, v186, v187
    v_cvt_pk_bf16_f32 v52, v36, v37
    v_cvt_pk_bf16_f32 v53, v38, v39
    v_mfma_f32_16x16x16_bf16 v[76:79], v[54:55], v[46:47], 0
    v_cvt_pk_bf16_f32 v64, v188, v189
    v_mfma_f32_16x16x16_bf16 v[92:95], v[56:57], v[46:47], 0
    v_cvt_pk_bf16_f32 v65, v190, v191
    v_mfma_f32_16x16x16_bf16 v[80:83], v[56:57], v[48:49], 0
    v_cvt_pk_bf16_f32 v66, v192, v193
    v_mfma_f32_16x16x16_bf16 v[96:99], v[58:59], v[48:49], 0
    v_cvt_pk_bf16_f32 v67, v194, v195
    v_mfma_f32_16x16x16_bf16 v[84:87], v[58:59], v[50:51], 0
    v_cvt_pk_bf16_f32 v68, v196, v197
    v_mfma_f32_16x16x16_bf16 v[100:103], v[60:61], v[50:51], 0
    v_cvt_pk_bf16_f32 v69, v198, v199
    v_mfma_f32_16x16x16_bf16 v[88:91], v[60:61], v[52:53], 0
    v_cvt_pk_bf16_f32 v70, v200, v201
    v_mfma_f32_16x16x16_bf16 v[104:107], v[62:63], v[52:53], 0
    v_cvt_pk_bf16_f32 v71, v202, v203
    v_cvt_pk_bf16_f32 v72, v204, v205
    v_cvt_pk_bf16_f32 v73, v206, v207
    v_cndmask_b32 v76, v76, v77, s[88:89]
    v_cndmask_b32 v78, v78, v79, s[88:89]
    v_cndmask_b32 v92, v92, v93, s[88:89]
    v_cndmask_b32 v94, v94, v95, s[88:89]
    v_add_f32 v76, s92, v76
    v_add_f32 v78, s92, v78
    v_cndmask_b32 v108, v76, v92, s[90:91]
    v_cndmask_b32 v112, v78, v94, s[94:95]
    v_max_f32_e64 v116, v108, v112
    v_cndmask_b32 v80, v80, v81, s[88:89]
    v_cndmask_b32 v82, v82, v83, s[88:89]
    v_cndmask_b32 v96, v96, v97, s[88:89]
    v_cndmask_b32 v98, v98, v99, s[88:89]
    v_cndmask_b32 v109, v80, v96, s[90:91]
    v_cndmask_b32 v113, v82, v98, s[94:95]
    v_max_f32_e64 v117, v109, v113
    v_cndmask_b32 v84, v84, v85, s[88:89]
    v_cndmask_b32 v86, v86, v87, s[88:89]
    v_cndmask_b32 v100, v100, v101, s[88:89]
    v_cndmask_b32 v102, v102, v103, s[88:89]
    v_cndmask_b32 v110, v84, v100, s[90:91]
    v_cndmask_b32 v114, v86, v102, s[94:95]
    v_max_f32_e64 v118, v110, v114
    v_cndmask_b32 v88, v88, v89, s[88:89]
    v_cndmask_b32 v90, v90, v91, s[88:89]
    v_cndmask_b32 v104, v104, v105, s[88:89]
    v_cndmask_b32 v106, v106, v107, s[88:89]
    v_cndmask_b32 v111, v88, v104, s[90:91]
    v_cndmask_b32 v115, v90, v106, s[94:95]
    v_max_f32 v119, v111, v115
    s_mov_b32 s93, 0x3eb8aa3b
    v_permlane16_swap_b32 v116, v117
    v_permlane16_swap_b32 v118, v119
    v_max_f32 v116, v116, v117
    v_max_f32 v118, v118, v119
    s_nop 1
    v_permlane32_swap_b32 v116, v118
    v_max_f32 v116, v116, v118
    v_mul_f32 v116, 0xbeb8aa3b, v116
    v_mov_b32 v118, v116
    s_nop 1
    v_permlane32_swap_b32 v116, v118
    v_mov_b32 v117, v116
    v_mov_b32 v119, v118
    s_nop 0
    v_permlane16_swap_b32 v116, v117
    v_permlane16_swap_b32 v118, v119
    v_fma_f32 v108, v108, s93, v116
    v_fma_f32 v112, v112, s93, v116
    v_fma_f32 v109, v109, s93, v117
    v_fma_f32 v113, v113, s93, v117
    v_fma_f32 v110, v110, s93, v118
    v_fma_f32 v114, v114, s93, v118
    v_fma_f32 v111, v111, s93, v119
    v_fma_f32 v115, v115, s93, v119
    v_exp_f32 v108, v108
    v_exp_f32 v112, v112
    v_exp_f32 v109, v109
    v_exp_f32 v113, v113
    v_exp_f32 v110, v110
    v_exp_f32 v114, v114
    v_exp_f32 v111, v111
    v_exp_f32 v115, v115
    v_add_f32 v116, v108, v112
    v_add_f32 v117, v109, v113
    v_add_f32 v118, v110, v114
    v_add_f32 v119, v111, v115
    v_permlane16_swap_b32 v116, v117
    s_nop 0
    v_permlane16_swap_b32 v118, v119
    v_add_f32 v116, v116, v117
    v_add_f32 v118, v118, v119
    s_nop 1
    v_permlane32_swap_b32 v116, v118
    v_add_f32 v116, v116, v118
    v_rcp_f32 v116, v116
    s_nop 0
    v_mov_b32 v118, v116
    s_nop 1
    v_permlane32_swap_b32 v116, v118
    v_mov_b32 v117, v116
    v_mov_b32 v119, v118
    s_nop 0
    v_permlane16_swap_b32 v116, v117
    v_permlane16_swap_b32 v118, v119
    v_mul_f32 v108, v108, v116
    v_mul_f32 v112, v112, v116
    v_mul_f32 v109, v109, v117
    v_mul_f32 v113, v113, v117
    v_mul_f32 v110, v110, v118
    v_mul_f32 v114, v114, v118
    v_mul_f32 v111, v111, v119
    v_mul_f32 v115, v115, v119
    v_cvt_pk_bf16_f32 v120, v108, v112
    v_cvt_pk_bf16_f32 v121, v109, v113
    v_cvt_pk_bf16_f32 v122, v110, v114
    v_cvt_pk_bf16_f32 v123, v111, v115
    v_perm_b32 v76, v120, v120, v164
    v_perm_b32 v77, v120, v120, v165
    v_perm_b32 v78, v120, v120, v166
    v_perm_b32 v79, v120, v120, v167
    v_perm_b32 v80, v121, v121, v164
    v_perm_b32 v81, v121, v121, v165
    v_perm_b32 v82, v121, v121, v166
    v_perm_b32 v83, v121, v121, v167
    v_mfma_f32_16x16x32_bf16 v[92:95], v[64:67], v[76:79], 0
    v_perm_b32 v84, v122, v122, v164
    v_perm_b32 v85, v122, v122, v165
    v_perm_b32 v86, v122, v122, v166
    v_perm_b32 v87, v122, v122, v167
    v_mfma_f32_16x16x32_bf16 v[96:99], v[66:69], v[80:83], 0
    v_perm_b32 v88, v123, v123, v164
    v_perm_b32 v89, v123, v123, v165
    v_perm_b32 v90, v123, v123, v166
    v_perm_b32 v91, v123, v123, v167
    v_mfma_f32_16x16x32_bf16 v[100:103], v[68:71], v[84:87], 0
    s_add_u32 s11, s99, 32768
    s_lshl_b32 s3, s5, 4
    s_lshl_b32 s8, s6, 2
    v_mfma_f32_16x16x32_bf16 v[104:107], v[70:73], v[88:91], 0
    s_add_u32 s3, s3, s8
    s_add_u32 s3, s3, s40
    s_add_u32 s10, s3, 319488
    v_cvt_pk_bf16_f32 v24, v92, v93
    v_cvt_pk_bf16_f32 v25, v94, v95
    v_cvt_pk_bf16_f32 v26, v96, v97
    v_cvt_pk_bf16_f32 v27, v98, v99
    s_nop 0
    v_permlane16_swap_b32 v24, v26
    v_permlane16_swap_b32 v25, v27
    buffer_store_dwordx4 v[24:27], v1, s[72:75], s99 offen
    s_cmp_eq_u32 s78, 0
    s_cbranch_scc0 Lslow_87
Lfs_86:
    v_cvt_pk_bf16_f32 v28, v100, v101
    v_cvt_pk_bf16_f32 v29, v102, v103
    v_cvt_pk_bf16_f32 v30, v104, v105
    v_cvt_pk_bf16_f32 v31, v106, v107
    s_nop 0
    v_permlane16_swap_b32 v28, v30
    v_permlane16_swap_b32 v29, v31
    buffer_store_dwordx4 v[28:31], v1, s[72:75], s11 offen
    s_cmp_eq_u32 s78, 0
    s_cbranch_scc0 Lslow_89
Lfs_88:
    s_add_u32 s11, s40, 319488
    s_mov_b32 s90, 0xbdd2d3e8
    s_mov_b32 s91, 0xbdd2d3e8
    v_lshl_add_u32 v216, v17, 9, v12
    v_xor_b32 v217, 64, v216
    s_add_u32 s12, s99, 32768
    s_waitcnt vmcnt(0)
    buffer_store_dword v6, v7, s[72:75], s10 offen
    s_cmp_eq_u32 s78, 0
    s_cbranch_scc0 Lslow_91
Lfs_90:
    ds_read_b32 v10, v9 offset:32
    s_waitcnt lgkmcnt(0)
    v_cmp_gt_u32 vcc, 1, v10
    s_cbranch_vccnz Lslow_94
Lfok_92:
    s_nop 0
    ds_read_b64_tr_b16 v[88:89], v216 offset:0
    ds_read_b64_tr_b16 v[90:91], v216 offset:512
    ds_read_b64_tr_b16 v[92:93], v217 offset:0
    ds_read_b64_tr_b16 v[94:95], v217 offset:512
    ds_read_b64_tr_b16 v[96:97], v216 offset:2048
    ds_read_b64_tr_b16 v[98:99], v216 offset:2560
    ds_read_b64_tr_b16 v[100:101], v217 offset:2048
    ds_read_b64_tr_b16 v[102:103], v217 offset:2560
    ds_read_b64_tr_b16 v[104:105], v216 offset:4096
    ds_read_b64_tr_b16 v[106:107], v216 offset:4608
    ds_read_b64_tr_b16 v[108:109], v217 offset:4096
    ds_read_b64_tr_b16 v[110:111], v217 offset:4608
    ds_read_b64_tr_b16 v[112:113], v216 offset:6144
    ds_read_b64_tr_b16 v[114:115], v216 offset:6656
    s_lshl_b32 s3, s13, 13
    s_add_u32 s3, s3, 131072
    v_lshl_add_u32 v3, v16, 7, s3
    v_lshl_add_u32 v3, v17, 3, v3
    v_and_b32 v4, 7, v0
    s_lshl_b32 s3, s14, 2
    v_xor_b32 v4, s3, v4
    v_xor_b32 v5, 0, v4
    v_lshl_add_u32 v184, v5, 4, v3
    v_xor_b32 v5, 1, v4
    v_lshl_add_u32 v185, v5, 4, v3
    v_xor_b32 v5, 2, v4
    v_lshl_add_u32 v186, v5, 4, v3
    v_xor_b32 v5, 3, v4
    v_lshl_add_u32 v187, v5, 4, v3
    s_waitcnt lgkmcnt(0)
    s_nop 0
    ds_read_b64 v[248:249], v184
    ds_read_b64 v[250:251], v185
    ds_read_b64 v[252:253], v186
    ds_read_b64 v[254:255], v187
    ds_read_b128 v[152:155], v18 offset:9728
    ds_read_b128 v[156:159], v18 offset:9760
    ds_read_b128 v[160:163], v18 offset:9792
    ds_read_b128 v[164:167], v18 offset:9824
    ds_read_b128 v[168:171], v18 offset:9472
    ds_read_b128 v[172:175], v18 offset:9504
    ds_read_b128 v[176:179], v18 offset:9536
    ds_read_b128 v[180:183], v18 offset:9568
    v_mov_b32 v19, 1
    s_mov_b64 exec, s[64:65]
    ds_write_b32 v9, v19 offset:80
    s_mov_b64 exec, -1
    buffer_load_dword v2, v11, s[84:87], s11 offen sc1
    s_waitcnt lgkmcnt(9)
    ds_read_b128 v[232:235], v18 offset:9216
    ds_read_b128 v[236:239], v18 offset:9248
    ds_read_b128 v[240:243], v18 offset:9280
    ds_read_b128 v[244:247], v18 offset:9312
    v_lshlrev_b32 v184, 16, v248
    v_and_b32 v185, 0xffff0000, v248
    v_lshlrev_b32 v186, 16, v249
    v_and_b32 v187, 0xffff0000, v249
    v_lshlrev_b32 v188, 16, v250
    v_and_b32 v189, 0xffff0000, v250
    v_lshlrev_b32 v190, 16, v251
    v_and_b32 v191, 0xffff0000, v251
    v_lshlrev_b32 v192, 16, v252
    v_and_b32 v193, 0xffff0000, v252
    v_lshlrev_b32 v194, 16, v253
    v_and_b32 v195, 0xffff0000, v253
    v_lshlrev_b32 v196, 16, v254
    v_and_b32 v197, 0xffff0000, v254
    v_lshlrev_b32 v198, 16, v255
    v_and_b32 v199, 0xffff0000, v255
    s_waitcnt lgkmcnt(5)
    s_nop 0
    v_cvt_pk_bf16_f32 v208, v152, v153
    v_cvt_pk_bf16_f32 v209, v154, v155
    v_cvt_pk_bf16_f32 v210, v156, v157
    v_cvt_pk_bf16_f32 v211, v158, v159
    v_cvt_pk_bf16_f32 v212, v160, v161
    v_cvt_pk_bf16_f32 v213, v162, v163
    v_cvt_pk_bf16_f32 v214, v164, v165
    v_cvt_pk_bf16_f32 v215, v166, v167
    v_cvt_pk_bf16_f32 v168, v168, v169
    v_cvt_pk_bf16_f32 v169, v170, v171
    v_cvt_pk_bf16_f32 v170, v172, v173
    v_cvt_pk_bf16_f32 v171, v174, v175
    v_cvt_pk_bf16_f32 v172, v176, v177
    v_cvt_pk_bf16_f32 v173, v178, v179
    v_cvt_pk_bf16_f32 v174, v180, v181
    v_cvt_pk_bf16_f32 v175, v182, v183
    v_mov_b32 v3, v11
    s_mov_b32 s55, s11
    s_waitcnt vmcnt(0)
    v_cmp_ne_u32 vcc, s7, v2
    s_nop 0
    s_cmp_eq_u64 vcc, 0
    s_cbranch_scc0 Lslow_97
Lok_95:
    s_add_u32 s66, s41, 8192
    buffer_load_dwordx4 v[24:27], v1, s[84:87], s41 offen offset:0 sc1
    buffer_load_dwordx4 v[28:31], v1, s[84:87], s41 offen offset:1024 sc1
    buffer_load_dwordx4 v[32:35], v1, s[84:87], s41 offen offset:2048 sc1
    buffer_load_dwordx4 v[36:39], v1, s[84:87], s41 offen offset:3072 sc1
    buffer_load_dwordx4 v[40:43], v8, s[84:87], s41 offen offset:0 sc1
    buffer_load_dwordx4 v[44:47], v8, s[84:87], s41 offen offset:1024 sc1
    buffer_load_dwordx4 v[48:51], v8, s[84:87], s41 offen offset:2048 sc1
    buffer_load_dwordx4 v[52:55], v8, s[84:87], s41 offen offset:3072 sc1
    v_and_b32 v11, 7, v0
    s_lshl_b32 s3, s14, 5
    v_lshl_add_u32 v11, v11, 2, s3
    s_add_u32 s12, s96, 65536
    s_add_u32 s11, s41, 65536
    v_mov_b32 v5, 0x3f803f80
    s_lshl_b32 s3, s6, 10
    s_add_u32 s3, s3, 147456
    v_add_u32 v4, s3, v1
    s_waitcnt vmcnt(7)
    v_mfma_f32_32x32x16_bf16 v[120:135], v[88:91], v[24:27], 0
    ds_read_b64_tr_b16 v[116:117], v217 offset:6144
    ds_read_b64_tr_b16 v[118:119], v217 offset:6656
    v_mfma_f32_32x32x16_bf16 v[136:151], v[92:95], v[24:27], 0
    buffer_load_dwordx4 v[56:59], v1, s[84:87], s66 offen offset:0 sc1
    ds_read_b64_tr_b16 v[88:89], v216 offset:8192
    ds_read_b64_tr_b16 v[90:91], v216 offset:8704
    s_waitcnt vmcnt(7)
    v_mfma_f32_32x32x16_bf16 v[120:135], v[96:99], v[28:31], v[120:135]
    ds_read_b64_tr_b16 v[92:93], v217 offset:8192
    ds_read_b64_tr_b16 v[94:95], v217 offset:8704
    v_mfma_f32_32x32x16_bf16 v[136:151], v[100:103], v[28:31], v[136:151]
    buffer_load_dwordx4 v[60:63], v1, s[84:87], s66 offen offset:1024 sc1
    ds_read_b32 v10, v9 offset:32
    ds_read_b64_tr_b16 v[96:97], v216 offset:10240
    ds_read_b64_tr_b16 v[98:99], v216 offset:10752
    s_waitcnt vmcnt(7)
    v_mfma_f32_32x32x16_bf16 v[120:135], v[104:107], v[32:35], v[120:135]
    ds_read_b64_tr_b16 v[100:101], v217 offset:10240
    ds_read_b64_tr_b16 v[102:103], v217 offset:10752
    v_mfma_f32_32x32x16_bf16 v[136:151], v[108:111], v[32:35], v[136:151]
    buffer_load_dwordx4 v[64:67], v1, s[84:87], s66 offen offset:2048 sc1
    ds_read_b64_tr_b16 v[104:105], v216 offset:12288
    ds_read_b64_tr_b16 v[106:107], v216 offset:12800
    s_waitcnt vmcnt(7)
    v_mfma_f32_32x32x16_bf16 v[120:135], v[112:115], v[36:39], v[120:135]
    ds_read_b64_tr_b16 v[108:109], v217 offset:12288
    ds_read_b64_tr_b16 v[110:111], v217 offset:12800
    s_waitcnt lgkmcnt(13)
    v_mfma_f32_32x32x16_bf16 v[136:151], v[116:119], v[36:39], v[136:151]
    buffer_load_dwordx4 v[68:71], v1, s[84:87], s66 offen offset:3072 sc1
    ds_read_b64_tr_b16 v[112:113], v216 offset:14336
    ds_read_b64_tr_b16 v[114:115], v216 offset:14848
    s_waitcnt vmcnt(7) lgkmcnt(13)
    v_mfma_f32_32x32x16_bf16 v[120:135], v[88:91], v[40:43], v[120:135]
    ds_read_b64_tr_b16 v[116:117], v217 offset:14336
    ds_read_b64_tr_b16 v[118:119], v217 offset:14848
    v_mov_b32 v19, 1
    s_mov_b64 exec, s[64:65]
    ds_write_b32 v9, v19 offset:48
    s_mov_b64 exec, -1
    s_waitcnt lgkmcnt(13)
    v_cmp_gt_u32 vcc, 2, v10
    v_mfma_f32_32x32x16_bf16 v[136:151], v[92:95], v[40:43], v[136:151]
    buffer_load_dwordx4 v[72:75], v8, s[84:87], s66 offen offset:0 sc1
    s_cbranch_vccnz Lslow_100
Lfok_98:
    ds_read_b64_tr_b16 v[88:89], v216 offset:32768
    ds_read_b64_tr_b16 v[90:91], v216 offset:33280
    s_waitcnt vmcnt(7) lgkmcnt(13)
    v_mfma_f32_32x32x16_bf16 v[120:135], v[96:99], v[44:47], v[120:135]
    ds_read_b64_tr_b16 v[92:93], v217 offset:32768
    ds_read_b64_tr_b16 v[94:95], v217 offset:33280
    s_waitcnt lgkmcnt(13)
    v_mfma_f32_32x32x16_bf16 v[136:151], v[100:103], v[44:47], v[136:151]
    buffer_load_dwordx4 v[76:79], v8, s[84:87], s66 offen offset:1024 sc1
    ds_read_b64_tr_b16 v[96:97], v216 offset:34816
    ds_read_b64_tr_b16 v[98:99], v216 offset:35328
    s_waitcnt vmcnt(7) lgkmcnt(13)
    v_mfma_f32_32x32x16_bf16 v[120:135], v[104:107], v[48:51], v[120:135]
    ds_read_b64_tr_b16 v[100:101], v217 offset:34816
    ds_read_b64_tr_b16 v[102:103], v217 offset:35328
    s_waitcnt lgkmcnt(13)
    v_mfma_f32_32x32x16_bf16 v[136:151], v[108:111], v[48:51], v[136:151]
    buffer_load_dwordx4 v[80:83], v8, s[84:87], s66 offen offset:2048 sc1
    ds_read_b64_tr_b16 v[104:105], v216 offset:36864
    ds_read_b64_tr_b16 v[106:107], v216 offset:37376
    s_waitcnt vmcnt(7) lgkmcnt(13)
    v_mfma_f32_32x32x16_bf16 v[120:135], v[112:115], v[52:55], v[120:135]
    ds_read_b64_tr_b16 v[108:109], v217 offset:36864
    ds_read_b64_tr_b16 v[110:111], v217 offset:37376
    s_waitcnt lgkmcnt(13)
    v_mfma_f32_32x32x16_bf16 v[136:151], v[116:119], v[52:55], v[136:151]
    buffer_load_dwordx4 v[84:87], v8, s[84:87], s66 offen offset:3072 sc1
    v_mov_b32 v19, 2
    s_mov_b64 exec, s[64:65]
    ds_write_b32 v9, v19 offset:112
    s_mov_b64 exec, -1
    ds_read_b64_tr_b16 v[112:113], v216 offset:38912
    ds_read_b64_tr_b16 v[114:115], v216 offset:39424
    s_waitcnt vmcnt(7) lgkmcnt(13)
    v_mfma_f32_32x32x16_bf16 v[120:135], v[88:91], v[56:59], v[120:135]
    ds_read_b64_tr_b16 v[116:117], v217 offset:38912
    ds_read_b64_tr_b16 v[118:119], v217 offset:39424
    s_waitcnt lgkmcnt(13)
    v_mfma_f32_32x32x16_bf16 v[136:151], v[92:95], v[56:59], v[136:151]
    ds_read_b64_tr_b16 v[88:89], v217 offset:40960
    ds_read_b64_tr_b16 v[90:91], v217 offset:41472
    ds_read_b32 v10, v9 offset:80
    s_waitcnt vmcnt(6) lgkmcnt(14)
    v_mfma_f32_32x32x16_bf16 v[120:135], v[96:99], v[60:63], v[120:135]
    ds_read_b64_tr_b16 v[92:93], v217 offset:43008
    ds_read_b64_tr_b16 v[94:95], v217 offset:43520
    s_waitcnt lgkmcnt(14)
    v_mfma_f32_32x32x16_bf16 v[136:151], v[100:103], v[60:63], v[136:151]
    ds_read_b64_tr_b16 v[96:97], v217 offset:45056
    ds_read_b64_tr_b16 v[98:99], v217 offset:45568
    s_waitcnt vmcnt(5) lgkmcnt(14)
    v_mfma_f32_32x32x16_bf16 v[120:135], v[104:107], v[64:67], v[120:135]
    ds_read_b64_tr_b16 v[100:101], v217 offset:47104
    ds_read_b64_tr_b16 v[102:103], v217 offset:47616
    s_waitcnt lgkmcnt(14)
    v_mfma_f32_32x32x16_bf16 v[136:151], v[108:111], v[64:67], v[136:151]
    ds_read_b64_tr_b16 v[104:105], v216 offset:40960
    ds_read_b64_tr_b16 v[106:107], v216 offset:41472
    s_waitcnt vmcnt(4) lgkmcnt(13)
    v_mfma_f32_32x32x16_bf16 v[120:135], v[112:115], v[68:71], v[120:135]
    ds_read_b64_tr_b16 v[108:109], v216 offset:43008
    ds_read_b64_tr_b16 v[110:111], v216 offset:43520
    s_waitcnt lgkmcnt(10)
    v_cmp_gt_u32 vcc, 1, v10
    s_nop 0
    s_and_b64 vcc, vcc, s[50:51]
    s_cbranch_scc1 Lslow_103
Lfok_101:
    v_mfma_f32_32x32x16_bf16 v[136:151], v[116:119], v[68:71], v[136:151]
    ds_read_b64_tr_b16 v[112:113], v216 offset:45056
    ds_read_b64_tr_b16 v[114:115], v216 offset:45568
    s_waitcnt vmcnt(3)
    v_mfma_f32_32x32x16_bf16 v[136:151], v[88:91], v[72:75], v[136:151]
    ds_read_b64_tr_b16 v[116:117], v216 offset:47104
    ds_read_b64_tr_b16 v[118:119], v216 offset:47616
    v_mov_b32 v19, 2
    s_mov_b64 exec, s[64:65]
    ds_write_b32 v9, v19 offset:48
    s_mov_b64 exec, -1
    s_waitcnt vmcnt(2) lgkmcnt(13)
    v_mfma_f32_32x32x16_bf16 v[136:151], v[92:95], v[76:79], v[136:151]
    s_waitcnt vmcnt(1) lgkmcnt(11)
    v_mfma_f32_32x32x16_bf16 v[136:151], v[96:99], v[80:83], v[136:151]
    s_waitcnt vmcnt(0) lgkmcnt(9)
    v_mfma_f32_32x32x16_bf16 v[136:151], v[100:103], v[84:87], v[136:151]
    s_waitcnt lgkmcnt(7)
    v_mfma_f32_32x32x16_bf16 v[120:135], v[104:107], v[72:75], v[120:135]
    s_waitcnt lgkmcnt(5)
    v_mfma_f32_32x32x16_bf16 v[120:135], v[108:111], v[76:79], v[120:135]
    s_nop 7
    ds_write_b128 v22, v[136:139] offset:0
    ds_write_b128 v22, v[140:143] offset:1024
    s_waitcnt lgkmcnt(5)
    v_mfma_f32_32x32x16_bf16 v[120:135], v[112:115], v[80:83], v[120:135]
    ds_write_b128 v22, v[144:147] offset:2048
    ds_write_b128 v22, v[148:151] offset:3072
    v_mov_b32 v19, 2
    s_mov_b64 exec, s[64:65]
    ds_write_b32 v9, v19 offset:64
    s_mov_b64 exec, -1
    s_waitcnt lgkmcnt(6)
    v_mfma_f32_32x32x16_bf16 v[120:135], v[116:119], v[84:87], v[120:135]
    ds_read_b32 v10, v9 offset:64
    ds_read_b128 v[216:219], v23 offset:0
    ds_read_b128 v[220:223], v23 offset:1024
    ds_read_b128 v[224:227], v23 offset:2048
    ds_read_b128 v[228:231], v23 offset:3072
    s_waitcnt lgkmcnt(4)
    v_cmp_gt_u32 vcc, 2, v10
    s_nop 0
    s_and_b64 vcc, vcc, s[50:51]
    s_cbranch_scc1 Lslow_106
Lfok_104:
    v_mov_b32 v19, 2
    s_mov_b64 exec, s[64:65]
    ds_write_b32 v9, v19 offset:80
    s_mov_b64 exec, -1
    s_waitcnt lgkmcnt(4)
    v_pk_add_f32 v[120:121], v[120:121], v[216:217]
    v_pk_add_f32 v[122:123], v[122:123], v[218:219]
    v_pk_fma_f32 v[184:185], v[120:121], v[232:233], v[184:185]
    v_pk_fma_f32 v[186:187], v[122:123], v[234:235], v[186:187]
    v_cvt_pk_bf16_f32 v200, v184, v185
    v_cvt_pk_bf16_f32 v201, v186, v187
    v_lshlrev_b32 v184, 16, v200
    v_and_b32 v185, 0xffff0000, v200
    v_lshlrev_b32 v186, 16, v201
    v_and_b32 v187, 0xffff0000, v201
    v_pk_mul_f32 v[216:217], v[184:185], v[152:153]
    v_pk_mul_f32 v[218:219], v[186:187], v[154:155]
    v_cvt_pk_bf16_f32 v248, v216, v217
    v_cvt_pk_bf16_f32 v249, v218, v219
    s_waitcnt lgkmcnt(3)
    v_pk_add_f32 v[124:125], v[124:125], v[220:221]
    v_pk_add_f32 v[126:127], v[126:127], v[222:223]
    v_pk_fma_f32 v[188:189], v[124:125], v[236:237], v[188:189]
    v_pk_fma_f32 v[190:191], v[126:127], v[238:239], v[190:191]
    v_cvt_pk_bf16_f32 v202, v188, v189
    v_cvt_pk_bf16_f32 v203, v190, v191
    v_lshlrev_b32 v188, 16, v202
    v_and_b32 v189, 0xffff0000, v202
    v_lshlrev_b32_e64 v190, 16, v203
    v_and_b32 v191, 0xffff0000, v203
    v_pk_mul_f32 v[220:221], v[188:189], v[156:157]
    v_pk_mul_f32 v[222:223], v[190:191], v[158:159]
    v_cvt_pk_bf16_f32 v250, v220, v221
    v_cvt_pk_bf16_f32 v251, v222, v223
    buffer_store_dwordx4 v[248:251], v1, s[72:75], s12 offen
    s_cmp_eq_u32 s78, 0
    s_cbranch_scc0 Lslow_108
Lfs_107:
    s_waitcnt lgkmcnt(2)
    v_pk_add_f32 v[128:129], v[128:129], v[224:225]
    v_pk_add_f32 v[130:131], v[130:131], v[226:227]
    v_pk_fma_f32 v[192:193], v[128:129], v[240:241], v[192:193]
    v_pk_fma_f32 v[194:195], v[130:131], v[242:243], v[194:195]
    v_cvt_pk_bf16_f32 v204, v192, v193
    v_cvt_pk_bf16_f32 v205, v194, v195
    v_lshlrev_b32 v192, 16, v204
    v_and_b32 v193, 0xffff0000, v204
    v_lshlrev_b32_e64 v194, 16, v205
    v_and_b32 v195, 0xffff0000, v205
    v_pk_mul_f32 v[224:225], v[192:193], v[160:161]
    v_pk_mul_f32 v[226:227], v[194:195], v[162:163]
    v_cvt_pk_bf16_f32 v252, v224, v225
    v_cvt_pk_bf16_f32 v253, v226, v227
    s_waitcnt lgkmcnt(1)
    v_pk_add_f32 v[132:133], v[132:133], v[228:229]
    v_pk_add_f32 v[134:135], v[134:135], v[230:231]
    v_pk_fma_f32 v[196:197], v[132:133], v[244:245], v[196:197]
    v_pk_fma_f32 v[198:199], v[134:135], v[246:247], v[198:199]
    v_cvt_pk_bf16_f32 v206, v196, v197
    v_cvt_pk_bf16_f32 v207, v198, v199
    v_lshlrev_b32 v196, 16, v206
    v_and_b32 v197, 0xffff0000, v206
    v_lshlrev_b32_e64 v198, 16, v207
    v_and_b32 v199, 0xffff0000, v207
    v_pk_mul_f32 v[228:229], v[196:197], v[164:165]
    v_pk_mul_f32 v[230:231], v[198:199], v[166:167]
    v_cvt_pk_bf16_f32 v254, v228, v229
    v_cvt_pk_bf16_f32 v255, v230, v231
    buffer_store_dwordx4 v[252:255], v1, s[72:75], s12 offen offset:1024
    s_cmp_eq_u32 s78, 0
    s_cbranch_scc0 Lslow_110
Lfs_109:
    v_dot2_f32_bf16 v216, v200, v5, 0
    v_dot2_f32_bf16 v217, v200, v200, 0
    v_dot2_f32_bf16 v218, v248, v5, 0
    v_dot2_f32_bf16 v220, v248, v248, 0
    v_dot2_f32_bf16 v221, v248, v208, 0
    v_dot2_f32_bf16 v222, v248, v168, 0
    v_dot2_f32_bf16 v216, v201, v5, v216
    v_dot2_f32_bf16 v217, v201, v201, v217
    v_dot2_f32_bf16 v218, v249, v5, v218
    v_dot2_f32_bf16 v220, v249, v249, v220
    v_dot2_f32_bf16 v221, v249, v209, v221
    v_dot2_f32_bf16 v222, v249, v169, v222
    v_dot2_f32_bf16 v216, v202, v5, v216
    v_dot2_f32_bf16 v217, v202, v202, v217
    v_dot2_f32_bf16 v218, v250, v5, v218
    v_dot2_f32_bf16 v220, v250, v250, v220
    v_dot2_f32_bf16 v221, v250, v210, v221
    v_dot2_f32_bf16 v222, v250, v170, v222
    v_dot2_f32_bf16 v216, v203, v5, v216
    v_dot2_f32_bf16 v217, v203, v203, v217
    v_dot2_f32_bf16 v218, v251, v5, v218
    v_dot2_f32_bf16 v220, v251, v251, v220
    v_dot2_f32_bf16 v221, v251, v211, v221
    v_dot2_f32_bf16 v222, v251, v171, v222
    v_dot2_f32_bf16 v216, v204, v5, v216
    v_dot2_f32_bf16 v217, v204, v204, v217
    v_dot2_f32_bf16 v218, v252, v5, v218
    v_dot2_f32_bf16 v220, v252, v252, v220
    v_dot2_f32_bf16 v221, v252, v212, v221
    v_dot2_f32_bf16 v222, v252, v172, v222
    v_dot2_f32_bf16 v216, v205, v5, v216
    v_dot2_f32_bf16 v217, v205, v205, v217
    v_dot2_f32_bf16 v218, v253, v5, v218
    v_dot2_f32_bf16 v220, v253, v253, v220
    v_dot2_f32_bf16 v221, v253, v213, v221
    v_dot2_f32_bf16 v222, v253, v173, v222
    v_dot2_f32_bf16 v216, v206, v5, v216
    v_dot2_f32_bf16 v217, v206, v206, v217
    v_dot2_f32_bf16 v218, v254, v5, v218
    v_dot2_f32_bf16 v220, v254, v254, v220
    v_dot2_f32_bf16 v221, v254, v214, v221
    v_dot2_f32_bf16 v222, v254, v174, v222
    v_dot2_f32_bf16 v216, v207, v5, v216
    v_dot2_f32_bf16 v217, v207, v207, v217
    v_dot2_f32_bf16 v218, v255, v5, v218
    v_dot2_f32_bf16 v220, v255, v255, v220
    v_dot2_f32_bf16 v221, v255, v215, v221
    v_dot2_f32_bf16 v222, v255, v175, v222
    s_nop 0
    v_permlane32_swap_b32 v216, v220
    v_permlane32_swap_b32 v217, v221
    v_permlane32_swap_b32 v218, v222
    v_add_f32 v216, v216, v220
    v_add_f32 v217, v217, v221
    v_add_f32 v218, v218, v222
    ds_write_b128 v4, v[216:219]
    v_mov_b32 v19, 3
    s_mov_b64 exec, s[64:65]
    ds_write_b32 v9, v19 offset:112
    s_mov_b64 exec, -1
    s_waitcnt vmcnt(0)
    buffer_store_dword v6, v7, s[72:75], s97 offen offset:256
    s_cmp_eq_u32 s78, 0
    s_cbranch_scc0 Lslow_112
Lfs_111:
    s_xor_b32 s3, s13, 1
    s_lshl_b32 s8, s3, 15
    v_add_u32 v168, s8, v12
    v_add_u32_e64 v169, s8, v13
    v_xor_b32 v170, 0x8000, v168
    v_xor_b32 v171, 0x8000, v169
    s_lshl_b32 s8, s3, 13
    s_add_u32 s52, s41, s8
    s_xor_b32 s53, s52, 8192
    v_and_b32 v2, 3, v0
    s_lshl_b32 s8, s3, 2
    v_add_u32 v2, s8, v2
    s_lshl_b32 s8, s14, 3
    v_add_u32 v2, s8, v2
    v_lshlrev_b32 v2, 2, v2
    s_lshl_b32 s8, s3, 7
    v_add_u32 v3, s8, v2
    s_lshl_b32 s8, s13, 7
    v_add_u32 v4, s8, v11
    v_and_b32 v5, 8, v0
    v_cmp_eq_u32 vcc, 0, v5
    s_nop 1
    v_cndmask_b32 v174, v3, v4, vcc
    s_add_u32 s54, s40, 319488
    s_mul_i32 s8, s13, 31
    v_xor_b32 v2, s8, v16
    v_cmp_ge_u32 s[94:95], s14, v2
    s_nop 0
    s_not_b64 s[68:69], s[94:95]
    s_lshl_b32 s8, s14, 1
    s_add_u32 s8, s8, s13
    s_lshl_b64 s[56:57], 1, s8
    s_lshl_b32 s8, s8, 9
    s_add_u32 s8, s8, 161792
    v_and_b32_e64 v2, 1, v0
    v_lshl_add_u32 v172, v2, 4, s8
    v_lshl_add_u32 v172, v17, 5, v172
    ds_read_b32 v10, v9 offset:32
    s_waitcnt lgkmcnt(0)
    v_cmp_gt_u32 vcc, 3, v10
    s_cbranch_vccnz Lslow_115
Lfok_113:
    s_nop 0
    ds_read_b64_tr_b16 v[88:89], v14 offset:0
    ds_read_b64_tr_b16 v[90:91], v14 offset:1024
    ds_read_b64_tr_b16 v[92:93], v15 offset:0
    ds_read_b64_tr_b16 v[94:95], v15 offset:1024
    ds_read_b64_tr_b16 v[96:97], v14 offset:2048
    ds_read_b64_tr_b16 v[98:99], v14 offset:3072
    ds_read_b64_tr_b16 v[100:101], v15 offset:2048
    ds_read_b64_tr_b16 v[102:103], v15 offset:3072
    ds_read_b64_tr_b16 v[104:105], v14 offset:4096
    ds_read_b64_tr_b16 v[106:107], v14 offset:5120
    ds_read_b64_tr_b16 v[108:109], v15 offset:4096
    ds_read_b64_tr_b16 v[110:111], v15 offset:5120
    ds_read_b64_tr_b16 v[112:113], v14 offset:6144
    ds_read_b64_tr_b16 v[114:115], v14 offset:7168
    s_movk_i32 s0, 20000
Lspin_117:
    buffer_load_dword v2, v11, s[84:87], s98 offen offset:256 sc1
    s_sub_u32 s0, s0, 1
    s_cbranch_scc1 Lok_116
    s_waitcnt vmcnt(0)
    v_cmp_ne_u32 vcc, s7, v2
    s_nop 0
    s_cmp_eq_u64 vcc, 0
    s_cbranch_scc0 Lspin_117
Lok_116:
    s_add_u32 s66, s11, 8192
    buffer_load_dwordx4 v[24:27], v1, s[84:87], s11 offen offset:0 sc1
    buffer_load_dwordx4 v[28:31], v1, s[84:87], s11 offen offset:1024 sc1
    buffer_load_dwordx4 v[32:35], v1, s[84:87], s11 offen offset:2048 sc1
    buffer_load_dwordx4 v[36:39], v1, s[84:87], s11 offen offset:3072 sc1
    buffer_load_dwordx4 v[40:43], v8, s[84:87], s11 offen offset:0 sc1
    buffer_load_dwordx4 v[44:47], v8, s[84:87], s11 offen offset:1024 sc1
    buffer_load_dwordx4 v[48:51], v8, s[84:87], s11 offen offset:2048 sc1
    buffer_load_dwordx4 v[52:55], v8, s[84:87], s11 offen offset:3072 sc1
    s_lshr_b32 s3, s5, 2
    s_add_u32 s3, s3, 1
    s_sub_u32 s8, 0, s3
    s_bitcmp1_b32 s5, 1
    s_cselect_b32 s3, s8, s3
    s_lshl_b32 s8, s13, 5
    s_add_u32 s3, s3, s8
    v_add_u32 v2, s3, v16
    v_and_b32 v3, 32, v2
    v_lshlrev_b32 v3, 10, v3
    v_and_b32_e64 v4, 31, v2
    v_lshl_add_u32 v3, v4, 4, v3
    v_lshl_add_u32 v3, v17, 9, v3
    v_mov_b32 v4, 0x7fffffff
    v_cmp_gt_u32 vcc, 64, v2
    s_nop 1
    v_cndmask_b32 v200, v4, v3, vcc
    s_not_b64 s[92:93], vcc
    v_and_b32 v4, 1, v2
    v_lshlrev_b32 v4, 4, v4
    v_lshl_add_u32 v4, v17, 5, v4
    s_lshl_b32 s3, s14, 7
    s_add_u32 s3, s3, 153600
    v_add_u32 v201, s3, v4
    v_and_b32 v202, 15, v0
    v_lshlrev_b32 v202, 2, v202
    s_xor_b32 s100, s98, 128
    s_lshl_b32 s3, s5, 12
    s_lshl_b32 s8, s14, 11
    s_add_u32 s3, s3, s8
    s_add_u32 s12, s3, s40
    s_lshl_b32 s3, s14, 10
    s_add_u32 s3, s3, 161792
    v_add_u32 v232, s3, v1
    s_lshl_b32 s3, s13, 11
    s_add_u32 s3, s3, 147456
    v_add_u32 v233, s3, v1
    s_waitcnt vmcnt(7) lgkmcnt(12)
    v_mfma_f32_32x32x16_bf16 v[120:135], v[88:91], v[24:27], 0
    ds_read_b64_tr_b16 v[116:117], v15 offset:6144
    ds_read_b64_tr_b16 v[118:119], v15 offset:7168
    s_waitcnt lgkmcnt(12)
    v_mfma_f32_32x32x16_bf16 v[136:151], v[92:95], v[24:27], 0
    buffer_load_dwordx4 v[56:59], v1, s[84:87], s66 offen offset:0 sc1
    ds_read_b64_tr_b16 v[88:89], v14 offset:8192
    ds_read_b64_tr_b16 v[90:91], v14 offset:9216
    s_waitcnt vmcnt(7) lgkmcnt(12)
    v_mfma_f32_32x32x16_bf16 v[120:135], v[96:99], v[28:31], v[120:135]
    ds_read_b64_tr_b16 v[92:93], v15 offset:8192
    ds_read_b64_tr_b16 v[94:95], v15 offset:9216
    s_waitcnt lgkmcnt(12)
    v_mfma_f32_32x32x16_bf16 v[136:151], v[100:103], v[28:31], v[136:151]
    buffer_load_dwordx4 v[60:63], v1, s[84:87], s66 offen offset:1024 sc1
    ds_read_b32 v10, v9 offset:32
    ds_read_b64_tr_b16 v[96:97], v14 offset:10240
    ds_read_b64_tr_b16 v[98:99], v14 offset:11264
    s_waitcnt vmcnt(7) lgkmcnt(13)
    v_mfma_f32_32x32x16_bf16 v[120:135], v[104:107], v[32:35], v[120:135]
    ds_read_b64_tr_b16 v[100:101], v15 offset:10240
    ds_read_b64_tr_b16 v[102:103], v15 offset:11264
    s_waitcnt lgkmcnt(13)
    v_mfma_f32_32x32x16_bf16 v[136:151], v[108:111], v[32:35], v[136:151]
    buffer_load_dwordx4 v[64:67], v1, s[84:87], s66 offen offset:2048 sc1
    ds_read_b64_tr_b16 v[104:105], v14 offset:12288
    ds_read_b64_tr_b16 v[106:107], v14 offset:13312
    s_waitcnt vmcnt(7) lgkmcnt(13)
    v_mfma_f32_32x32x16_bf16 v[120:135], v[112:115], v[36:39], v[120:135]
    ds_read_b64_tr_b16 v[108:109], v15 offset:12288
    ds_read_b64_tr_b16 v[110:111], v15 offset:13312
    s_waitcnt lgkmcnt(13)
    v_mfma_f32_32x32x16_bf16 v[136:151], v[116:119], v[36:39], v[136:151]
    buffer_load_dwordx4 v[68:71], v1, s[84:87], s66 offen offset:3072 sc1
    ds_read_b64_tr_b16 v[112:113], v14 offset:14336
    ds_read_b64_tr_b16 v[114:115], v14 offset:15360
    s_waitcnt vmcnt(7) lgkmcnt(13)
    v_mfma_f32_32x32x16_bf16 v[120:135], v[88:91], v[40:43], v[120:135]
    ds_read_b64_tr_b16 v[116:117], v15 offset:14336
    ds_read_b64_tr_b16 v[118:119], v15 offset:15360
    v_mov_b32 v19, 3
    s_mov_b64 exec, s[64:65]
    ds_write_b32 v9, v19 offset:48
    s_mov_b64 exec, -1
    s_waitcnt lgkmcnt(13)
    v_cmp_gt_u32 vcc, 4, v10
    v_mfma_f32_32x32x16_bf16 v[136:151], v[92:95], v[40:43], v[136:151]
    buffer_load_dwordx4 v[72:75], v8, s[84:87], s66 offen offset:0 sc1
    s_cbranch_vccnz Lslow_120
Lfok_118:
    ds_read_b64_tr_b16 v[88:89], v14 offset:32768
    ds_read_b64_tr_b16 v[90:91], v14 offset:33792
    s_waitcnt vmcnt(7) lgkmcnt(13)
    v_mfma_f32_32x32x16_bf16 v[120:135], v[96:99], v[44:47], v[120:135]
    ds_read_b64_tr_b16 v[92:93], v15 offset:32768
    ds_read_b64_tr_b16 v[94:95], v15 offset:33792
    s_waitcnt lgkmcnt(13)
    v_mfma_f32_32x32x16_bf16 v[136:151], v[100:103], v[44:47], v[136:151]
    buffer_load_dwordx4 v[76:79], v8, s[84:87], s66 offen offset:1024 sc1
    ds_read_b64_tr_b16 v[96:97], v14 offset:34816
    ds_read_b64_tr_b16 v[98:99], v14 offset:35840
    s_waitcnt vmcnt(7) lgkmcnt(13)
    v_mfma_f32_32x32x16_bf16 v[120:135], v[104:107], v[48:51], v[120:135]
    ds_read_b64_tr_b16 v[100:101], v15 offset:34816
    ds_read_b64_tr_b16 v[102:103], v15 offset:35840
    s_waitcnt lgkmcnt(13)
    v_mfma_f32_32x32x16_bf16 v[136:151], v[108:111], v[48:51], v[136:151]
    buffer_load_dwordx4 v[80:83], v8, s[84:87], s66 offen offset:2048 sc1
    ds_read_b64_tr_b16 v[104:105], v14 offset:36864
    ds_read_b64_tr_b16 v[106:107], v14 offset:37888
    s_waitcnt vmcnt(7) lgkmcnt(13)
    v_mfma_f32_32x32x16_bf16 v[120:135], v[112:115], v[52:55], v[120:135]
    ds_read_b64_tr_b16 v[108:109], v15 offset:36864
    ds_read_b64_tr_b16 v[110:111], v15 offset:37888
    s_waitcnt lgkmcnt(13)
    v_mfma_f32_32x32x16_bf16 v[136:151], v[116:119], v[52:55], v[136:151]
    buffer_load_dwordx4 v[84:87], v8, s[84:87], s66 offen offset:3072 sc1
    ds_read_b64_tr_b16 v[112:113], v14 offset:38912
    ds_read_b64_tr_b16 v[114:115], v14 offset:39936
    s_waitcnt vmcnt(7) lgkmcnt(12)
    v_mfma_f32_32x32x16_bf16 v[120:135], v[88:91], v[56:59], v[120:135]
    ds_read_b64_tr_b16 v[116:117], v15 offset:38912
    ds_read_b64_tr_b16 v[118:119], v15 offset:39936
    s_waitcnt lgkmcnt(12)
    v_mfma_f32_32x32x16_bf16 v[136:151], v[92:95], v[56:59], v[136:151]
    buffer_load_dword v203, v202, s[84:87], s100 offen offset:256 sc1
    s_add_u32 s3, s96, 196608
    v_lshlrev_b32 v3, 3, v1
    s_mov_b64 exec, 0xffff
    buffer_load_dword v3, v3, s[84:87], s3 offen sc1
    s_mov_b64 exec, -1
    v_mov_b32 v19, 4
    s_mov_b64 exec, s[64:65]
    ds_write_b32 v9, v19 offset:112
    s_mov_b64 exec, -1
    ds_read_b64_tr_b16 v[88:89], v15 offset:40960
    ds_read_b64_tr_b16 v[90:91], v15 offset:41984
    ds_read_b32 v10, v9 offset:80
    s_waitcnt vmcnt(8) lgkmcnt(14)
    v_mfma_f32_32x32x16_bf16 v[120:135], v[96:99], v[60:63], v[120:135]
    ds_read_b64_tr_b16 v[92:93], v15 offset:43008
    ds_read_b64_tr_b16 v[94:95], v15 offset:44032
    s_waitcnt lgkmcnt(14)
    v_mfma_f32_32x32x16_bf16 v[136:151], v[100:103], v[60:63], v[136:151]
    ds_read_b64_tr_b16 v[96:97], v15 offset:45056
    ds_read_b64_tr_b16 v[98:99], v15 offset:46080
    s_waitcnt vmcnt(7) lgkmcnt(14)
    v_mfma_f32_32x32x16_bf16 v[120:135], v[104:107], v[64:67], v[120:135]
    ds_read_b64_tr_b16 v[100:101], v15 offset:47104
    ds_read_b64_tr_b16 v[102:103], v15 offset:48128
    ds_read_b32 v234, v9 offset:96
    s_waitcnt lgkmcnt(14)
    v_mfma_f32_32x32x16_bf16 v[136:151], v[108:111], v[64:67], v[136:151]
    ds_read_b64_tr_b16 v[104:105], v14 offset:40960
    ds_read_b64_tr_b16 v[106:107], v14 offset:41984
    s_waitcnt vmcnt(6) lgkmcnt(14)
    v_mfma_f32_32x32x16_bf16 v[120:135], v[112:115], v[68:71], v[120:135]
    ds_read_b64_tr_b16 v[108:109], v14 offset:43008
    ds_read_b64_tr_b16 v[110:111], v14 offset:44032
    s_waitcnt lgkmcnt(11)
    v_cmp_gt_u32 vcc, 2, v10
    s_nop 0
    s_and_b64 vcc, vcc, s[50:51]
    s_cbranch_scc1 Lslow_123
Lfok_121:
    s_waitcnt lgkmcnt(4)
    v_cmp_gt_u32 vcc, 4, v234
    s_cbranch_vccnz Lslow_126
Lfok_124:
    ds_read_b128 v[152:155], v232
    ds_read_b128 v[156:159], v233
    ds_read_b128 v[248:251], v21
    v_mfma_f32_32x32x16_bf16 v[136:151], v[116:119], v[68:71], v[136:151]
    ds_read_b64_tr_b16 v[112:113], v14 offset:45056
    ds_read_b64_tr_b16 v[114:115], v14 offset:46080
    s_waitcnt vmcnt(5)
    v_mfma_f32_32x32x16_bf16 v[136:151], v[88:91], v[72:75], v[136:151]
    ds_read_b64_tr_b16 v[116:117], v14 offset:47104
    ds_read_b64_tr_b16 v[118:119], v14 offset:48128
    v_mov_b32 v19, 4
    s_mov_b64 exec, s[64:65]
    ds_write_b32 v9, v19 offset:48
    s_mov_b64 exec, -1
    s_waitcnt vmcnt(4)
    v_mfma_f32_32x32x16_bf16 v[136:151], v[92:95], v[76:79], v[136:151]
    s_waitcnt vmcnt(3)
    v_mfma_f32_32x32x16_bf16 v[136:151], v[96:99], v[80:83], v[136:151]
    s_waitcnt vmcnt(2)
    v_mfma_f32_32x32x16_bf16 v[136:151], v[100:103], v[84:87], v[136:151]
    s_waitcnt lgkmcnt(10)
    v_mfma_f32_32x32x16_bf16 v[120:135], v[104:107], v[72:75], v[120:135]
    s_waitcnt lgkmcnt(8)
    v_mfma_f32_32x32x16_bf16 v[120:135], v[108:111], v[76:79], v[120:135]
    s_nop 7
    ds_write_b128 v22, v[136:139] offset:0
    ds_write_b128 v22, v[140:143] offset:1024
    s_waitcnt lgkmcnt(5)
    v_mfma_f32_32x32x16_bf16 v[120:135], v[112:115], v[80:83], v[120:135]
    ds_write_b128 v22, v[144:147] offset:2048
    ds_write_b128 v22, v[148:151] offset:3072
    v_mov_b32 v19, 3
    s_mov_b64 exec, s[64:65]
    ds_write_b32 v9, v19 offset:64
    s_mov_b64 exec, -1
    s_waitcnt lgkmcnt(6)
    v_mfma_f32_32x32x16_bf16 v[120:135], v[116:119], v[84:87], v[120:135]
    v_mfma_f32_32x32x16_bf16 v[120:135], v[152:155], v[156:159], v[120:135]
    v_mov_b32 v2, v248
    v_mov_b32 v4, v249
    v_mov_b32 v5, v250
    s_waitcnt vmcnt(1)
    v_cmp_ne_u32 vcc, s7, v203
    s_nop 0
    s_cmp_eq_u64 vcc, 0
    s_cbranch_scc0 Lslow_129
Lok_127:
    ds_read_b32 v10, v9 offset:64
    ds_read_b128 v[216:219], v23 offset:0
    ds_read_b128 v[220:223], v23 offset:1024
    ds_read_b128 v[224:227], v23 offset:2048
    ds_read_b128 v[228:231], v23 offset:3072
    s_waitcnt lgkmcnt(4)
    v_cmp_gt_u32 vcc, 3, v10
    s_nop 0
    s_and_b64 vcc, vcc, s[50:51]
    s_cbranch_scc1 Lslow_132
Lfok_130:
    v_mov_b32 v19, 3
    s_mov_b64 exec, s[64:65]
    ds_write_b32 v9, v19 offset:80
    s_mov_b64 exec, -1
    s_waitcnt lgkmcnt(4)
    v_pk_add_f32 v[120:121], v[120:121], v[216:217]
    v_pk_add_f32 v[122:123], v[122:123], v[218:219]
    s_waitcnt lgkmcnt(3)
    v_pk_add_f32 v[124:125], v[124:125], v[220:221]
    v_pk_add_f32 v[126:127], v[126:127], v[222:223]
    s_waitcnt lgkmcnt(2)
    v_pk_add_f32 v[128:129], v[128:129], v[224:225]
    v_pk_add_f32 v[130:131], v[130:131], v[226:227]
    s_waitcnt lgkmcnt(1)
    v_pk_add_f32 v[132:133], v[132:133], v[228:229]
    v_pk_add_f32 v[134:135], v[134:135], v[230:231]
    v_pk_mul_f32 v[120:121], v[120:121], v[2:3] op_sel_hi:[1,0]
    v_pk_mul_f32 v[122:123], v[122:123], v[2:3] op_sel_hi:[1,0]
    v_pk_mul_f32 v[124:125], v[124:125], v[2:3] op_sel_hi:[1,0]
    v_pk_mul_f32 v[126:127], v[126:127], v[2:3] op_sel_hi:[1,0]
    v_pk_mul_f32 v[128:129], v[128:129], v[2:3] op_sel_hi:[1,0]
    v_pk_mul_f32 v[130:131], v[130:131], v[2:3] op_sel_hi:[1,0]
    v_pk_mul_f32 v[132:133], v[132:133], v[2:3] op_sel_hi:[1,0]
    v_pk_mul_f32 v[134:135], v[134:135], v[2:3] op_sel_hi:[1,0]
    ds_read_b128 v[152:155], v18 offset:9728
    ds_read_b128 v[156:159], v18 offset:9760
    ds_read_b128 v[160:163], v18 offset:9792
    ds_read_b128 v[164:167], v18 offset:9824
    ds_read_b128 v[232:235], v18 offset:9472
    ds_read_b128 v[236:239], v18 offset:9504
    ds_read_b128 v[240:243], v18 offset:9536
    ds_read_b128 v[244:247], v18 offset:9568
    v_pk_mul_f32 v[216:217], v[120:121], v[120:121]
    v_pk_mul_f32 v[218:219], v[122:123], v[122:123]
    v_pk_mul_f32 v[220:221], v[124:125], v[124:125]
    v_pk_mul_f32 v[222:223], v[126:127], v[126:127]
    v_pk_mul_f32 v[224:225], v[128:129], v[128:129]
    v_pk_mul_f32 v[226:227], v[130:131], v[130:131]
    v_pk_mul_f32 v[228:229], v[132:133], v[132:133]
    v_pk_mul_f32 v[230:231], v[134:135], v[134:135]
    v_pk_fma_f32 v[216:217], v[216:217], s[90:91], v[20:21] op_sel_hi:[1,1,0]
    v_pk_fma_f32 v[218:219], v[218:219], s[90:91], v[20:21] op_sel_hi:[1,1,0]
    v_pk_fma_f32 v[220:221], v[220:221], s[90:91], v[20:21] op_sel_hi:[1,1,0]
    v_pk_fma_f32 v[222:223], v[222:223], s[90:91], v[20:21] op_sel_hi:[1,1,0]
    v_pk_fma_f32 v[224:225], v[224:225], s[90:91], v[20:21] op_sel_hi:[1,1,0]
    v_pk_fma_f32 v[226:227], v[226:227], s[90:91], v[20:21] op_sel_hi:[1,1,0]
    v_pk_fma_f32 v[228:229], v[228:229], s[90:91], v[20:21] op_sel_hi:[1,1,0]
    v_pk_fma_f32 v[230:231], v[230:231], s[90:91], v[20:21] op_sel_hi:[1,1,0]
    v_pk_mul_f32 v[216:217], v[216:217], v[120:121]
    v_pk_mul_f32 v[218:219], v[218:219], v[122:123]
    v_pk_mul_f32 v[220:221], v[220:221], v[124:125]
    v_pk_mul_f32 v[222:223], v[222:223], v[126:127]
    v_pk_mul_f32 v[224:225], v[224:225], v[128:129]
    v_pk_mul_f32 v[226:227], v[226:227], v[130:131]
    v_pk_mul_f32 v[228:229], v[228:229], v[132:133]
    v_pk_mul_f32 v[230:231], v[230:231], v[134:135]
    v_exp_f32 v216, v216
    v_exp_f32 v217, v217
    v_exp_f32 v218, v218
    v_exp_f32 v219, v219
    v_exp_f32 v220, v220
    v_exp_f32 v221, v221
    v_exp_f32 v222, v222
    v_exp_f32 v223, v223
    v_exp_f32 v224, v224
    v_exp_f32 v225, v225
    v_exp_f32 v226, v226
    v_exp_f32 v227, v227
    v_exp_f32 v228, v228
    v_exp_f32 v229, v229
    v_exp_f32 v230, v230
    v_exp_f32 v231, v231
    v_pk_add_f32 v[216:217], v[216:217], 1.0 op_sel_hi:[1,0]
    v_pk_add_f32 v[218:219], v[218:219], 1.0 op_sel_hi:[1,0]
    v_pk_add_f32 v[220:221], v[220:221], 1.0 op_sel_hi:[1,0]
    v_pk_add_f32 v[222:223], v[222:223], 1.0 op_sel_hi:[1,0]
    v_pk_add_f32 v[224:225], v[224:225], 1.0 op_sel_hi:[1,0]
    v_pk_add_f32 v[226:227], v[226:227], 1.0 op_sel_hi:[1,0]
    v_pk_add_f32 v[228:229], v[228:229], 1.0 op_sel_hi:[1,0]
    v_pk_add_f32 v[230:231], v[230:231], 1.0 op_sel_hi:[1,0]
    v_rcp_f32 v216, v216
    v_rcp_f32 v217, v217
    v_rcp_f32 v218, v218
    v_rcp_f32 v219, v219
    v_rcp_f32 v220, v220
    v_rcp_f32 v221, v221
    v_rcp_f32 v222, v222
    v_rcp_f32 v223, v223
    v_rcp_f32 v224, v224
    v_rcp_f32 v225, v225
    v_rcp_f32 v226, v226
    v_rcp_f32 v227, v227
    v_rcp_f32 v228, v228
    v_rcp_f32 v229, v229
    v_rcp_f32 v230, v230
    v_rcp_f32 v231, v231
    v_pk_mul_f32 v[216:217], v[216:217], v[120:121]
    v_pk_mul_f32 v[218:219], v[218:219], v[122:123]
    v_pk_mul_f32 v[220:221], v[220:221], v[124:125]
    v_pk_mul_f32 v[222:223], v[222:223], v[126:127]
    v_pk_mul_f32 v[224:225], v[224:225], v[128:129]
    v_pk_mul_f32 v[226:227], v[226:227], v[130:131]
    v_pk_mul_f32 v[228:229], v[228:229], v[132:133]
    v_pk_mul_f32 v[230:231], v[230:231], v[134:135]
    v_cvt_pk_bf16_f32 v248, v216, v217
    v_cvt_pk_bf16_f32 v249, v218, v219
    v_cvt_pk_bf16_f32 v250, v220, v221
    v_cvt_pk_bf16_f32 v251, v222, v223
    v_cvt_pk_bf16_f32 v252, v224, v225
    v_cvt_pk_bf16_f32 v253, v226, v227
    v_cvt_pk_bf16_f32 v254, v228, v229
    v_cvt_pk_bf16_f32 v255, v230, v231
    buffer_store_dwordx4 v[248:251], v200, s[72:75], s12 offen
    buffer_store_dwordx4 v[252:255], v200, s[72:75], s12 offen offset:1024
    s_cmp_eq_u32 s78, 0
    s_cbranch_scc0 Lslow_134
Lfs_133:
    s_cmp_eq_u64 s[92:93], 0
    s_cbranch_scc1 Lnh_135
    s_mov_b64 exec, s[92:93]
    ds_write_b128 v201, v[248:251]
    ds_write_b128 v201, v[252:255] offset:64
    s_mov_b64 exec, -1
Lnh_135:
    v_mov_b32 v19, 5
    s_mov_b64 exec, s[64:65]
    ds_write_b32 v9, v19 offset:112
    s_mov_b64 exec, -1
    s_waitcnt lgkmcnt(1)
    v_pk_add_f32 v[200:201], v[184:185], v[4:5] op_sel_hi:[1,0] neg_lo:[0,1] neg_hi:[0,1]
    v_pk_mul_f32 v[200:201], v[200:201], v[4:5] op_sel:[0,1] op_sel_hi:[1,1]
    v_pk_fma_f32 v[200:201], v[200:201], v[152:153], v[232:233]
    v_pk_add_f32 v[202:203], v[186:187], v[4:5] op_sel_hi:[1,0] neg_lo:[0,1] neg_hi:[0,1]
    v_pk_mul_f32 v[202:203], v[202:203], v[4:5] op_sel:[0,1] op_sel_hi:[1,1]
    v_pk_fma_f32 v[202:203], v[202:203], v[154:155], v[234:235]
    v_pk_add_f32 v[204:205], v[188:189], v[4:5] op_sel_hi:[1,0] neg_lo:[0,1] neg_hi:[0,1]
    v_pk_mul_f32 v[204:205], v[204:205], v[4:5] op_sel:[0,1] op_sel_hi:[1,1]
    v_pk_fma_f32 v[204:205], v[204:205], v[156:157], v[236:237]
    v_pk_add_f32 v[206:207], v[190:191], v[4:5] op_sel_hi:[1,0] neg_lo:[0,1] neg_hi:[0,1]
    v_pk_mul_f32 v[206:207], v[206:207], v[4:5] op_sel:[0,1] op_sel_hi:[1,1]
    v_pk_fma_f32 v[206:207], v[206:207], v[158:159], v[238:239]
    v_pk_add_f32 v[208:209], v[192:193], v[4:5] op_sel_hi:[1,0] neg_lo:[0,1] neg_hi:[0,1]
    v_pk_mul_f32 v[208:209], v[208:209], v[4:5] op_sel:[0,1] op_sel_hi:[1,1]
    v_pk_fma_f32 v[208:209], v[208:209], v[160:161], v[240:241]
    v_pk_add_f32 v[210:211], v[194:195], v[4:5] op_sel_hi:[1,0] neg_lo:[0,1] neg_hi:[0,1]
    v_pk_mul_f32 v[210:211], v[210:211], v[4:5] op_sel:[0,1] op_sel_hi:[1,1]
    v_pk_fma_f32 v[210:211], v[210:211], v[162:163], v[242:243]
    v_pk_add_f32 v[212:213], v[196:197], v[4:5] op_sel_hi:[1,0] neg_lo:[0,1] neg_hi:[0,1]
    v_pk_mul_f32 v[212:213], v[212:213], v[4:5] op_sel:[0,1] op_sel_hi:[1,1]
    v_pk_fma_f32 v[212:213], v[212:213], v[164:165], v[244:245]
    v_pk_add_f32 v[214:215], v[198:199], v[4:5] op_sel_hi:[1,0] neg_lo:[0,1] neg_hi:[0,1]
    v_pk_mul_f32 v[214:215], v[214:215], v[4:5] op_sel:[0,1] op_sel_hi:[1,1]
    v_pk_fma_f32 v[214:215], v[214:215], v[166:167], v[246:247]
    v_cvt_pk_bf16_f32 v2, v200, v201
    v_lshlrev_b32_e64 v200, 16, v2
    v_and_b32 v201, 0xffff0000, v2
    v_cvt_pk_bf16_f32 v2, v202, v203
    v_lshlrev_b32_e64 v202, 16, v2
    v_and_b32 v203, 0xffff0000, v2
    v_cvt_pk_bf16_f32 v2, v204, v205
    v_lshlrev_b32_e64 v204, 16, v2
    v_and_b32 v205, 0xffff0000, v2
    v_cvt_pk_bf16_f32 v2, v206, v207
    v_lshlrev_b32_e64 v206, 16, v2
    v_and_b32 v207, 0xffff0000, v2
    v_cvt_pk_bf16_f32 v2, v208, v209
    v_lshlrev_b32_e64 v208, 16, v2
    v_and_b32 v209, 0xffff0000, v2
    v_cvt_pk_bf16_f32 v2, v210, v211
    v_lshlrev_b32_e64 v210, 16, v2
    v_and_b32 v211, 0xffff0000, v2
    v_cvt_pk_bf16_f32 v2, v212, v213
    v_lshlrev_b32_e64 v212, 16, v2
    v_and_b32 v213, 0xffff0000, v2
    v_cvt_pk_bf16_f32 v2, v214, v215
    v_lshlrev_b32 v214, 16, v2
    v_and_b32 v215, 0xffff0000, v2
    s_waitcnt vmcnt(0)
    buffer_store_dword v6, v7, s[72:75], s97 offen offset:512
    s_cmp_eq_u32 s78, 0
    s_cbranch_scc0 Lslow_137
Lfs_136:
    ds_read_b32 v10, v9 offset:32
    s_waitcnt lgkmcnt(0)
    v_cmp_gt_u32 vcc, 6, v10
    s_cbranch_vccnz Lslow_140
Lfok_138:
    s_nop 0
    ds_read_b64_tr_b16 v[88:89], v168 offset:0
    ds_read_b64_tr_b16 v[90:91], v168 offset:1024
    ds_read_b64_tr_b16 v[92:93], v169 offset:0
    ds_read_b64_tr_b16 v[94:95], v169 offset:1024
    ds_read_b64_tr_b16 v[96:97], v168 offset:2048
    ds_read_b64_tr_b16 v[98:99], v168 offset:3072
    ds_read_b64_tr_b16 v[100:101], v169 offset:2048
    ds_read_b64_tr_b16 v[102:103], v169 offset:3072
    ds_read_b64_tr_b16 v[104:105], v168 offset:4096
    ds_read_b64_tr_b16 v[106:107], v168 offset:5120
    ds_read_b64_tr_b16 v[108:109], v169 offset:4096
    ds_read_b64_tr_b16 v[110:111], v169 offset:5120
    ds_read_b64_tr_b16 v[112:113], v168 offset:6144
    ds_read_b64_tr_b16 v[114:115], v168 offset:7168
    s_movk_i32 s0, 20000
Lspin_142:
    buffer_load_dword v2, v174, s[84:87], s54 offen offset:512 sc1
    s_sub_u32 s0, s0, 1
    s_cbranch_scc1 Lok_141
    s_waitcnt vmcnt(0)
    v_cmp_ne_u32 vcc, s7, v2
    s_nop 0
    s_cmp_eq_u64 vcc, 0
    s_cbranch_scc0 Lspin_142
Lok_141:
    buffer_load_dwordx4 v[24:27], v1, s[84:87], s52 offen offset:0 sc1
    buffer_load_dwordx4 v[28:31], v1, s[84:87], s52 offen offset:1024 sc1
    buffer_load_dwordx4 v[32:35], v1, s[84:87], s52 offen offset:2048 sc1
    buffer_load_dwordx4 v[36:39], v1, s[84:87], s52 offen offset:3072 sc1
    buffer_load_dwordx4 v[40:43], v8, s[84:87], s52 offen offset:0 sc1
    buffer_load_dwordx4 v[44:47], v8, s[84:87], s52 offen offset:1024 sc1
    buffer_load_dwordx4 v[48:51], v8, s[84:87], s52 offen offset:2048 sc1
    buffer_load_dwordx4 v[52:55], v8, s[84:87], s52 offen offset:3072 sc1
    s_waitcnt vmcnt(7) lgkmcnt(12)
    v_mfma_f32_32x32x16_bf16 v[120:135], v[88:91], v[24:27], 0
    ds_read_b64_tr_b16 v[116:117], v169 offset:6144
    ds_read_b64_tr_b16 v[118:119], v169 offset:7168
    s_waitcnt lgkmcnt(12)
    v_mfma_f32_32x32x16_bf16 v[136:151], v[92:95], v[24:27], 0
    s_mov_b64 exec, s[68:69]
    buffer_load_dwordx4 v[56:59], v1, s[84:87], s53 offen offset:0 sc1
    s_mov_b64 exec, -1
    ds_read_b64_tr_b16 v[88:89], v168 offset:8192
    ds_read_b64_tr_b16 v[90:91], v168 offset:9216
    s_waitcnt vmcnt(7) lgkmcnt(12)
    v_mfma_f32_32x32x16_bf16 v[120:135], v[96:99], v[28:31], v[120:135]
    ds_read_b64_tr_b16 v[92:93], v169 offset:8192
    ds_read_b64_tr_b16 v[94:95], v169 offset:9216
    s_waitcnt lgkmcnt(12)
    v_mfma_f32_32x32x16_bf16 v[136:151], v[100:103], v[28:31], v[136:151]
    s_mov_b64 exec, s[68:69]
    buffer_load_dwordx4 v[60:63], v1, s[84:87], s53 offen offset:1024 sc1
    s_mov_b64 exec, -1
    ds_read_b64_tr_b16 v[96:97], v168 offset:10240
    ds_read_b64_tr_b16 v[98:99], v168 offset:11264
    s_waitcnt vmcnt(7) lgkmcnt(12)
    v_mfma_f32_32x32x16_bf16 v[120:135], v[104:107], v[32:35], v[120:135]
    ds_read_b64_tr_b16 v[100:101], v169 offset:10240
    ds_read_b64_tr_b16 v[102:103], v169 offset:11264
    s_waitcnt lgkmcnt(12)
    v_mfma_f32_32x32x16_bf16 v[136:151], v[108:111], v[32:35], v[136:151]
    s_mov_b64 exec, s[68:69]
    buffer_load_dwordx4 v[64:67], v1, s[84:87], s53 offen offset:2048 sc1
    s_mov_b64 exec, -1
    ds_read_b64_tr_b16 v[104:105], v168 offset:12288
    ds_read_b64_tr_b16 v[106:107], v168 offset:13312
    s_waitcnt vmcnt(7) lgkmcnt(12)
    v_mfma_f32_32x32x16_bf16 v[120:135], v[112:115], v[36:39], v[120:135]
    ds_read_b64_tr_b16 v[108:109], v169 offset:12288
    ds_read_b64_tr_b16 v[110:111], v169 offset:13312
    s_waitcnt lgkmcnt(12)
    v_mfma_f32_32x32x16_bf16 v[136:151], v[116:119], v[36:39], v[136:151]
    s_mov_b64 exec, s[68:69]
    buffer_load_dwordx4 v[68:71], v1, s[84:87], s53 offen offset:3072 sc1
    s_mov_b64 exec, -1
    ds_read_b64_tr_b16 v[112:113], v168 offset:14336
    ds_read_b64_tr_b16 v[114:115], v168 offset:15360
    s_waitcnt vmcnt(7) lgkmcnt(12)
    v_mfma_f32_32x32x16_bf16 v[120:135], v[88:91], v[40:43], v[120:135]
    ds_read_b64_tr_b16 v[116:117], v169 offset:14336
    ds_read_b64_tr_b16 v[118:119], v169 offset:15360
    ds_read_b32 v10, v9 offset:96
    s_waitcnt lgkmcnt(13)
    v_mfma_f32_32x32x16_bf16 v[136:151], v[92:95], v[40:43], v[136:151]
    s_mov_b64 exec, s[68:69]
    buffer_load_dwordx4 v[72:75], v8, s[84:87], s53 offen offset:0 sc1
    s_mov_b64 exec, -1
    ds_read_b64_tr_b16 v[88:89], v170 offset:0
    ds_read_b64_tr_b16 v[90:91], v170 offset:1024
    s_waitcnt vmcnt(7) lgkmcnt(13)
    v_mfma_f32_32x32x16_bf16 v[120:135], v[96:99], v[44:47], v[120:135]
    ds_read_b64_tr_b16 v[92:93], v171 offset:0
    ds_read_b64_tr_b16 v[94:95], v171 offset:1024
    s_waitcnt lgkmcnt(13)
    v_mfma_f32_32x32x16_bf16 v[136:151], v[100:103], v[44:47], v[136:151]
    s_mov_b64 exec, s[68:69]
    buffer_load_dwordx4 v[76:79], v8, s[84:87], s53 offen offset:1024 sc1
    s_mov_b64 exec, -1
    ds_read_b64_tr_b16 v[96:97], v170 offset:2048
    ds_read_b64_tr_b16 v[98:99], v170 offset:3072
    s_waitcnt vmcnt(7) lgkmcnt(13)
    v_mfma_f32_32x32x16_bf16 v[120:135], v[104:107], v[48:51], v[120:135]
    ds_read_b64_tr_b16 v[100:101], v171 offset:2048
    ds_read_b64_tr_b16 v[102:103], v171 offset:3072
    s_waitcnt lgkmcnt(8)
    v_cmp_gt_u32 vcc, 5, v10
    s_nop 0
    s_and_b64 vcc, vcc, s[56:57]
    s_cbranch_scc1 Lslow_145
Lfok_143:
    s_mov_b64 exec, s[94:95]
    s_nop 0
    ds_read_b128 v[56:59], v172 offset:0
    ds_read_b128 v[60:63], v172 offset:64
    ds_read_b128 v[64:67], v172 offset:128
    ds_read_b128 v[68:71], v172 offset:192
    ds_read_b128 v[72:75], v172 offset:256
    ds_read_b128 v[76:79], v172 offset:320
    ds_read_b128 v[80:83], v172 offset:384
    ds_read_b128 v[84:87], v172 offset:448
    s_mov_b64 exec, -1
    v_mfma_f32_32x32x16_bf16 v[136:151], v[108:111], v[48:51], v[136:151]
    s_mov_b64 exec, s[68:69]
    buffer_load_dwordx4 v[80:83], v8, s[84:87], s53 offen offset:2048 sc1
    s_mov_b64 exec, -1
    ds_read_b64_tr_b16 v[104:105], v170 offset:4096
    ds_read_b64_tr_b16 v[106:107], v170 offset:5120
    s_waitcnt vmcnt(7)
    v_mfma_f32_32x32x16_bf16 v[120:135], v[112:115], v[52:55], v[120:135]
    ds_read_b64_tr_b16 v[108:109], v171 offset:4096
    ds_read_b64_tr_b16 v[110:111], v171 offset:5120
    v_mfma_f32_32x32x16_bf16 v[136:151], v[116:119], v[52:55], v[136:151]
    s_mov_b64 exec, s[68:69]
    buffer_load_dwordx4 v[84:87], v8, s[84:87], s53 offen offset:3072 sc1
    s_mov_b64 exec, -1
    v_mov_b32 v19, 6
    s_mov_b64 exec, s[64:65]
    ds_write_b32 v9, v19 offset:112
    s_mov_b64 exec, -1
    ds_read_b64_tr_b16 v[112:113], v170 offset:6144
    ds_read_b64_tr_b16 v[114:115], v170 offset:7168
    s_waitcnt vmcnt(7) lgkmcnt(14)
    v_mfma_f32_32x32x16_bf16 v[120:135], v[88:91], v[56:59], v[120:135]
    ds_read_b64_tr_b16 v[116:117], v171 offset:6144
    ds_read_b64_tr_b16 v[118:119], v171 offset:7168
    v_mfma_f32_32x32x16_bf16 v[136:151], v[92:95], v[56:59], v[136:151]
    ds_read_b64_tr_b16 v[88:89], v171 offset:8192
    ds_read_b64_tr_b16 v[90:91], v171 offset:9216
    ds_read_b32 v10, v9 offset:80
    s_waitcnt vmcnt(6) lgkmcnt(14)
    v_mfma_f32_32x32x16_bf16 v[120:135], v[96:99], v[60:63], v[120:135]
    ds_read_b64_tr_b16 v[92:93], v171 offset:10240
    ds_read_b64_tr_b16 v[94:95], v171 offset:11264
    v_mfma_f32_32x32x16_bf16 v[136:151], v[100:103], v[60:63], v[136:151]
    ds_read_b64_tr_b16 v[96:97], v171 offset:12288
    ds_read_b64_tr_b16 v[98:99], v171 offset:13312
    s_waitcnt vmcnt(5) lgkmcnt(14)
    v_mfma_f32_32x32x16_bf16 v[120:135], v[104:107], v[64:67], v[120:135]
    ds_read_b64_tr_b16 v[100:101], v171 offset:14336
    ds_read_b64_tr_b16 v[102:103], v171 offset:15360
    s_waitcnt lgkmcnt(14)
    v_mfma_f32_32x32x16_bf16 v[136:151], v[108:111], v[64:67], v[136:151]
    ds_read_b64_tr_b16 v[104:105], v170 offset:8192
    ds_read_b64_tr_b16 v[106:107], v170 offset:9216
    s_waitcnt vmcnt(4) lgkmcnt(13)
    v_mfma_f32_32x32x16_bf16 v[120:135], v[112:115], v[68:71], v[120:135]
    ds_read_b64_tr_b16 v[108:109], v170 offset:10240
    ds_read_b64_tr_b16 v[110:111], v170 offset:11264
    s_waitcnt lgkmcnt(10)
    v_cmp_gt_u32 vcc, 3, v10
    s_nop 0
    s_and_b64 vcc, vcc, s[50:51]
    s_cbranch_scc1 Lslow_148
Lfok_146:
    s_nop 0
    ds_read_b128 v[232:235], v18 offset:9984
    ds_read_b128 v[236:239], v18 offset:10016
    ds_read_b128 v[240:243], v18 offset:10048
    v_mfma_f32_32x32x16_bf16 v[136:151], v[116:119], v[68:71], v[136:151]
    ds_read_b64_tr_b16 v[112:113], v170 offset:12288
    ds_read_b64_tr_b16 v[114:115], v170 offset:13312
    ds_read_b128 v[244:247], v18 offset:10080
    s_add_u32 s12, s96, 65536
    s_add_u32 s67, s41, 65536
    s_waitcnt vmcnt(3)
    v_mfma_f32_32x32x16_bf16 v[136:151], v[88:91], v[72:75], v[136:151]
    ds_read_b64_tr_b16 v[116:117], v170 offset:14336
    ds_read_b64_tr_b16 v[118:119], v170 offset:15360
    v_mov_b32 v19, 6
    s_mov_b64 exec, s[64:65]
    ds_write_b32 v9, v19 offset:48
    s_mov_b64 exec, -1
    v_mov_b32 v5, 0x3f803f80
    s_lshl_b32 s3, s6, 10
    s_add_u32 s3, s3, 147456
    s_waitcnt vmcnt(2) lgkmcnt(14)
    v_mfma_f32_32x32x16_bf16 v[136:151], v[92:95], v[76:79], v[136:151]
    v_add_u32 v4, s3, v1
    s_waitcnt vmcnt(1) lgkmcnt(14)
    v_mfma_f32_32x32x16_bf16 v[136:151], v[96:99], v[80:83], v[136:151]
    s_waitcnt vmcnt(0) lgkmcnt(13)
    v_mfma_f32_32x32x16_bf16 v[136:151], v[100:103], v[84:87], v[136:151]
    s_waitcnt lgkmcnt(11)
    v_mfma_f32_32x32x16_bf16 v[120:135], v[104:107], v[72:75], v[120:135]
    s_waitcnt lgkmcnt(9)
    v_mfma_f32_32x32x16_bf16 v[120:135], v[108:111], v[76:79], v[120:135]
    s_nop 7
    ds_write_b128 v22, v[136:139] offset:0
    ds_write_b128 v22, v[140:143] offset:1024
    s_waitcnt lgkmcnt(6)
    v_mfma_f32_32x32x16_bf16 v[120:135], v[112:115], v[80:83], v[120:135]
    ds_write_b128 v22, v[144:147] offset:2048
    ds_write_b128 v22, v[148:151] offset:3072
    v_mov_b32 v19, 4
    s_mov_b64 exec, s[64:65]
    ds_write_b32 v9, v19 offset:64
    s_mov_b64 exec, -1
    s_waitcnt lgkmcnt(6)
    v_mfma_f32_32x32x16_bf16 v[120:135], v[116:119], v[84:87], v[120:135]
    ds_read_b32 v10, v9 offset:64
    ds_read_b128 v[216:219], v23 offset:0
    ds_read_b128 v[220:223], v23 offset:1024
    ds_read_b128 v[224:227], v23 offset:2048
    ds_read_b128 v[228:231], v23 offset:3072
    s_waitcnt lgkmcnt(4)
    v_cmp_gt_u32 vcc, 4, v10
    s_nop 0
    s_and_b64 vcc, vcc, s[50:51]
    s_cbranch_scc1 Lslow_151
Lfok_149:
    v_mov_b32 v19, 4
    s_mov_b64 exec, s[64:65]
    ds_write_b32 v9, v19 offset:80
    s_mov_b64 exec, -1
    s_nop 0
    v_pk_add_f32 v[200:201], v[200:201], v[120:121]
    v_pk_add_f32 v[202:203], v[202:203], v[122:123]
    v_pk_add_f32 v[204:205], v[204:205], v[124:125]
    v_pk_add_f32 v[206:207], v[206:207], v[126:127]
    v_pk_add_f32 v[208:209], v[208:209], v[128:129]
    v_pk_add_f32 v[210:211], v[210:211], v[130:131]
    v_pk_add_f32 v[212:213], v[212:213], v[132:133]
    v_pk_add_f32 v[214:215], v[214:215], v[134:135]
    s_waitcnt lgkmcnt(4)
    v_pk_add_f32 v[200:201], v[200:201], v[216:217]
    v_pk_add_f32 v[202:203], v[202:203], v[218:219]
    v_cvt_pk_bf16_f32 v248, v200, v201
    v_cvt_pk_bf16_f32 v249, v202, v203
    s_waitcnt lgkmcnt(3)
    v_pk_add_f32 v[204:205], v[204:205], v[220:221]
    v_pk_add_f32 v[206:207], v[206:207], v[222:223]
    v_cvt_pk_bf16_f32 v250, v204, v205
    v_cvt_pk_bf16_f32 v251, v206, v207
    buffer_store_dwordx4 v[248:251], v1, s[72:75], s12 offen
    s_cmp_eq_u32 s78, 0
    s_cbranch_scc0 Lslow_153
Lfs_152:
    s_waitcnt lgkmcnt(2)
    v_pk_add_f32 v[208:209], v[208:209], v[224:225]
    v_pk_add_f32 v[210:211], v[210:211], v[226:227]
    v_cvt_pk_bf16_f32 v252, v208, v209
    v_cvt_pk_bf16_f32 v253, v210, v211
    s_waitcnt lgkmcnt(1)
    v_pk_add_f32 v[212:213], v[212:213], v[228:229]
    v_pk_add_f32 v[214:215], v[214:215], v[230:231]
    v_cvt_pk_bf16_f32 v254, v212, v213
    v_cvt_pk_bf16_f32 v255, v214, v215
    buffer_store_dwordx4 v[252:255], v1, s[72:75], s12 offen offset:1024
    s_cmp_eq_u32 s78, 0
    s_cbranch_scc0 Lslow_155
Lfs_154:
    v_dot2_f32_bf16 v152, v248, v5, 0
    v_dot2_f32_bf16 v153, v248, v248, 0
    v_dot2_f32_bf16 v152, v249, v5, v152
    v_dot2_f32_bf16 v153, v249, v249, v153
    v_dot2_f32_bf16 v152, v250, v5, v152
    v_dot2_f32_bf16 v153, v250, v250, v153
    v_dot2_f32_bf16 v152, v251, v5, v152
    v_dot2_f32_bf16 v153, v251, v251, v153
    v_dot2_f32_bf16 v152, v252, v5, v152
    v_dot2_f32_bf16 v153, v252, v252, v153
    v_dot2_f32_bf16 v152, v253, v5, v152
    v_dot2_f32_bf16 v153, v253, v253, v153
    v_dot2_f32_bf16 v152, v254, v5, v152
    v_dot2_f32_bf16 v153, v254, v254, v153
    v_dot2_f32_bf16 v152, v255, v5, v152
    v_dot2_f32_bf16 v153, v255, v255, v153
    s_nop 2
    ds_write_b64 v4, v[152:153]
    v_lshlrev_b32 v216, 16, v248
    v_and_b32 v217, 0xffff0000, v248
    v_lshlrev_b32 v218, 16, v249
    v_and_b32 v219, 0xffff0000, v249
    v_lshlrev_b32 v220, 16, v250
    v_and_b32 v221, 0xffff0000, v250
    v_lshlrev_b32 v222, 16, v251
    v_and_b32 v223, 0xffff0000, v251
    v_lshlrev_b32 v224, 16, v252
    v_and_b32 v225, 0xffff0000, v252
    v_lshlrev_b32 v226, 16, v253
    v_and_b32 v227, 0xffff0000, v253
    v_lshlrev_b32 v228, 16, v254
    v_and_b32 v229, 0xffff0000, v254
    v_lshlrev_b32_e64 v230, 16, v255
    v_and_b32 v231, 0xffff0000, v255
    v_pk_fma_f32 v[184:185], v[216:217], v[232:233], v[184:185]
    v_pk_fma_f32 v[186:187], v[218:219], v[234:235], v[186:187]
    v_pk_fma_f32 v[188:189], v[220:221], v[236:237], v[188:189]
    v_pk_fma_f32 v[190:191], v[222:223], v[238:239], v[190:191]
    v_pk_fma_f32 v[192:193], v[224:225], v[240:241], v[192:193]
    v_pk_fma_f32 v[194:195], v[226:227], v[242:243], v[194:195]
    v_pk_fma_f32 v[196:197], v[228:229], v[244:245], v[196:197]
    v_pk_fma_f32 v[198:199], v[230:231], v[246:247], v[198:199]
    s_waitcnt vmcnt(0)
    buffer_store_dword v6, v7, s[72:75], s97 offen offset:768
    s_cmp_eq_u32 s78, 0
    s_cbranch_scc0 Lslow_157
Lfs_156:
    v_mov_b32 v19, 7
    s_mov_b64 exec, s[64:65]
    ds_write_b32 v9, v19 offset:112
    s_mov_b64 exec, -1
    ds_read_b32 v10, v9 offset:32
    s_waitcnt lgkmcnt(0)
    v_cmp_gt_u32 vcc, 7, v10
    s_cbranch_vccnz Lslow_160
Lfok_158:
    s_nop 0
    ds_read_b64_tr_b16 v[88:89], v14 offset:0
    ds_read_b64_tr_b16 v[90:91], v14 offset:1024
    ds_read_b64_tr_b16 v[92:93], v15 offset:0
    ds_read_b64_tr_b16 v[94:95], v15 offset:1024
    ds_read_b64_tr_b16 v[96:97], v14 offset:2048
    ds_read_b64_tr_b16 v[98:99], v14 offset:3072
    ds_read_b64_tr_b16 v[100:101], v15 offset:2048
    ds_read_b64_tr_b16 v[102:103], v15 offset:3072
    ds_read_b64_tr_b16 v[104:105], v14 offset:4096
    ds_read_b64_tr_b16 v[106:107], v14 offset:5120
    ds_read_b64_tr_b16 v[108:109], v15 offset:4096
    ds_read_b64_tr_b16 v[110:111], v15 offset:5120
    ds_read_b64_tr_b16 v[112:113], v14 offset:6144
    ds_read_b64_tr_b16 v[114:115], v14 offset:7168
    s_movk_i32 s0, 20000
Lspin_162:
    buffer_load_dword v2, v11, s[84:87], s98 offen offset:768 sc1
    s_sub_u32 s0, s0, 1
    s_cbranch_scc1 Lok_161
    s_waitcnt vmcnt(0)
    v_cmp_ne_u32 vcc, s7, v2
    s_nop 0
    s_cmp_eq_u64 vcc, 0
    s_cbranch_scc0 Lspin_162
Lok_161:
    s_add_u32 s66, s67, 8192
    buffer_load_dwordx4 v[24:27], v1, s[84:87], s67 offen offset:0 sc1
    buffer_load_dwordx4 v[28:31], v1, s[84:87], s67 offen offset:1024 sc1
    buffer_load_dwordx4 v[32:35], v1, s[84:87], s67 offen offset:2048 sc1
    buffer_load_dwordx4 v[36:39], v1, s[84:87], s67 offen offset:3072 sc1
    buffer_load_dwordx4 v[40:43], v8, s[84:87], s67 offen offset:0 sc1
    buffer_load_dwordx4 v[44:47], v8, s[84:87], s67 offen offset:1024 sc1
    buffer_load_dwordx4 v[48:51], v8, s[84:87], s67 offen offset:2048 sc1
    buffer_load_dwordx4 v[52:55], v8, s[84:87], s67 offen offset:3072 sc1
    v_and_b32 v3, 15, v0
    v_lshlrev_b32 v3, 2, v3
    s_add_u32 s92, s41, 65536
    s_add_u32 s93, s41, 196608
    s_sub_u32 s3, s41, s40
    s_lshr_b32 s3, s3, 1
    s_add_u32 s3, s3, s40
    s_add_u32 s94, s3, 262144
    v_and_b32 v4, 15, v0
    s_lshl_b32 s3, s15, 5
    v_add_u32 v5, s3, v4
    v_lshlrev_b32 v5, 10, v5
    v_lshl_add_u32 v5, v17, 4, v5
    v_and_b32 v4, 16, v0
    v_lshl_add_u32 v5, v4, 1, v5
    s_lshl_b32 s3, s5, 7
    s_lshl_b32 s8, s14, 6
    s_add_u32 s11, s3, s8
    s_add_u32 s12, s11, 16384
    s_waitcnt vmcnt(7) lgkmcnt(12)
    v_mfma_f32_32x32x16_bf16 v[120:135], v[88:91], v[24:27], 0
    ds_read_b64_tr_b16 v[116:117], v15 offset:6144
    ds_read_b64_tr_b16 v[118:119], v15 offset:7168
    s_waitcnt lgkmcnt(12)
    v_mfma_f32_32x32x16_bf16 v[136:151], v[92:95], v[24:27], 0
    buffer_load_dwordx4 v[56:59], v1, s[84:87], s66 offen offset:0 sc1
    ds_read_b64_tr_b16 v[88:89], v14 offset:8192
    ds_read_b64_tr_b16 v[90:91], v14 offset:9216
    s_waitcnt vmcnt(7) lgkmcnt(12)
    v_mfma_f32_32x32x16_bf16 v[120:135], v[96:99], v[28:31], v[120:135]
    ds_read_b64_tr_b16 v[92:93], v15 offset:8192
    ds_read_b64_tr_b16 v[94:95], v15 offset:9216
    s_waitcnt lgkmcnt(12)
    v_mfma_f32_32x32x16_bf16 v[136:151], v[100:103], v[28:31], v[136:151]
    buffer_load_dwordx4 v[60:63], v1, s[84:87], s66 offen offset:1024 sc1
    ds_read_b32 v10, v9 offset:32
    ds_read_b64_tr_b16 v[96:97], v14 offset:10240
    ds_read_b64_tr_b16 v[98:99], v14 offset:11264
    s_waitcnt vmcnt(7) lgkmcnt(13)
    v_mfma_f32_32x32x16_bf16 v[120:135], v[104:107], v[32:35], v[120:135]
    ds_read_b64_tr_b16 v[100:101], v15 offset:10240
    ds_read_b64_tr_b16 v[102:103], v15 offset:11264
    s_waitcnt lgkmcnt(13)
    v_mfma_f32_32x32x16_bf16 v[136:151], v[108:111], v[32:35], v[136:151]
    buffer_load_dwordx4 v[64:67], v1, s[84:87], s66 offen offset:2048 sc1
    ds_read_b64_tr_b16 v[104:105], v14 offset:12288
    ds_read_b64_tr_b16 v[106:107], v14 offset:13312
    s_waitcnt vmcnt(7) lgkmcnt(13)
    v_mfma_f32_32x32x16_bf16 v[120:135], v[112:115], v[36:39], v[120:135]
    ds_read_b64_tr_b16 v[108:109], v15 offset:12288
    ds_read_b64_tr_b16 v[110:111], v15 offset:13312
    s_waitcnt lgkmcnt(13)
    v_mfma_f32_32x32x16_bf16 v[136:151], v[116:119], v[36:39], v[136:151]
    buffer_load_dwordx4 v[68:71], v1, s[84:87], s66 offen offset:3072 sc1
    ds_read_b64_tr_b16 v[112:113], v14 offset:14336
    ds_read_b64_tr_b16 v[114:115], v14 offset:15360
    s_waitcnt vmcnt(7) lgkmcnt(13)
    v_mfma_f32_32x32x16_bf16 v[120:135], v[88:91], v[40:43], v[120:135]
    ds_read_b64_tr_b16 v[116:117], v15 offset:14336
    ds_read_b64_tr_b16 v[118:119], v15 offset:15360
    v_mov_b32 v19, 7
    s_mov_b64 exec, s[64:65]
    ds_write_b32 v9, v19 offset:48
    s_mov_b64 exec, -1
    s_waitcnt lgkmcnt(13)
    v_cmp_gt_u32 vcc, 8, v10
    v_mfma_f32_32x32x16_bf16 v[136:151], v[92:95], v[40:43], v[136:151]
    buffer_load_dwordx4 v[72:75], v8, s[84:87], s66 offen offset:0 sc1
    s_cbranch_vccnz Lslow_165
Lfok_163:
    ds_read_b64_tr_b16 v[88:89], v14 offset:32768
    ds_read_b64_tr_b16 v[90:91], v14 offset:33792
    s_waitcnt vmcnt(7) lgkmcnt(13)
    v_mfma_f32_32x32x16_bf16 v[120:135], v[96:99], v[44:47], v[120:135]
    ds_read_b32 v10, v9 offset:80
    ds_read_b64_tr_b16 v[92:93], v15 offset:32768
    ds_read_b64_tr_b16 v[94:95], v15 offset:33792
    s_waitcnt lgkmcnt(14)
    v_mfma_f32_32x32x16_bf16 v[136:151], v[100:103], v[44:47], v[136:151]
    buffer_load_dwordx4 v[76:79], v8, s[84:87], s66 offen offset:1024 sc1
    ds_read_b64_tr_b16 v[96:97], v14 offset:34816
    ds_read_b64_tr_b16 v[98:99], v14 offset:35840
    s_waitcnt vmcnt(7) lgkmcnt(14)
    v_mfma_f32_32x32x16_bf16 v[120:135], v[104:107], v[48:51], v[120:135]
    ds_read_b64_tr_b16 v[100:101], v15 offset:34816
    ds_read_b64_tr_b16 v[102:103], v15 offset:35840
    s_waitcnt lgkmcnt(14)
    v_mfma_f32_32x32x16_bf16 v[136:151], v[108:111], v[48:51], v[136:151]
    buffer_load_dwordx4 v[80:83], v8, s[84:87], s66 offen offset:2048 sc1
    ds_read_b64_tr_b16 v[104:105], v14 offset:36864
    ds_read_b64_tr_b16 v[106:107], v14 offset:37888
    s_waitcnt vmcnt(7) lgkmcnt(14)
    v_mfma_f32_32x32x16_bf16 v[120:135], v[112:115], v[52:55], v[120:135]
    ds_read_b64_tr_b16 v[108:109], v15 offset:36864
    ds_read_b64_tr_b16 v[110:111], v15 offset:37888
    s_waitcnt lgkmcnt(14)
    v_mfma_f32_32x32x16_bf16 v[136:151], v[116:119], v[52:55], v[136:151]
    buffer_load_dwordx4 v[84:87], v8, s[84:87], s66 offen offset:3072 sc1
    v_mov_b32 v19, 8
    s_mov_b64 exec, s[64:65]
    ds_write_b32 v9, v19 offset:112
    s_mov_b64 exec, -1
    s_waitcnt lgkmcnt(11)
    v_cmp_gt_u32 vcc, 4, v10
    s_nop 0
    s_and_b64 vcc, vcc, s[50:51]
    s_cbranch_scc1 Lslow_168
Lfok_166:
    ds_read_b64_tr_b16 v[112:113], v14 offset:38912
    ds_read_b64_tr_b16 v[114:115], v14 offset:39936
    s_waitcnt vmcnt(7)
    v_mfma_f32_32x32x16_bf16 v[120:135], v[88:91], v[56:59], v[120:135]
    ds_read_b64_tr_b16 v[116:117], v15 offset:38912
    ds_read_b64_tr_b16 v[118:119], v15 offset:39936
    s_waitcnt lgkmcnt(13)
    v_mfma_f32_32x32x16_bf16 v[136:151], v[92:95], v[56:59], v[136:151]
    ds_read_b64_tr_b16 v[88:89], v15 offset:40960
    ds_read_b64_tr_b16 v[90:91], v15 offset:41984
    s_waitcnt vmcnt(6) lgkmcnt(13)
    v_mfma_f32_32x32x16_bf16 v[120:135], v[96:99], v[60:63], v[120:135]
    ds_read_b64_tr_b16 v[92:93], v15 offset:43008
    ds_read_b64_tr_b16 v[94:95], v15 offset:44032
    s_waitcnt lgkmcnt(13)
    v_mfma_f32_32x32x16_bf16 v[136:151], v[100:103], v[60:63], v[136:151]
    ds_read_b32 v10, v9 offset:32
    ds_read_b64_tr_b16 v[96:97], v15 offset:45056
    ds_read_b64_tr_b16 v[98:99], v15 offset:46080
    s_waitcnt vmcnt(5) lgkmcnt(14)
    v_mfma_f32_32x32x16_bf16 v[120:135], v[104:107], v[64:67], v[120:135]
    ds_read_b64_tr_b16 v[100:101], v15 offset:47104
    ds_read_b64_tr_b16 v[102:103], v15 offset:48128
    s_waitcnt lgkmcnt(14)
    v_mfma_f32_32x32x16_bf16 v[136:151], v[108:111], v[64:67], v[136:151]
    ds_read_b64_tr_b16 v[104:105], v14 offset:40960
    ds_read_b64_tr_b16 v[106:107], v14 offset:41984
    s_waitcnt vmcnt(4) lgkmcnt(13)
    v_mfma_f32_32x32x16_bf16 v[120:135], v[112:115], v[68:71], v[120:135]
    ds_read_b64_tr_b16 v[108:109], v14 offset:43008
    ds_read_b64_tr_b16 v[110:111], v14 offset:44032
    s_waitcnt lgkmcnt(13)
    v_mfma_f32_32x32x16_bf16 v[136:151], v[116:119], v[68:71], v[136:151]
    ds_read_b64_tr_b16 v[112:113], v14 offset:45056
    ds_read_b64_tr_b16 v[114:115], v14 offset:46080
    s_waitcnt vmcnt(3) lgkmcnt(13)
    v_mfma_f32_32x32x16_bf16 v[136:151], v[88:91], v[72:75], v[136:151]
    ds_read_b64_tr_b16 v[116:117], v14 offset:47104
    ds_read_b64_tr_b16 v[118:119], v14 offset:48128
    v_mov_b32 v19, 8
    s_mov_b64 exec, s[64:65]
    ds_write_b32 v9, v19 offset:48
    s_mov_b64 exec, -1
    ds_read_b32 v17, v9 offset:96
    s_waitcnt lgkmcnt(14)
    v_cmp_gt_u32 vcc, 9, v10
    s_waitcnt vmcnt(2)
    v_mfma_f32_32x32x16_bf16 v[136:151], v[92:95], v[76:79], v[136:151]
    s_cbranch_vccnz Lslow_171
Lfok_169:
    ds_read_b64_tr_b16 v[88:89], v12 offset:0
    ds_read_b64_tr_b16 v[90:91], v12 offset:1024
    s_waitcnt vmcnt(1) lgkmcnt(14)
    v_mfma_f32_32x32x16_bf16 v[136:151], v[96:99], v[80:83], v[136:151]
    ds_read_b64_tr_b16 v[92:93], v13 offset:0
    ds_read_b64_tr_b16 v[94:95], v13 offset:1024
    s_waitcnt lgkmcnt(4)
    v_cmp_gt_u32 vcc, 6, v17
    s_cbranch_vccnz Lslow_174
Lfok_172:
    ds_read_b128 v[216:219], v21
    s_add_u32 s88, s96, 65536
    s_add_u32 s89, s96, 196608
    s_sub_u32 s3, s96, s40
    s_lshr_b32 s3, s3, 1
    s_waitcnt vmcnt(0)
    v_mfma_f32_32x32x16_bf16 v[136:151], v[100:103], v[84:87], v[136:151]
    ds_read_b64_tr_b16 v[96:97], v12 offset:2048
    ds_read_b64_tr_b16 v[98:99], v12 offset:3072
    s_add_u32 s3, s3, s40
    s_add_u32 s90, s3, 262144
    s_waitcnt lgkmcnt(2)
    v_mov_b32 v16, v216
    v_mov_b32 v21, v217
    v_mov_b32 v20, v218
    v_mfma_f32_32x32x16_bf16 v[120:135], v[104:107], v[72:75], v[120:135]
    ds_read_b64_tr_b16 v[100:101], v13 offset:2048
    ds_read_b64_tr_b16 v[102:103], v13 offset:3072
    v_mov_b32_e64 v4, v219
    v_mfma_f32_32x32x16_bf16 v[120:135], v[108:111], v[76:79], v[120:135]
    ds_write_b128 v22, v[136:139] offset:0
    ds_read_b64_tr_b16 v[104:105], v12 offset:4096
    ds_read_b64_tr_b16 v[106:107], v12 offset:5120
    v_mfma_f32_32x32x16_bf16 v[120:135], v[112:115], v[80:83], v[120:135]
    ds_write_b128 v22, v[140:143] offset:1024
    ds_read_b64_tr_b16 v[108:109], v13 offset:4096
    ds_read_b64_tr_b16 v[110:111], v13 offset:5120
    v_mfma_f32_32x32x16_bf16 v[120:135], v[116:119], v[84:87], v[120:135]
    ds_write_b128 v22, v[144:147] offset:2048
    ds_read_b64_tr_b16 v[112:113], v12 offset:6144
    ds_read_b64_tr_b16 v[114:115], v12 offset:7168
    v_mfma_f32_32x32x16_bf16 v[152:167], v[88:91], v[24:27], 0
    ds_write_b128 v22, v[148:151] offset:3072
    v_mov_b32 v19, 5
    s_mov_b64 exec, s[64:65]
    ds_write_b32 v9, v19 offset:64
    s_mov_b64 exec, -1
    ds_read_b64_tr_b16 v[116:117], v13 offset:6144
    ds_read_b64_tr_b16 v[118:119], v13 offset:7168
    v_mfma_f32_32x32x16_bf16 v[168:183], v[92:95], v[24:27], 0
    ds_read_b64_tr_b16 v[88:89], v12 offset:8192
    ds_read_b64_tr_b16 v[90:91], v12 offset:9216
    s_waitcnt lgkmcnt(14)
    v_mfma_f32_32x32x16_bf16 v[152:167], v[96:99], v[28:31], v[152:167]
    ds_read_b64_tr_b16 v[92:93], v13 offset:8192
    ds_read_b64_tr_b16 v[94:95], v13 offset:9216
    ds_read_b32 v17, v9 offset:64
    ds_read_b128 v[216:219], v23 offset:0
    ds_read_b128 v[220:223], v23 offset:1024
    ds_read_b128 v[224:227], v23 offset:2048
    ds_read_b128 v[228:231], v23 offset:3072
    s_waitcnt lgkmcnt(14)
    s_nop 0
    v_mfma_f32_32x32x16_bf16 v[168:183], v[100:103], v[28:31], v[168:183]
    ds_read_b32 v10, v9 offset:32
    ds_read_b64_tr_b16 v[96:97], v12 offset:10240
    ds_read_b64_tr_b16 v[98:99], v12 offset:11264
    ds_read_b128 v[200:203], v18 offset:10240
    ds_read_b128 v[204:207], v18 offset:10272
    ds_read_b128 v[208:211], v18 offset:10304
    ds_read_b128 v[212:215], v18 offset:10336
    s_waitcnt lgkmcnt(14)
    v_mfma_f32_32x32x16_bf16 v[152:167], v[104:107], v[32:35], v[152:167]
    ds_read_b64_tr_b16 v[100:101], v13 offset:10240
    ds_read_b64_tr_b16 v[102:103], v13 offset:11264
    s_waitcnt lgkmcnt(13)
    v_cmp_gt_u32 vcc, 5, v17
    s_nop 0
    s_and_b64 vcc, vcc, s[50:51]
    s_cbranch_scc1 Lslow_177
Lfok_175:
    v_mov_b32 v19, 5
    s_mov_b64 exec, s[64:65]
    ds_write_b32 v9, v19 offset:80
    s_mov_b64 exec, -1
    v_mfma_f32_32x32x16_bf16 v[168:183], v[108:111], v[32:35], v[168:183]
    ds_read_b64_tr_b16 v[104:105], v12 offset:12288
    ds_read_b64_tr_b16 v[106:107], v12 offset:13312
    s_waitcnt lgkmcnt(5)
    v_pk_fma_f32 v[200:201], v[200:201], v[16:17], v[216:217] op_sel_hi:[1,0,1] neg_lo:[1,0,0] neg_hi:[1,0,0]
    v_pk_fma_f32 v[202:203], v[202:203], v[16:17], v[218:219] op_sel_hi:[1,0,1] neg_lo:[1,0,0] neg_hi:[1,0,0]
    v_pk_fma_f32 v[204:205], v[204:205], v[16:17], v[220:221] op_sel_hi:[1,0,1] neg_lo:[1,0,0] neg_hi:[1,0,0]
    v_pk_fma_f32 v[206:207], v[206:207], v[16:17], v[222:223] op_sel_hi:[1,0,1] neg_lo:[1,0,0] neg_hi:[1,0,0]
    v_pk_fma_f32 v[208:209], v[208:209], v[16:17], v[224:225] op_sel_hi:[1,0,1] neg_lo:[1,0,0] neg_hi:[1,0,0]
    v_pk_fma_f32 v[210:211], v[210:211], v[16:17], v[226:227] op_sel_hi:[1,0,1] neg_lo:[1,0,0] neg_hi:[1,0,0]
    v_pk_fma_f32 v[212:213], v[212:213], v[16:17], v[228:229] op_sel_hi:[1,0,1] neg_lo:[1,0,0] neg_hi:[1,0,0]
    v_pk_fma_f32 v[214:215], v[214:215], v[16:17], v[230:231] op_sel_hi:[1,0,1] neg_lo:[1,0,0] neg_hi:[1,0,0]
    v_pk_add_f32 v[200:201], v[200:201], v[120:121]
    v_pk_add_f32 v[202:203], v[202:203], v[122:123]
    v_pk_add_f32 v[204:205], v[204:205], v[124:125]
    v_pk_add_f32 v[206:207], v[206:207], v[126:127]
    v_pk_add_f32 v[208:209], v[208:209], v[128:129]
    v_pk_add_f32 v[210:211], v[210:211], v[130:131]
    v_pk_add_f32 v[212:213], v[212:213], v[132:133]
    v_pk_add_f32 v[214:215], v[214:215], v[134:135]
    v_pk_mul_f32 v[216:217], v[200:201], v[200:201]
    v_pk_mul_f32 v[218:219], v[202:203], v[202:203]
    v_pk_mul_f32 v[220:221], v[204:205], v[204:205]
    v_pk_mul_f32 v[222:223], v[206:207], v[206:207]
    v_pk_mul_f32 v[224:225], v[208:209], v[208:209]
    v_pk_mul_f32 v[226:227], v[210:211], v[210:211]
    v_pk_mul_f32 v[228:229], v[212:213], v[212:213]
    v_pk_mul_f32 v[230:231], v[214:215], v[214:215]
    v_pk_fma_f32 v[216:217], v[216:217], v[20:21], v[20:21] op_sel:[0,0,1] op_sel_hi:[1,0,1]
    v_pk_fma_f32 v[218:219], v[218:219], v[20:21], v[20:21] op_sel:[0,0,1] op_sel_hi:[1,0,1]
    v_pk_fma_f32 v[220:221], v[220:221], v[20:21], v[20:21] op_sel:[0,0,1] op_sel_hi:[1,0,1]
    v_pk_fma_f32 v[222:223], v[222:223], v[20:21], v[20:21] op_sel:[0,0,1] op_sel_hi:[1,0,1]
    v_pk_fma_f32 v[224:225], v[224:225], v[20:21], v[20:21] op_sel:[0,0,1] op_sel_hi:[1,0,1]
    v_pk_fma_f32 v[226:227], v[226:227], v[20:21], v[20:21] op_sel:[0,0,1] op_sel_hi:[1,0,1]
    v_pk_fma_f32 v[228:229], v[228:229], v[20:21], v[20:21] op_sel:[0,0,1] op_sel_hi:[1,0,1]
    v_pk_fma_f32 v[230:231], v[230:231], v[20:21], v[20:21] op_sel:[0,0,1] op_sel_hi:[1,0,1]
    v_pk_mul_f32 v[216:217], v[216:217], v[200:201]
    v_pk_mul_f32 v[218:219], v[218:219], v[202:203]
    v_pk_mul_f32 v[220:221], v[220:221], v[204:205]
    v_pk_mul_f32 v[222:223], v[222:223], v[206:207]
    v_pk_mul_f32 v[224:225], v[224:225], v[208:209]
    v_pk_mul_f32 v[226:227], v[226:227], v[210:211]
    v_pk_mul_f32 v[228:229], v[228:229], v[212:213]
    v_pk_mul_f32 v[230:231], v[230:231], v[214:215]
    v_exp_f32 v216, v216
    v_exp_f32 v217, v217
    v_exp_f32_e64 v218, v218
    v_mfma_f32_32x32x16_bf16 v[152:167], v[112:115], v[36:39], v[152:167]
    ds_read_b64_tr_b16 v[108:109], v13 offset:12288
    ds_read_b64_tr_b16 v[110:111], v13 offset:13312
    v_exp_f32 v219, v219
    v_exp_f32 v220, v220
    v_exp_f32_e64 v221, v221
    v_mfma_f32_32x32x16_bf16 v[168:183], v[116:119], v[36:39], v[168:183]
    ds_read_b64_tr_b16 v[112:113], v12 offset:14336
    ds_read_b64_tr_b16 v[114:115], v12 offset:15360
    v_exp_f32 v222, v222
    v_exp_f32 v223, v223
    v_exp_f32_e64 v224, v224
    v_mfma_f32_32x32x16_bf16 v[152:167], v[88:91], v[40:43], v[152:167]
    ds_read_b64_tr_b16 v[116:117], v13 offset:14336
    ds_read_b64_tr_b16 v[118:119], v13 offset:15360
    v_mov_b32 v19, 9
    s_mov_b64 exec, s[64:65]
    ds_write_b32 v9, v19 offset:48
    s_mov_b64 exec, -1
    v_exp_f32 v225, v225
    v_exp_f32 v226, v226
    v_exp_f32 v227, v227
    v_cmp_gt_u32 vcc, 10, v10
    v_mfma_f32_32x32x16_bf16 v[168:183], v[92:95], v[40:43], v[168:183]
    s_cbranch_vccnz Lslow_180
Lfok_178:
    ds_read_b64_tr_b16 v[88:89], v13 offset:32768
    ds_read_b64_tr_b16 v[90:91], v13 offset:33792
    v_exp_f32 v228, v228
    v_exp_f32 v229, v229
    v_exp_f32_e64 v230, v230
    v_mfma_f32_32x32x16_bf16 v[152:167], v[96:99], v[44:47], v[152:167]
    ds_read_b32 v10, v9 offset:80
    ds_read_b64_tr_b16 v[92:93], v13 offset:34816
    ds_read_b64_tr_b16 v[94:95], v13 offset:35840
    v_exp_f32_e64 v231, v231
    v_fma_f32 v216, v216, v4, v4
    v_fma_f32 v217, v217, v4, v4
    v_fma_f32 v218, v218, v4, v4
    s_waitcnt lgkmcnt(14)
    s_nop 0
    v_mfma_f32_32x32x16_bf16 v[168:183], v[100:103], v[44:47], v[168:183]
    ds_read_b64_tr_b16 v[96:97], v13 offset:36864
    ds_read_b64_tr_b16 v[98:99], v13 offset:37888
    v_fma_f32 v219, v219, v4, v4
    v_fma_f32 v220, v220, v4, v4
    v_fma_f32 v221, v221, v4, v4
    v_fma_f32 v222, v222, v4, v4
    v_fma_f32 v223, v223, v4, v4
    s_waitcnt lgkmcnt(14)
    s_nop 0
    v_mfma_f32_32x32x16_bf16 v[152:167], v[104:107], v[48:51], v[152:167]
    ds_read_b64_tr_b16 v[100:101], v13 offset:38912
    ds_read_b64_tr_b16 v[102:103], v13 offset:39936
    v_fma_f32 v224, v224, v4, v4
    v_fma_f32 v225, v225, v4, v4
    v_fma_f32 v226, v226, v4, v4
    v_fma_f32 v227, v227, v4, v4
    v_fma_f32 v228, v228, v4, v4
    s_waitcnt lgkmcnt(14)
    v_mfma_f32_32x32x16_bf16 v[168:183], v[108:111], v[48:51], v[168:183]
    ds_read_b64_tr_b16 v[104:105], v13 offset:40960
    ds_read_b64_tr_b16 v[106:107], v13 offset:41984
    v_fma_f32 v229, v229, v4, v4
    v_fma_f32 v230, v230, v4, v4
    v_fma_f32 v231, v231, v4, v4
    v_rcp_f32 v216, v216
    s_waitcnt lgkmcnt(14)
    v_mfma_f32_32x32x16_bf16 v[152:167], v[112:115], v[52:55], v[152:167]
    ds_read_b64_tr_b16 v[108:109], v13 offset:43008
    ds_read_b64_tr_b16 v[110:111], v13 offset:44032
    v_rcp_f32 v217, v217
    v_rcp_f32 v218, v218
    v_rcp_f32 v219, v219
    s_waitcnt lgkmcnt(14)
    v_mfma_f32_32x32x16_bf16 v[168:183], v[116:119], v[52:55], v[168:183]
    s_waitcnt lgkmcnt(10)
    v_cmp_gt_u32 vcc, 5, v10
    s_nop 0
    s_and_b64 vcc, vcc, s[50:51]
    s_cbranch_scc1 Lslow_183
Lfok_181:
    ds_read_b64_tr_b16 v[112:113], v13 offset:45056
    ds_read_b64_tr_b16 v[114:115], v13 offset:46080
    v_rcp_f32 v220, v220
    v_rcp_f32 v221, v221
    v_rcp_f32_e64 v222, v222
    v_mfma_f32_32x32x16_bf16 v[168:183], v[88:91], v[56:59], v[168:183]
    ds_read_b64_tr_b16 v[116:117], v13 offset:47104
    ds_read_b64_tr_b16 v[118:119], v13 offset:48128
    v_rcp_f32 v223, v223
    v_rcp_f32 v224, v224
    v_rcp_f32 v225, v225
    s_waitcnt lgkmcnt(12)
    v_mfma_f32_32x32x16_bf16 v[168:183], v[92:95], v[60:63], v[168:183]
    ds_read_b64_tr_b16 v[88:89], v12 offset:32768
    ds_read_b64_tr_b16 v[90:91], v12 offset:33792
    v_rcp_f32 v226, v226
    v_rcp_f32 v227, v227
    v_rcp_f32 v228, v228
    s_waitcnt lgkmcnt(12)
    v_mfma_f32_32x32x16_bf16 v[168:183], v[96:99], v[64:67], v[168:183]
    ds_read_b64_tr_b16 v[92:93], v12 offset:34816
    ds_read_b64_tr_b16 v[94:95], v12 offset:35840
    v_rcp_f32 v229, v229
    v_rcp_f32 v230, v230
    v_rcp_f32 v231, v231
    s_waitcnt lgkmcnt(12)
    v_mfma_f32_32x32x16_bf16 v[168:183], v[100:103], v[68:71], v[168:183]
    ds_read_b32 v10, v9 offset:32
    ds_read_b64_tr_b16 v[96:97], v12 offset:36864
    ds_read_b64_tr_b16 v[98:99], v12 offset:37888
    v_mul_f32 v216, v216, v200
    v_mul_f32 v217, v217, v201
    v_mul_f32 v218, v218, v202
    v_mul_f32 v219, v219, v203
    v_mul_f32 v220, v220, v204
    s_waitcnt lgkmcnt(13)
    v_mfma_f32_32x32x16_bf16 v[168:183], v[104:107], v[72:75], v[168:183]
    ds_read_b64_tr_b16 v[100:101], v12 offset:38912
    ds_read_b64_tr_b16 v[102:103], v12 offset:39936
    v_mul_f32 v221, v221, v205
    v_mul_f32 v222, v222, v206
    v_mul_f32 v223, v223, v207
    v_mul_f32 v224, v224, v208
    v_mul_f32 v225, v225, v209
    s_waitcnt lgkmcnt(13)
    v_mfma_f32_32x32x16_bf16 v[168:183], v[108:111], v[76:79], v[168:183]
    ds_read_b64_tr_b16 v[104:105], v12 offset:40960
    ds_read_b64_tr_b16 v[106:107], v12 offset:41984
    v_mul_f32 v226, v226, v210
    v_mul_f32 v227, v227, v211
    v_mul_f32 v228, v228, v212
    v_mul_f32 v229, v229, v213
    v_mul_f32 v230, v230, v214
    s_waitcnt lgkmcnt(13)
    v_mfma_f32_32x32x16_bf16 v[168:183], v[112:115], v[80:83], v[168:183]
    ds_read_b64_tr_b16 v[108:109], v12 offset:43008
    ds_read_b64_tr_b16 v[110:111], v12 offset:44032
    v_mul_f32_e64 v231, v231, v215
    v_cvt_pk_bf16_f32 v200, v216, v217
    v_cvt_pk_bf16_f32 v201, v218, v219
    v_cvt_pk_bf16_f32 v202, v220, v221
    v_cvt_pk_bf16_f32 v203, v222, v223
    s_waitcnt lgkmcnt(13)
    v_mfma_f32_32x32x16_bf16 v[168:183], v[116:119], v[84:87], v[168:183]
    ds_read_b64_tr_b16 v[112:113], v12 offset:45056
    ds_read_b64_tr_b16 v[114:115], v12 offset:46080
    v_cvt_pk_bf16_f32 v204, v224, v225
    v_cvt_pk_bf16_f32 v205, v226, v227
    v_cvt_pk_bf16_f32 v206, v228, v229
    v_cvt_pk_bf16_f32 v207, v230, v231
    buffer_store_dwordx4 v[200:203], v1, s[72:75], s96 offen
    buffer_store_dwordx4 v[204:207], v1, s[72:75], s96 offen offset:1024
    s_cmp_eq_u32 s78, 0
    s_cbranch_scc0 Lslow_185
Lfs_184:
    s_waitcnt lgkmcnt(13)
    v_mfma_f32_32x32x16_bf16 v[152:167], v[88:91], v[56:59], v[152:167]
    ds_read_b64_tr_b16 v[116:117], v12 offset:47104
    ds_read_b64_tr_b16 v[118:119], v12 offset:48128
    v_mov_b32 v19, 10
    s_mov_b64 exec, s[64:65]
    ds_write_b32 v9, v19 offset:48
    s_mov_b64 exec, -1
    s_waitcnt lgkmcnt(13)
    v_cmp_gt_u32 vcc, 11, v10
    v_mfma_f32_32x32x16_bf16 v[152:167], v[92:95], v[60:63], v[152:167]
    ds_write_b128 v22, v[168:171] offset:0
    s_cbranch_vccnz Lslow_188
Lfok_186:
    ds_read_b64_tr_b16 v[88:89], v14 offset:0
    ds_read_b64_tr_b16 v[90:91], v14 offset:1024
    s_waitcnt lgkmcnt(14)
    v_mfma_f32_32x32x16_bf16 v[152:167], v[96:99], v[64:67], v[152:167]
    ds_write_b128 v22, v[172:175] offset:1024
    ds_read_b64_tr_b16 v[92:93], v15 offset:0
    ds_read_b64_tr_b16 v[94:95], v15 offset:1024
    s_waitcnt lgkmcnt(14)
    v_mfma_f32_32x32x16_bf16 v[152:167], v[100:103], v[68:71], v[152:167]
    ds_write_b128 v22, v[176:179] offset:2048
    ds_read_b64_tr_b16 v[96:97], v14 offset:2048
    ds_read_b64_tr_b16 v[98:99], v14 offset:3072
    s_waitcnt lgkmcnt(14)
    v_mfma_f32_32x32x16_bf16 v[152:167], v[104:107], v[72:75], v[152:167]
    ds_write_b128 v22, v[180:183] offset:3072
    v_mov_b32 v19, 6
    s_mov_b64 exec, s[64:65]
    ds_write_b32 v9, v19 offset:64
    s_mov_b64 exec, -1
    ds_read_b64_tr_b16 v[100:101], v15 offset:2048
    ds_read_b64_tr_b16 v[102:103], v15 offset:3072
    s_waitcnt lgkmcnt(14)
    v_mfma_f32_32x32x16_bf16 v[152:167], v[108:111], v[76:79], v[152:167]
    ds_read_b64_tr_b16 v[104:105], v14 offset:4096
    ds_read_b64_tr_b16 v[106:107], v14 offset:5120
    s_waitcnt lgkmcnt(14)
    v_mfma_f32_32x32x16_bf16 v[152:167], v[112:115], v[80:83], v[152:167]
    ds_read_b64_tr_b16 v[108:109], v15 offset:4096
    ds_read_b64_tr_b16 v[110:111], v15 offset:5120
    ds_read_b32 v17, v9 offset:64
    ds_read_b128 v[216:219], v23 offset:0
    ds_read_b128 v[220:223], v23 offset:1024
    ds_read_b128 v[224:227], v23 offset:2048
    ds_read_b128 v[228:231], v23 offset:3072
    s_waitcnt lgkmcnt(14)
    v_mfma_f32_32x32x16_bf16 v[152:167], v[116:119], v[84:87], v[152:167]
    ds_read_b64_tr_b16 v[112:113], v14 offset:6144
    ds_read_b64_tr_b16 v[114:115], v14 offset:7168
    ds_read_b128 v[200:203], v18 offset:10496
    ds_read_b128 v[204:207], v18 offset:10528
    ds_read_b128 v[208:211], v18 offset:10560
    ds_read_b128 v[212:215], v18 offset:10592
    s_waitcnt lgkmcnt(14)
    v_mfma_f32_32x32x16_bf16 v[120:135], v[88:91], v[24:27], 0
    ds_read_b64_tr_b16 v[116:117], v15 offset:6144
    ds_read_b64_tr_b16 v[118:119], v15 offset:7168
    s_waitcnt lgkmcnt(12)
    v_cmp_gt_u32 vcc, 6, v17
    s_nop 0
    s_and_b64 vcc, vcc, s[50:51]
    s_cbranch_scc1 Lslow_191
Lfok_189:
    v_mov_b32 v19, 6
    s_mov_b64 exec, s[64:65]
    ds_write_b32 v9, v19 offset:80
    s_mov_b64 exec, -1
    v_mfma_f32_32x32x16_bf16 v[136:151], v[92:95], v[24:27], 0
    ds_read_b64_tr_b16 v[88:89], v14 offset:8192
    ds_read_b64_tr_b16 v[90:91], v14 offset:9216
    s_waitcnt vmcnt(0)
    buffer_store_dword v6, v7, s[72:75], s97 offen offset:1024
    s_cmp_eq_u32 s78, 0
    s_cbranch_scc0 Lslow_193
Lfs_192:
    s_waitcnt lgkmcnt(5)
    v_pk_fma_f32 v[200:201], v[200:201], v[16:17], v[216:217] op_sel_hi:[1,0,1] neg_lo:[1,0,0] neg_hi:[1,0,0]
    v_pk_fma_f32 v[202:203], v[202:203], v[16:17], v[218:219] op_sel_hi:[1,0,1] neg_lo:[1,0,0] neg_hi:[1,0,0]
    v_pk_fma_f32 v[204:205], v[204:205], v[16:17], v[220:221] op_sel_hi:[1,0,1] neg_lo:[1,0,0] neg_hi:[1,0,0]
    v_pk_fma_f32 v[206:207], v[206:207], v[16:17], v[222:223] op_sel_hi:[1,0,1] neg_lo:[1,0,0] neg_hi:[1,0,0]
    v_pk_fma_f32 v[208:209], v[208:209], v[16:17], v[224:225] op_sel_hi:[1,0,1] neg_lo:[1,0,0] neg_hi:[1,0,0]
    v_pk_fma_f32 v[210:211], v[210:211], v[16:17], v[226:227] op_sel_hi:[1,0,1] neg_lo:[1,0,0] neg_hi:[1,0,0]
    v_pk_fma_f32 v[212:213], v[212:213], v[16:17], v[228:229] op_sel_hi:[1,0,1] neg_lo:[1,0,0] neg_hi:[1,0,0]
    v_pk_fma_f32 v[214:215], v[214:215], v[16:17], v[230:231] op_sel_hi:[1,0,1] neg_lo:[1,0,0] neg_hi:[1,0,0]
    v_pk_add_f32 v[200:201], v[200:201], v[152:153]
    v_pk_add_f32 v[202:203], v[202:203], v[154:155]
    v_pk_add_f32 v[204:205], v[204:205], v[156:157]
    v_pk_add_f32 v[206:207], v[206:207], v[158:159]
    v_pk_add_f32 v[208:209], v[208:209], v[160:161]
    v_pk_add_f32 v[210:211], v[210:211], v[162:163]
    v_pk_add_f32 v[212:213], v[212:213], v[164:165]
    v_pk_add_f32 v[214:215], v[214:215], v[166:167]
    v_pk_mul_f32 v[216:217], v[200:201], v[200:201]
    v_pk_mul_f32 v[218:219], v[202:203], v[202:203]
    v_pk_mul_f32 v[220:221], v[204:205], v[204:205]
    v_pk_mul_f32 v[222:223], v[206:207], v[206:207]
    v_pk_mul_f32 v[224:225], v[208:209], v[208:209]
    v_pk_mul_f32 v[226:227], v[210:211], v[210:211]
    v_pk_mul_f32 v[228:229], v[212:213], v[212:213]
    v_pk_mul_f32 v[230:231], v[214:215], v[214:215]
    v_pk_fma_f32 v[216:217], v[216:217], v[20:21], v[20:21] op_sel:[0,0,1] op_sel_hi:[1,0,1]
    v_pk_fma_f32 v[218:219], v[218:219], v[20:21], v[20:21] op_sel:[0,0,1] op_sel_hi:[1,0,1]
    v_pk_fma_f32 v[220:221], v[220:221], v[20:21], v[20:21] op_sel:[0,0,1] op_sel_hi:[1,0,1]
    v_pk_fma_f32 v[222:223], v[222:223], v[20:21], v[20:21] op_sel:[0,0,1] op_sel_hi:[1,0,1]
    v_pk_fma_f32 v[224:225], v[224:225], v[20:21], v[20:21] op_sel:[0,0,1] op_sel_hi:[1,0,1]
    v_pk_fma_f32 v[226:227], v[226:227], v[20:21], v[20:21] op_sel:[0,0,1] op_sel_hi:[1,0,1]
    v_pk_fma_f32 v[228:229], v[228:229], v[20:21], v[20:21] op_sel:[0,0,1] op_sel_hi:[1,0,1]
    v_pk_fma_f32 v[230:231], v[230:231], v[20:21], v[20:21] op_sel:[0,0,1] op_sel_hi:[1,0,1]
    v_pk_mul_f32 v[216:217], v[216:217], v[200:201]
    v_pk_mul_f32 v[218:219], v[218:219], v[202:203]
    v_pk_mul_f32 v[220:221], v[220:221], v[204:205]
    v_pk_mul_f32 v[222:223], v[222:223], v[206:207]
    v_pk_mul_f32 v[224:225], v[224:225], v[208:209]
    v_pk_mul_f32 v[226:227], v[226:227], v[210:211]
    v_pk_mul_f32 v[228:229], v[228:229], v[212:213]
    v_pk_mul_f32 v[230:231], v[230:231], v[214:215]
    v_exp_f32 v216, v216
    v_exp_f32 v217, v217
    v_exp_f32_e64 v218, v218
    v_mfma_f32_32x32x16_bf16 v[120:135], v[96:99], v[28:31], v[120:135]
    ds_read_b64_tr_b16 v[92:93], v15 offset:8192
    ds_read_b64_tr_b16 v[94:95], v15 offset:9216
    v_exp_f32 v219, v219
    v_exp_f32 v220, v220
    v_exp_f32_e64 v221, v221
    v_mfma_f32_32x32x16_bf16 v[136:151], v[100:103], v[28:31], v[136:151]
    ds_read_b32 v10, v9 offset:32
    ds_read_b64_tr_b16 v[96:97], v14 offset:10240
    ds_read_b64_tr_b16 v[98:99], v14 offset:11264
    v_exp_f32 v222, v222
    v_exp_f32 v223, v223
    v_exp_f32_e64 v224, v224
    v_mfma_f32_32x32x16_bf16 v[120:135], v[104:107], v[32:35], v[120:135]
    ds_read_b64_tr_b16 v[100:101], v15 offset:10240
    ds_read_b64_tr_b16 v[102:103], v15 offset:11264
    v_exp_f32 v225, v225
    v_exp_f32 v226, v226
    v_exp_f32_e64 v227, v227
    v_mfma_f32_32x32x16_bf16 v[136:151], v[108:111], v[32:35], v[136:151]
    ds_read_b64_tr_b16 v[104:105], v14 offset:12288
    ds_read_b64_tr_b16 v[106:107], v14 offset:13312
    v_exp_f32 v228, v228
    v_exp_f32 v229, v229
    v_exp_f32_e64 v230, v230
    v_mfma_f32_32x32x16_bf16 v[120:135], v[112:115], v[36:39], v[120:135]
    ds_read_b64_tr_b16 v[108:109], v15 offset:12288
    ds_read_b64_tr_b16 v[110:111], v15 offset:13312
    buffer_load_dword v2, v3, s[84:87], s98 offen offset:1024 sc1
    v_exp_f32_e64 v231, v231
    v_fma_f32 v216, v216, v4, v4
    v_fma_f32 v217, v217, v4, v4
    v_fma_f32 v218, v218, v4, v4
    s_waitcnt lgkmcnt(14)
    s_nop 0
    v_mfma_f32_32x32x16_bf16 v[136:151], v[116:119], v[36:39], v[136:151]
    ds_read_b64_tr_b16 v[112:113], v14 offset:14336
    ds_read_b64_tr_b16 v[114:115], v14 offset:15360
    v_fma_f32 v219, v219, v4, v4
    v_fma_f32 v220, v220, v4, v4
    v_fma_f32 v221, v221, v4, v4
    v_fma_f32 v222, v222, v4, v4
    v_fma_f32 v223, v223, v4, v4
    s_waitcnt lgkmcnt(13)
    v_mfma_f32_32x32x16_bf16 v[120:135], v[88:91], v[40:43], v[120:135]
    ds_read_b64_tr_b16 v[116:117], v15 offset:14336
    ds_read_b64_tr_b16 v[118:119], v15 offset:15360
    v_mov_b32 v19, 11
    s_mov_b64 exec, s[64:65]
    ds_write_b32 v9, v19 offset:48
    s_mov_b64 exec, -1
    v_fma_f32 v224, v224, v4, v4
    v_fma_f32 v225, v225, v4, v4
    v_fma_f32 v226, v226, v4, v4
    v_fma_f32 v227, v227, v4, v4
    v_fma_f32 v228, v228, v4, v4
    s_waitcnt lgkmcnt(13)
    v_cmp_gt_u32 vcc, 12, v10
    v_mfma_f32_32x32x16_bf16 v[136:151], v[92:95], v[40:43], v[136:151]
    s_cbranch_vccnz Lslow_196
Lfok_194:
    ds_read_b64_tr_b16 v[88:89], v15 offset:32768
    ds_read_b64_tr_b16 v[90:91], v15 offset:33792
    v_fma_f32 v229, v229, v4, v4
    v_fma_f32 v230, v230, v4, v4
    v_fma_f32 v231, v231, v4, v4
    v_rcp_f32 v216, v216
    s_waitcnt lgkmcnt(13)
    v_mfma_f32_32x32x16_bf16 v[120:135], v[96:99], v[44:47], v[120:135]
    ds_read_b32 v10, v9 offset:80
    ds_read_b64_tr_b16 v[92:93], v15 offset:34816
    ds_read_b64_tr_b16 v[94:95], v15 offset:35840
    v_rcp_f32 v217, v217
    v_rcp_f32 v218, v218
    v_rcp_f32 v219, v219
    s_waitcnt lgkmcnt(14)
    v_mfma_f32_32x32x16_bf16 v[136:151], v[100:103], v[44:47], v[136:151]
    ds_read_b64_tr_b16 v[96:97], v15 offset:36864
    ds_read_b64_tr_b16 v[98:99], v15 offset:37888
    v_rcp_f32 v220, v220
    v_rcp_f32 v221, v221
    v_rcp_f32 v222, v222
    s_waitcnt lgkmcnt(14)
    v_mfma_f32_32x32x16_bf16 v[120:135], v[104:107], v[48:51], v[120:135]
    ds_read_b64_tr_b16 v[100:101], v15 offset:38912
    ds_read_b64_tr_b16 v[102:103], v15 offset:39936
    v_rcp_f32 v223, v223
    v_rcp_f32 v224, v224
    v_rcp_f32 v225, v225
    s_waitcnt lgkmcnt(14)
    v_mfma_f32_32x32x16_bf16 v[136:151], v[108:111], v[48:51], v[136:151]
    ds_read_b64_tr_b16 v[104:105], v15 offset:40960
    ds_read_b64_tr_b16 v[106:107], v15 offset:41984
    v_rcp_f32 v226, v226
    v_rcp_f32 v227, v227
    v_rcp_f32 v228, v228
    s_waitcnt lgkmcnt(14)
    v_mfma_f32_32x32x16_bf16 v[120:135], v[112:115], v[52:55], v[120:135]
    ds_read_b64_tr_b16 v[108:109], v15 offset:43008
    ds_read_b64_tr_b16 v[110:111], v15 offset:44032
    v_rcp_f32 v229, v229
    v_rcp_f32 v230, v230
    v_rcp_f32 v231, v231
    s_waitcnt lgkmcnt(14)
    v_mfma_f32_32x32x16_bf16 v[136:151], v[116:119], v[52:55], v[136:151]
    s_waitcnt lgkmcnt(10)
    v_cmp_gt_u32 vcc, 6, v10
    s_nop 0
    s_and_b64 vcc, vcc, s[50:51]
    s_cbranch_scc1 Lslow_199
Lfok_197:
    ds_read_b64_tr_b16 v[112:113], v15 offset:45056
    ds_read_b64_tr_b16 v[114:115], v15 offset:46080
    s_waitcnt vmcnt(0)
    v_cmp_ne_u32 vcc, s7, v2
    s_nop 0
    s_cmp_eq_u64 vcc, 0
    s_cbranch_scc0 Lslow_202
Lok_200:
    buffer_load_dwordx4 v[232:235], v1, s[84:87], s41 offen offset:0 sc1
    v_mul_f32 v216, v216, v200
    v_mul_f32 v217, v217, v201
    v_mul_f32 v218, v218, v202
    v_mul_f32 v219, v219, v203
    v_mul_f32 v220, v220, v204
    v_mfma_f32_32x32x16_bf16 v[136:151], v[88:91], v[56:59], v[136:151]
    ds_read_b64_tr_b16 v[116:117], v15 offset:47104
    ds_read_b64_tr_b16 v[118:119], v15 offset:48128
    v_mul_f32 v221, v221, v205
    v_mul_f32 v222, v222, v206
    v_mul_f32 v223, v223, v207
    v_mul_f32 v224, v224, v208
    v_mul_f32 v225, v225, v209
    s_waitcnt lgkmcnt(12)
    v_mfma_f32_32x32x16_bf16 v[136:151], v[92:95], v[60:63], v[136:151]
    ds_read_b64_tr_b16 v[88:89], v14 offset:32768
    ds_read_b64_tr_b16 v[90:91], v14 offset:33792
    buffer_load_dwordx4 v[236:239], v1, s[84:87], s41 offen offset:1024 sc1
    v_mul_f32 v226, v226, v210
    v_mul_f32 v227, v227, v211
    v_mul_f32 v228, v228, v212
    v_mul_f32 v229, v229, v213
    v_mul_f32 v230, v230, v214
    s_waitcnt lgkmcnt(12)
    v_mfma_f32_32x32x16_bf16 v[136:151], v[96:99], v[64:67], v[136:151]
    ds_read_b64_tr_b16 v[92:93], v14 offset:34816
    ds_read_b64_tr_b16 v[94:95], v14 offset:35840
    v_mul_f32_e64 v231, v231, v215
    v_cvt_pk_bf16_f32 v200, v216, v217
    v_cvt_pk_bf16_f32 v201, v218, v219
    v_cvt_pk_bf16_f32 v202, v220, v221
    v_cvt_pk_bf16_f32 v203, v222, v223
    s_waitcnt lgkmcnt(12)
    s_nop 0
    v_mfma_f32_32x32x16_bf16 v[136:151], v[100:103], v[68:71], v[136:151]
    ds_read_b32 v10, v9 offset:32
    ds_read_b64_tr_b16 v[96:97], v14 offset:36864
    ds_read_b64_tr_b16 v[98:99], v14 offset:37888
    buffer_load_dwordx4 v[240:243], v1, s[84:87], s41 offen offset:2048 sc1
    v_cvt_pk_bf16_f32 v204, v224, v225
    v_cvt_pk_bf16_f32 v205, v226, v227
    v_cvt_pk_bf16_f32 v206, v228, v229
    v_cvt_pk_bf16_f32 v207, v230, v231
    buffer_store_dwordx4 v[200:203], v1, s[72:75], s88 offen
    buffer_store_dwordx4 v[204:207], v1, s[72:75], s88 offen offset:1024
    s_cmp_eq_u32 s78, 0
    s_cbranch_scc0 Lslow_204
Lfs_203:
    s_waitcnt lgkmcnt(13)
    v_mfma_f32_32x32x16_bf16 v[136:151], v[104:107], v[72:75], v[136:151]
    ds_read_b64_tr_b16 v[100:101], v14 offset:38912
    ds_read_b64_tr_b16 v[102:103], v14 offset:39936
    s_waitcnt lgkmcnt(13)
    v_mfma_f32_32x32x16_bf16 v[136:151], v[108:111], v[76:79], v[136:151]
    ds_read_b64_tr_b16 v[104:105], v14 offset:40960
    ds_read_b64_tr_b16 v[106:107], v14 offset:41984
    buffer_load_dwordx4 v[244:247], v1, s[84:87], s41 offen offset:3072 sc1
    s_waitcnt lgkmcnt(13)
    v_mfma_f32_32x32x16_bf16 v[136:151], v[112:115], v[80:83], v[136:151]
    ds_read_b64_tr_b16 v[108:109], v14 offset:43008
    ds_read_b64_tr_b16 v[110:111], v14 offset:44032
    s_waitcnt lgkmcnt(13)
    v_mfma_f32_32x32x16_bf16 v[136:151], v[116:119], v[84:87], v[136:151]
    ds_read_b64_tr_b16 v[112:113], v14 offset:45056
    ds_read_b64_tr_b16 v[114:115], v14 offset:46080
    buffer_load_dwordx4 v[248:251], v8, s[84:87], s41 offen offset:0 sc1
    s_waitcnt lgkmcnt(13)
    v_mfma_f32_32x32x16_bf16 v[120:135], v[88:91], v[56:59], v[120:135]
    ds_read_b64_tr_b16 v[116:117], v14 offset:47104
    ds_read_b64_tr_b16 v[118:119], v14 offset:48128
    v_mov_b32 v19, 12
    s_mov_b64 exec, s[64:65]
    ds_write_b32 v9, v19 offset:48
    s_mov_b64 exec, -1
    s_waitcnt lgkmcnt(13)
    v_cmp_gt_u32 vcc, 13, v10
    v_mfma_f32_32x32x16_bf16 v[120:135], v[92:95], v[60:63], v[120:135]
    ds_write_b128 v22, v[136:139] offset:0
    s_cbranch_vccnz Lslow_207
Lfok_205:
    ds_read_b64_tr_b16 v[88:89], v12 offset:0
    ds_read_b64_tr_b16 v[90:91], v12 offset:1024
    s_waitcnt lgkmcnt(14)
    v_mfma_f32_32x32x16_bf16 v[120:135], v[96:99], v[64:67], v[120:135]
    ds_write_b128 v22, v[140:143] offset:1024
    ds_read_b64_tr_b16 v[92:93], v13 offset:0
    ds_read_b64_tr_b16 v[94:95], v13 offset:1024
    s_waitcnt lgkmcnt(14)
    v_mfma_f32_32x32x16_bf16 v[120:135], v[100:103], v[68:71], v[120:135]
    ds_write_b128 v22, v[144:147] offset:2048
    ds_read_b64_tr_b16 v[96:97], v12 offset:2048
    ds_read_b64_tr_b16 v[98:99], v12 offset:3072
    s_waitcnt lgkmcnt(14)
    v_mfma_f32_32x32x16_bf16 v[120:135], v[104:107], v[72:75], v[120:135]
    ds_write_b128 v22, v[148:151] offset:3072
    v_mov_b32 v19, 7
    s_mov_b64 exec, s[64:65]
    ds_write_b32 v9, v19 offset:64
    s_mov_b64 exec, -1
    ds_read_b64_tr_b16 v[100:101], v13 offset:2048
    ds_read_b64_tr_b16 v[102:103], v13 offset:3072
    s_waitcnt lgkmcnt(14)
    v_mfma_f32_32x32x16_bf16 v[120:135], v[108:111], v[76:79], v[120:135]
    ds_read_b64_tr_b16 v[104:105], v12 offset:4096
    ds_read_b64_tr_b16 v[106:107], v12 offset:5120
    s_waitcnt vmcnt(2)
    buffer_store_dword v6, v7, s[72:75], s97 offen offset:1280
    s_cmp_eq_u32 s78, 0
    s_cbranch_scc0 Lslow_209
Lfs_208:
    s_waitcnt lgkmcnt(14)
    v_mfma_f32_32x32x16_bf16 v[120:135], v[112:115], v[80:83], v[120:135]
    ds_read_b64_tr_b16 v[108:109], v13 offset:4096
    ds_read_b64_tr_b16 v[110:111], v13 offset:5120
    ds_read_b32 v17, v9 offset:64
    ds_read_b128 v[216:219], v23 offset:0
    ds_read_b128 v[220:223], v23 offset:1024
    ds_read_b128 v[224:227], v23 offset:2048
    ds_read_b128 v[228:231], v23 offset:3072
    s_waitcnt lgkmcnt(14)
    v_mfma_f32_32x32x16_bf16 v[120:135], v[116:119], v[84:87], v[120:135]
    ds_read_b64_tr_b16 v[112:113], v12 offset:6144
    ds_read_b64_tr_b16 v[114:115], v12 offset:7168
    ds_read_b128 v[200:203], v18 offset:10752
    ds_read_b128 v[204:207], v18 offset:10784
    ds_read_b128 v[208:211], v18 offset:10816
    ds_read_b128 v[212:215], v18 offset:10848
    s_waitcnt lgkmcnt(14)
    v_mfma_f32_32x32x16_bf16 v[152:167], v[88:91], v[24:27], 0
    ds_read_b64_tr_b16 v[116:117], v13 offset:6144
    ds_read_b64_tr_b16 v[118:119], v13 offset:7168
    buffer_load_dwordx4 v[24:27], v8, s[84:87], s41 offen offset:1024 sc1
    s_waitcnt lgkmcnt(12)
    v_cmp_gt_u32 vcc, 7, v17
    s_nop 0
    s_and_b64 vcc, vcc, s[50:51]
    s_cbranch_scc1 Lslow_212
Lfok_210:
    v_mov_b32 v19, 7
    s_mov_b64 exec, s[64:65]
    ds_write_b32 v9, v19 offset:80
    s_mov_b64 exec, -1
    v_mfma_f32_32x32x16_bf16 v[152:167], v[92:95], v[56:59], v[152:167]
    ds_read_b64_tr_b16 v[88:89], v12 offset:8192
    ds_read_b64_tr_b16 v[90:91], v12 offset:9216
    s_waitcnt lgkmcnt(5)
    s_nop 0
    v_pk_fma_f32 v[200:201], v[200:201], v[16:17], v[216:217] op_sel_hi:[1,0,1] neg_lo:[1,0,0] neg_hi:[1,0,0]
    v_pk_fma_f32 v[202:203], v[202:203], v[16:17], v[218:219] op_sel_hi:[1,0,1] neg_lo:[1,0,0] neg_hi:[1,0,0]
    v_pk_fma_f32 v[204:205], v[204:205], v[16:17], v[220:221] op_sel_hi:[1,0,1] neg_lo:[1,0,0] neg_hi:[1,0,0]
    v_pk_fma_f32 v[206:207], v[206:207], v[16:17], v[222:223] op_sel_hi:[1,0,1] neg_lo:[1,0,0] neg_hi:[1,0,0]
    v_pk_fma_f32 v[208:209], v[208:209], v[16:17], v[224:225] op_sel_hi:[1,0,1] neg_lo:[1,0,0] neg_hi:[1,0,0]
    v_pk_fma_f32 v[210:211], v[210:211], v[16:17], v[226:227] op_sel_hi:[1,0,1] neg_lo:[1,0,0] neg_hi:[1,0,0]
    v_pk_fma_f32 v[212:213], v[212:213], v[16:17], v[228:229] op_sel_hi:[1,0,1] neg_lo:[1,0,0] neg_hi:[1,0,0]
    v_pk_fma_f32 v[214:215], v[214:215], v[16:17], v[230:231] op_sel_hi:[1,0,1] neg_lo:[1,0,0] neg_hi:[1,0,0]
    v_pk_add_f32 v[200:201], v[200:201], v[120:121]
    v_pk_add_f32 v[202:203], v[202:203], v[122:123]
    v_pk_add_f32 v[204:205], v[204:205], v[124:125]
    v_pk_add_f32 v[206:207], v[206:207], v[126:127]
    v_pk_add_f32 v[208:209], v[208:209], v[128:129]
    v_pk_add_f32 v[210:211], v[210:211], v[130:131]
    v_pk_add_f32 v[212:213], v[212:213], v[132:133]
    v_pk_add_f32 v[214:215], v[214:215], v[134:135]
    v_pk_mul_f32 v[216:217], v[200:201], v[200:201]
    v_pk_mul_f32 v[218:219], v[202:203], v[202:203]
    v_pk_mul_f32 v[220:221], v[204:205], v[204:205]
    v_pk_mul_f32 v[222:223], v[206:207], v[206:207]
    v_pk_mul_f32 v[224:225], v[208:209], v[208:209]
    v_pk_mul_f32 v[226:227], v[210:211], v[210:211]
    v_pk_mul_f32 v[228:229], v[212:213], v[212:213]
    v_pk_mul_f32 v[230:231], v[214:215], v[214:215]
    v_pk_fma_f32 v[216:217], v[216:217], v[20:21], v[20:21] op_sel:[0,0,1] op_sel_hi:[1,0,1]
    v_pk_fma_f32 v[218:219], v[218:219], v[20:21], v[20:21] op_sel:[0,0,1] op_sel_hi:[1,0,1]
    v_pk_fma_f32 v[220:221], v[220:221], v[20:21], v[20:21] op_sel:[0,0,1] op_sel_hi:[1,0,1]
    v_pk_fma_f32 v[222:223], v[222:223], v[20:21], v[20:21] op_sel:[0,0,1] op_sel_hi:[1,0,1]
    v_pk_fma_f32 v[224:225], v[224:225], v[20:21], v[20:21] op_sel:[0,0,1] op_sel_hi:[1,0,1]
    v_pk_fma_f32 v[226:227], v[226:227], v[20:21], v[20:21] op_sel:[0,0,1] op_sel_hi:[1,0,1]
    v_pk_fma_f32 v[228:229], v[228:229], v[20:21], v[20:21] op_sel:[0,0,1] op_sel_hi:[1,0,1]
    v_pk_fma_f32 v[230:231], v[230:231], v[20:21], v[20:21] op_sel:[0,0,1] op_sel_hi:[1,0,1]
    v_pk_mul_f32 v[216:217], v[216:217], v[200:201]
    v_pk_mul_f32 v[218:219], v[218:219], v[202:203]
    v_pk_mul_f32 v[220:221], v[220:221], v[204:205]
    v_pk_mul_f32 v[222:223], v[222:223], v[206:207]
    v_pk_mul_f32 v[224:225], v[224:225], v[208:209]
    v_pk_mul_f32 v[226:227], v[226:227], v[210:211]
    v_pk_mul_f32 v[228:229], v[228:229], v[212:213]
    v_pk_mul_f32 v[230:231], v[230:231], v[214:215]
    v_exp_f32 v216, v216
    v_exp_f32 v217, v217
    v_exp_f32_e64 v218, v218
    v_mfma_f32_32x32x16_bf16 v[152:167], v[96:99], v[28:31], v[152:167]
    ds_read_b64_tr_b16 v[92:93], v13 offset:8192
    ds_read_b64_tr_b16 v[94:95], v13 offset:9216
    buffer_load_dwordx4 v[56:59], v8, s[84:87], s41 offen offset:2048 sc1
    v_exp_f32 v219, v219
    v_exp_f32 v220, v220
    v_exp_f32_e64 v221, v221
    v_mfma_f32_32x32x16_bf16 v[152:167], v[100:103], v[60:63], v[152:167]
    ds_read_b32 v10, v9 offset:32
    ds_read_b64_tr_b16 v[96:97], v12 offset:10240
    ds_read_b64_tr_b16 v[98:99], v12 offset:11264
    v_exp_f32 v222, v222
    v_exp_f32 v223, v223
    v_exp_f32_e64 v224, v224
    v_mfma_f32_32x32x16_bf16 v[152:167], v[104:107], v[32:35], v[152:167]
    ds_read_b64_tr_b16 v[100:101], v13 offset:10240
    ds_read_b64_tr_b16 v[102:103], v13 offset:11264
    buffer_load_dwordx4 v[28:31], v8, s[84:87], s41 offen offset:3072 sc1
    v_exp_f32 v225, v225
    v_exp_f32 v226, v226
    v_exp_f32_e64 v227, v227
    v_mfma_f32_32x32x16_bf16 v[152:167], v[108:111], v[64:67], v[152:167]
    ds_read_b64_tr_b16 v[104:105], v12 offset:12288
    ds_read_b64_tr_b16 v[106:107], v12 offset:13312
    v_exp_f32 v228, v228
    v_exp_f32 v229, v229
    v_exp_f32_e64 v230, v230
    v_mfma_f32_32x32x16_bf16 v[152:167], v[112:115], v[36:39], v[152:167]
    ds_read_b64_tr_b16 v[108:109], v13 offset:12288
    ds_read_b64_tr_b16 v[110:111], v13 offset:13312
    s_add_u32 s41, s41, 8192
    buffer_load_dwordx4 v[60:63], v1, s[84:87], s41 offen offset:0 sc1
    v_exp_f32_e64 v231, v231
    v_fma_f32 v216, v216, v4, v4
    v_fma_f32 v217, v217, v4, v4
    v_fma_f32 v218, v218, v4, v4
    s_waitcnt lgkmcnt(14)
    s_nop 0
    v_mfma_f32_32x32x16_bf16 v[152:167], v[116:119], v[68:71], v[152:167]
    ds_read_b64_tr_b16 v[112:113], v12 offset:14336
    ds_read_b64_tr_b16 v[114:115], v12 offset:15360
    v_fma_f32 v219, v219, v4, v4
    v_fma_f32 v220, v220, v4, v4
    v_fma_f32 v221, v221, v4, v4
    v_fma_f32 v222, v222, v4, v4
    v_fma_f32 v223, v223, v4, v4
    s_waitcnt lgkmcnt(13)
    v_mfma_f32_32x32x16_bf16 v[152:167], v[88:91], v[40:43], v[152:167]
    ds_read_b64_tr_b16 v[116:117], v13 offset:14336
    ds_read_b64_tr_b16 v[118:119], v13 offset:15360
    v_mov_b32 v19, 13
    s_mov_b64 exec, s[64:65]
    ds_write_b32 v9, v19 offset:48
    s_mov_b64 exec, -1
    buffer_load_dwordx4 v[32:35], v1, s[84:87], s41 offen offset:1024 sc1
    v_fma_f32 v224, v224, v4, v4
    v_fma_f32 v225, v225, v4, v4
    v_fma_f32 v226, v226, v4, v4
    v_fma_f32 v227, v227, v4, v4
    v_fma_f32 v228, v228, v4, v4
    s_waitcnt lgkmcnt(13)
    v_cmp_gt_u32 vcc, 14, v10
    v_mfma_f32_32x32x16_bf16 v[152:167], v[92:95], v[72:75], v[152:167]
    s_cbranch_vccnz Lslow_215
Lfok_213:
    ds_read_b64_tr_b16 v[88:89], v12 offset:32768
    ds_read_b64_tr_b16 v[90:91], v12 offset:33792
    v_fma_f32 v229, v229, v4, v4
    v_fma_f32 v230, v230, v4, v4
    v_fma_f32 v231, v231, v4, v4
    v_rcp_f32 v216, v216
    s_waitcnt lgkmcnt(13)
    v_mfma_f32_32x32x16_bf16 v[152:167], v[96:99], v[44:47], v[152:167]
    ds_read_b32 v10, v9 offset:80
    ds_read_b64_tr_b16 v[92:93], v13 offset:32768
    ds_read_b64_tr_b16 v[94:95], v13 offset:33792
    buffer_load_dwordx4 v[64:67], v1, s[84:87], s41 offen offset:2048 sc1
    v_rcp_f32 v217, v217
    v_rcp_f32 v218, v218
    v_rcp_f32 v219, v219
    s_waitcnt lgkmcnt(14)
    v_mfma_f32_32x32x16_bf16 v[152:167], v[100:103], v[76:79], v[152:167]
    ds_read_b64_tr_b16 v[96:97], v12 offset:34816
    ds_read_b64_tr_b16 v[98:99], v12 offset:35840
    v_rcp_f32 v220, v220
    v_rcp_f32 v221, v221
    v_rcp_f32 v222, v222
    s_waitcnt lgkmcnt(14)
    v_mfma_f32_32x32x16_bf16 v[152:167], v[104:107], v[48:51], v[152:167]
    ds_read_b64_tr_b16 v[100:101], v13 offset:34816
    ds_read_b64_tr_b16 v[102:103], v13 offset:35840
    buffer_load_dwordx4 v[36:39], v1, s[84:87], s41 offen offset:3072 sc1
    v_rcp_f32 v223, v223
    v_rcp_f32 v224, v224
    v_rcp_f32 v225, v225
    s_waitcnt lgkmcnt(14)
    v_mfma_f32_32x32x16_bf16 v[152:167], v[108:111], v[80:83], v[152:167]
    ds_read_b64_tr_b16 v[104:105], v12 offset:36864
    ds_read_b64_tr_b16 v[106:107], v12 offset:37888
    v_rcp_f32 v226, v226
    v_rcp_f32 v227, v227
    v_rcp_f32 v228, v228
    s_waitcnt lgkmcnt(14)
    v_mfma_f32_32x32x16_bf16 v[152:167], v[112:115], v[52:55], v[152:167]
    ds_read_b64_tr_b16 v[108:109], v13 offset:36864
    ds_read_b64_tr_b16 v[110:111], v13 offset:37888
    buffer_load_dwordx4 v[68:71], v8, s[84:87], s41 offen offset:0 sc1
    v_rcp_f32 v229, v229
    v_rcp_f32 v230, v230
    v_rcp_f32 v231, v231
    s_waitcnt lgkmcnt(14)
    v_mfma_f32_32x32x16_bf16 v[152:167], v[116:119], v[84:87], v[152:167]
    s_waitcnt lgkmcnt(10)
    v_cmp_gt_u32 vcc, 7, v10
    s_nop 0
    s_and_b64 vcc, vcc, s[50:51]
    s_cbranch_scc1 Lslow_218
Lfok_216:
    ds_read_b64_tr_b16 v[112:113], v12 offset:38912
    ds_read_b64_tr_b16 v[114:115], v12 offset:39936
    v_mul_f32 v216, v216, v200
    v_mul_f32 v217, v217, v201
    v_mul_f32 v218, v218, v202
    v_mul_f32 v219, v219, v203
    v_mul_f32_e64 v220, v220, v204
    v_mfma_f32_32x32x16_bf16 v[168:183], v[88:91], v[232:235], 0
    ds_read_b64_tr_b16 v[116:117], v13 offset:38912
    ds_read_b64_tr_b16 v[118:119], v13 offset:39936
    buffer_load_dwordx4 v[40:43], v8, s[84:87], s41 offen offset:1024 sc1
    v_mul_f32 v221, v221, v205
    v_mul_f32 v222, v222, v206
    v_mul_f32 v223, v223, v207
    v_mul_f32 v224, v224, v208
    v_mul_f32 v225, v225, v209
    s_waitcnt lgkmcnt(12)
    v_mfma_f32_32x32x16_bf16 v[136:151], v[92:95], v[232:235], 0
    ds_read_b64_tr_b16 v[88:89], v12 offset:40960
    ds_read_b64_tr_b16 v[90:91], v12 offset:41984
    v_mul_f32 v226, v226, v210
    v_mul_f32 v227, v227, v211
    v_mul_f32 v228, v228, v212
    v_mul_f32 v229, v229, v213
    v_mul_f32 v230, v230, v214
    s_waitcnt lgkmcnt(12)
    v_mfma_f32_32x32x16_bf16 v[168:183], v[96:99], v[236:239], v[168:183]
    ds_write_b128 v22, v[160:163] offset:0
    ds_read_b64_tr_b16 v[92:93], v13 offset:40960
    ds_read_b64_tr_b16 v[94:95], v13 offset:41984
    buffer_load_dwordx4 v[72:75], v8, s[84:87], s41 offen offset:2048 sc1
    v_mul_f32_e64 v231, v231, v215
    v_cvt_pk_bf16_f32 v200, v216, v217
    v_cvt_pk_bf16_f32 v201, v218, v219
    v_cvt_pk_bf16_f32 v202, v220, v221
    v_cvt_pk_bf16_f32 v203, v222, v223
    s_waitcnt lgkmcnt(13)
    v_mfma_f32_32x32x16_bf16 v[136:151], v[100:103], v[236:239], v[136:151]
    ds_write_b128 v22, v[164:167] offset:1024
    v_mov_b32 v19, 8
    s_mov_b64 exec, s[64:65]
    ds_write_b32 v9, v19 offset:64
    s_mov_b64 exec, -1
    ds_read_b32 v10, v9 offset:32
    ds_read_b64_tr_b16 v[96:97], v12 offset:43008
    ds_read_b64_tr_b16 v[98:99], v12 offset:44032
    buffer_load_dword v3, v11, s[84:87], s98 offen offset:1280 sc1
    v_cvt_pk_bf16_f32 v204, v224, v225
    v_cvt_pk_bf16_f32 v205, v226, v227
    v_cvt_pk_bf16_f32 v206, v228, v229
    v_cvt_pk_bf16_f32 v207, v230, v231
    buffer_store_dwordx4 v[200:203], v1, s[72:75], s89 offen
    buffer_store_dwordx4 v[204:207], v1, s[72:75], s89 offen offset:1024
    s_cmp_eq_u32 s78, 0
    s_cbranch_scc0 Lslow_220
Lfs_219:
    s_waitcnt lgkmcnt(14)
    v_mfma_f32_32x32x16_bf16 v[168:183], v[104:107], v[240:243], v[168:183]
    ds_read_b64_tr_b16 v[100:101], v13 offset:43008
    ds_read_b64_tr_b16 v[102:103], v13 offset:44032
    buffer_load_dwordx4 v[44:47], v8, s[84:87], s41 offen offset:3072 sc1
    s_waitcnt lgkmcnt(14)
    v_mfma_f32_32x32x16_bf16 v[136:151], v[108:111], v[240:243], v[136:151]
    ds_read_b64_tr_b16 v[104:105], v12 offset:45056
    ds_read_b64_tr_b16 v[106:107], v12 offset:46080
    s_waitcnt vmcnt(16) lgkmcnt(14)
    v_mfma_f32_32x32x16_bf16 v[168:183], v[112:115], v[244:247], v[168:183]
    ds_read_b64_tr_b16 v[108:109], v13 offset:45056
    ds_read_b64_tr_b16 v[110:111], v13 offset:46080
    s_waitcnt lgkmcnt(14)
    v_mfma_f32_32x32x16_bf16 v[136:151], v[116:119], v[244:247], v[136:151]
    ds_read_b64_tr_b16 v[112:113], v12 offset:47104
    ds_read_b64_tr_b16 v[114:115], v12 offset:48128
    ds_read_b32 v17, v9 offset:64
    ds_read_b128 v[216:219], v23 offset:0
    ds_read_b128 v[220:223], v23 offset:1024
    s_lshl_b32 s3, s14, 6
    v_subrev_u32 v215, s3, v18
    s_waitcnt vmcnt(15) lgkmcnt(14)
    v_mfma_f32_32x32x16_bf16 v[168:183], v[88:91], v[248:251], v[168:183]
    ds_read_b64_tr_b16 v[116:117], v13 offset:47104
    ds_read_b64_tr_b16 v[118:119], v13 offset:48128
    v_mov_b32 v19, 14
    s_mov_b64 exec, s[64:65]
    ds_write_b32 v9, v19 offset:48
    s_mov_b64 exec, -1
    ds_read_b128 v[200:203], v215 offset:11008
    ds_read_b128 v[204:207], v215 offset:11040
    s_waitcnt lgkmcnt(14)
    v_cmp_gt_u32 vcc, 15, v10
    v_mfma_f32_32x32x16_bf16 v[136:151], v[92:95], v[248:251], v[136:151]
    s_cbranch_vccnz Lslow_223
Lfok_221:
    ds_read_b64_tr_b16 v[88:89], v14 offset:0
    ds_read_b64_tr_b16 v[90:91], v14 offset:1024
    s_waitcnt lgkmcnt(9)
    v_cmp_gt_u32 vcc, 8, v17
    s_nop 0
    s_and_b64 vcc, vcc, s[50:51]
    s_cbranch_scc1 Lslow_226
Lfok_224:
    v_mov_b32 v19, 8
    s_mov_b64 exec, s[64:65]
    ds_write_b32 v9, v19 offset:80
    s_mov_b64 exec, -1
    s_waitcnt lgkmcnt(3)
    v_pk_fma_f32 v[200:201], v[200:201], v[16:17], v[216:217] op_sel_hi:[1,0,1] neg_lo:[1,0,0] neg_hi:[1,0,0]
    v_pk_fma_f32 v[202:203], v[202:203], v[16:17], v[218:219] op_sel_hi:[1,0,1] neg_lo:[1,0,0] neg_hi:[1,0,0]
    v_pk_fma_f32 v[204:205], v[204:205], v[16:17], v[220:221] op_sel_hi:[1,0,1] neg_lo:[1,0,0] neg_hi:[1,0,0]
    v_pk_fma_f32 v[206:207], v[206:207], v[16:17], v[222:223] op_sel_hi:[1,0,1] neg_lo:[1,0,0] neg_hi:[1,0,0]
    v_pk_add_f32 v[200:201], v[200:201], v[152:153]
    v_pk_add_f32 v[202:203], v[202:203], v[154:155]
    v_pk_add_f32 v[204:205], v[204:205], v[156:157]
    v_pk_add_f32 v[206:207], v[206:207], v[158:159]
    v_pk_mul_f32 v[216:217], v[200:201], v[200:201]
    v_pk_mul_f32 v[218:219], v[202:203], v[202:203]
    v_pk_mul_f32 v[220:221], v[204:205], v[204:205]
    v_pk_mul_f32 v[222:223], v[206:207], v[206:207]
    v_pk_fma_f32 v[216:217], v[216:217], v[20:21], v[20:21] op_sel:[0,0,1] op_sel_hi:[1,0,1]
    v_pk_fma_f32 v[218:219], v[218:219], v[20:21], v[20:21] op_sel:[0,0,1] op_sel_hi:[1,0,1]
    v_pk_fma_f32 v[220:221], v[220:221], v[20:21], v[20:21] op_sel:[0,0,1] op_sel_hi:[1,0,1]
    v_pk_fma_f32 v[222:223], v[222:223], v[20:21], v[20:21] op_sel:[0,0,1] op_sel_hi:[1,0,1]
    v_pk_mul_f32 v[216:217], v[216:217], v[200:201]
    v_pk_mul_f32 v[218:219], v[218:219], v[202:203]
    v_pk_mul_f32 v[220:221], v[220:221], v[204:205]
    v_pk_mul_f32 v[222:223], v[222:223], v[206:207]
    v_exp_f32 v216, v216
    v_exp_f32 v217, v217
    v_exp_f32 v218, v218
    s_waitcnt vmcnt(13)
    v_mfma_f32_32x32x16_bf16 v[168:183], v[96:99], v[24:27], v[168:183]
    ds_read_b64_tr_b16 v[92:93], v15 offset:0
    ds_read_b64_tr_b16 v[94:95], v15 offset:1024
    v_exp_f32 v219, v219
    v_exp_f32 v220, v220
    v_exp_f32_e64 v221, v221
    v_mfma_f32_32x32x16_bf16 v[136:151], v[100:103], v[24:27], v[136:151]
    ds_read_b64_tr_b16 v[96:97], v14 offset:2048
    ds_read_b64_tr_b16 v[98:99], v14 offset:3072
    v_exp_f32 v222, v222
    v_exp_f32 v223, v223
    v_fma_f32 v216, v216, v4, v4
    s_waitcnt vmcnt(12)
    v_mfma_f32_32x32x16_bf16 v[168:183], v[104:107], v[56:59], v[168:183]
    ds_read_b64_tr_b16 v[100:101], v15 offset:2048
    ds_read_b64_tr_b16 v[102:103], v15 offset:3072
    s_waitcnt vmcnt(3)
    v_cmp_ne_u32 vcc, s7, v3
    s_nop 0
    s_cmp_eq_u64 vcc, 0
    s_cbranch_scc0 Lslow_229
Lok_227:
    buffer_load_dwordx4 v[76:79], v1, s[84:87], s92 offen offset:0 sc1
    v_fma_f32 v217, v217, v4, v4
    v_fma_f32 v218, v218, v4, v4
    v_fma_f32 v219, v219, v4, v4
    v_fma_f32 v220, v220, v4, v4
    v_fma_f32 v221, v221, v4, v4
    v_mfma_f32_32x32x16_bf16 v[136:151], v[108:111], v[56:59], v[136:151]
    ds_read_b64_tr_b16 v[104:105], v14 offset:4096
    ds_read_b64_tr_b16 v[106:107], v14 offset:5120
    s_waitcnt vmcnt(2)
    buffer_store_dword v6, v7, s[72:75], s97 offen offset:1536
    s_cmp_eq_u32 s78, 0
    s_cbranch_scc0 Lslow_231
Lfs_230:
    buffer_load_dwordx4 v[48:51], v1, s[84:87], s92 offen offset:1024 sc1
    v_fma_f32 v222, v222, v4, v4
    v_fma_f32 v223, v223, v4, v4
    v_rcp_f32 v216, v216
    v_rcp_f32_e64 v217, v217
    v_mfma_f32_32x32x16_bf16 v[168:183], v[112:115], v[28:31], v[168:183]
    ds_read_b64_tr_b16 v[108:109], v15 offset:4096
    ds_read_b64_tr_b16 v[110:111], v15 offset:5120
    buffer_load_dwordx4 v[80:83], v1, s[84:87], s92 offen offset:2048 sc1
    v_rcp_f32 v218, v218
    v_rcp_f32 v219, v219
    v_rcp_f32_e64 v220, v220
    v_mfma_f32_32x32x16_bf16 v[136:151], v[116:119], v[28:31], v[136:151]
    ds_read_b64_tr_b16 v[112:113], v14 offset:6144
    ds_read_b64_tr_b16 v[114:115], v14 offset:7168
    buffer_load_dwordx4 v[52:55], v1, s[84:87], s92 offen offset:3072 sc1
    v_rcp_f32 v221, v221
    v_rcp_f32 v222, v222
    v_rcp_f32 v223, v223
    s_waitcnt lgkmcnt(13)
    v_mfma_f32_32x32x16_bf16 v[168:183], v[88:91], v[60:63], v[168:183]
    ds_read_b64_tr_b16 v[116:117], v15 offset:6144
    ds_read_b64_tr_b16 v[118:119], v15 offset:7168
    v_mul_f32 v216, v216, v200
    v_mul_f32 v217, v217, v201
    v_mul_f32 v218, v218, v202
    v_mul_f32 v219, v219, v203
    v_mul_f32 v220, v220, v204
    s_waitcnt lgkmcnt(12)
    v_mfma_f32_32x32x16_bf16 v[136:151], v[92:95], v[60:63], v[136:151]
    ds_read_b64_tr_b16 v[88:89], v14 offset:8192
    ds_read_b64_tr_b16 v[90:91], v14 offset:9216
    buffer_load_dwordx4 v[84:87], v8, s[84:87], s92 offen offset:0 sc1
    v_mul_f32 v221, v221, v205
    v_mul_f32 v222, v222, v206
    v_mul_f32_e64 v223, v223, v207
    v_cvt_pk_bf16_f32 v200, v216, v217
    v_cvt_pk_bf16_f32 v201, v218, v219
    s_waitcnt lgkmcnt(12)
    v_mfma_f32_32x32x16_bf16 v[168:183], v[96:99], v[32:35], v[168:183]
    ds_read_b64_tr_b16 v[92:93], v15 offset:8192
    ds_read_b64_tr_b16 v[94:95], v15 offset:9216
    v_cvt_pk_bf16_f32 v202, v220, v221
    v_cvt_pk_bf16_f32 v203, v222, v223
    buffer_store_dwordx4 v[200:203], v1, s[72:75], s90 offen
    s_cmp_eq_u32 s78, 0
    s_cbranch_scc0 Lslow_233
Lfs_232:
    s_waitcnt lgkmcnt(12)
    v_mfma_f32_32x32x16_bf16 v[136:151], v[100:103], v[32:35], v[136:151]
    ds_read_b32 v10, v9 offset:32
    ds_read_b64_tr_b16 v[96:97], v14 offset:10240
    ds_read_b64_tr_b16 v[98:99], v14 offset:11264
    buffer_load_dwordx4 v[232:235], v8, s[84:87], s92 offen offset:1024 sc1
    s_waitcnt lgkmcnt(13)
    v_mfma_f32_32x32x16_bf16 v[168:183], v[104:107], v[64:67], v[168:183]
    ds_read_b64_tr_b16 v[100:101], v15 offset:10240
    ds_read_b64_tr_b16 v[102:103], v15 offset:11264
    s_waitcnt lgkmcnt(13)
    v_mfma_f32_32x32x16_bf16 v[136:151], v[108:111], v[64:67], v[136:151]
    ds_read_b64_tr_b16 v[104:105], v14 offset:12288
    ds_read_b64_tr_b16 v[106:107], v14 offset:13312
    buffer_load_dwordx4 v[236:239], v8, s[84:87], s92 offen offset:2048 sc1
    s_waitcnt lgkmcnt(13)
    v_mfma_f32_32x32x16_bf16 v[168:183], v[112:115], v[36:39], v[168:183]
    ds_read_b64_tr_b16 v[108:109], v15 offset:12288
    ds_read_b64_tr_b16 v[110:111], v15 offset:13312
    s_waitcnt lgkmcnt(13)
    v_mfma_f32_32x32x16_bf16 v[136:151], v[116:119], v[36:39], v[136:151]
    ds_read_b64_tr_b16 v[112:113], v14 offset:14336
    ds_read_b64_tr_b16 v[114:115], v14 offset:15360
    buffer_load_dwordx4 v[240:243], v8, s[84:87], s92 offen offset:3072 sc1
    s_waitcnt lgkmcnt(13)
    v_mfma_f32_32x32x16_bf16 v[168:183], v[88:91], v[68:71], v[168:183]
    ds_read_b64_tr_b16 v[116:117], v15 offset:14336
    ds_read_b64_tr_b16 v[118:119], v15 offset:15360
    v_mov_b32 v19, 15
    s_mov_b64 exec, s[64:65]
    ds_write_b32 v9, v19 offset:48
    s_mov_b64 exec, -1
    s_waitcnt lgkmcnt(13)
    v_cmp_gt_u32 vcc, 16, v10
    v_mfma_f32_32x32x16_bf16 v[136:151], v[92:95], v[68:71], v[136:151]
    s_cbranch_vccnz Lslow_236
Lfok_234:
    ds_read_b64_tr_b16 v[88:89], v14 offset:32768
    ds_read_b64_tr_b16 v[90:91], v14 offset:33792
    s_add_u32 s92, s92, 8192
    buffer_load_dwordx4 v[244:247], v1, s[84:87], s92 offen offset:0 sc1
    s_waitcnt lgkmcnt(13)
    v_mfma_f32_32x32x16_bf16 v[168:183], v[96:99], v[40:43], v[168:183]
    ds_read_b64_tr_b16 v[92:93], v15 offset:32768
    ds_read_b64_tr_b16 v[94:95], v15 offset:33792
    s_waitcnt lgkmcnt(13)
    v_mfma_f32_32x32x16_bf16 v[136:151], v[100:103], v[40:43], v[136:151]
    ds_read_b64_tr_b16 v[96:97], v14 offset:34816
    ds_read_b64_tr_b16 v[98:99], v14 offset:35840
    buffer_load_dwordx4 v[248:251], v1, s[84:87], s92 offen offset:1024 sc1
    s_waitcnt lgkmcnt(13)
    v_mfma_f32_32x32x16_bf16 v[168:183], v[104:107], v[72:75], v[168:183]
    ds_read_b64_tr_b16 v[100:101], v15 offset:34816
    ds_read_b64_tr_b16 v[102:103], v15 offset:35840
    s_waitcnt vmcnt(5)
    buffer_store_dword v6, v7, s[72:75], s97 offen offset:1792
    s_cmp_eq_u32 s78, 0
    s_cbranch_scc0 Lslow_238
Lfs_237:
    s_waitcnt lgkmcnt(13)
    v_mfma_f32_32x32x16_bf16 v[136:151], v[108:111], v[72:75], v[136:151]
    ds_read_b64_tr_b16 v[104:105], v14 offset:36864
    ds_read_b64_tr_b16 v[106:107], v14 offset:37888
    buffer_load_dwordx4 v[24:27], v1, s[84:87], s92 offen offset:2048 sc1
    s_waitcnt lgkmcnt(13)
    v_mfma_f32_32x32x16_bf16 v[168:183], v[112:115], v[44:47], v[168:183]
    ds_read_b64_tr_b16 v[108:109], v15 offset:36864
    ds_read_b64_tr_b16 v[110:111], v15 offset:37888
    s_waitcnt lgkmcnt(13)
    v_mfma_f32_32x32x16_bf16 v[136:151], v[116:119], v[44:47], v[136:151]
    ds_read_b64_tr_b16 v[112:113], v14 offset:38912
    ds_read_b64_tr_b16 v[114:115], v14 offset:39936
    buffer_load_dwordx4 v[56:59], v1, s[84:87], s92 offen offset:3072 sc1
    s_waitcnt lgkmcnt(12)
    v_mfma_f32_32x32x16_bf16 v[168:183], v[88:91], v[76:79], v[168:183]
    ds_read_b64_tr_b16 v[116:117], v15 offset:38912
    ds_read_b64_tr_b16 v[118:119], v15 offset:39936
    s_waitcnt lgkmcnt(12)
    v_mfma_f32_32x32x16_bf16 v[136:151], v[92:95], v[76:79], v[136:151]
    ds_read_b64_tr_b16 v[88:89], v14 offset:40960
    ds_read_b64_tr_b16 v[90:91], v14 offset:41984
    buffer_load_dwordx4 v[28:31], v8, s[84:87], s92 offen offset:0 sc1
    s_waitcnt lgkmcnt(12)
    v_mfma_f32_32x32x16_bf16 v[168:183], v[96:99], v[48:51], v[168:183]
    ds_read_b64_tr_b16 v[92:93], v15 offset:40960
    ds_read_b64_tr_b16 v[94:95], v15 offset:41984
    s_waitcnt lgkmcnt(12)
    v_mfma_f32_32x32x16_bf16 v[136:151], v[100:103], v[48:51], v[136:151]
    ds_read_b32 v10, v9 offset:32
    ds_read_b64_tr_b16 v[96:97], v14 offset:43008
    ds_read_b64_tr_b16 v[98:99], v14 offset:44032
    buffer_load_dword v2, v11, s[84:87], s98 offen offset:1536 sc1
    buffer_load_dwordx4 v[60:63], v8, s[84:87], s92 offen offset:1024 sc1
    s_waitcnt lgkmcnt(13)
    v_mfma_f32_32x32x16_bf16 v[168:183], v[104:107], v[80:83], v[168:183]
    ds_read_b64_tr_b16 v[100:101], v15 offset:43008
    ds_read_b64_tr_b16 v[102:103], v15 offset:44032
    s_waitcnt lgkmcnt(13)
    v_mfma_f32_32x32x16_bf16 v[136:151], v[108:111], v[80:83], v[136:151]
    ds_read_b64_tr_b16 v[104:105], v14 offset:45056
    ds_read_b64_tr_b16 v[106:107], v14 offset:46080
    buffer_load_dwordx4 v[32:35], v8, s[84:87], s92 offen offset:2048 sc1
    s_waitcnt lgkmcnt(13)
    v_mfma_f32_32x32x16_bf16 v[168:183], v[112:115], v[52:55], v[168:183]
    ds_read_b64_tr_b16 v[108:109], v15 offset:45056
    ds_read_b64_tr_b16 v[110:111], v15 offset:46080
    s_waitcnt lgkmcnt(13)
    v_mfma_f32_32x32x16_bf16 v[136:151], v[116:119], v[52:55], v[136:151]
    ds_read_b64_tr_b16 v[112:113], v14 offset:47104
    ds_read_b64_tr_b16 v[114:115], v14 offset:48128
    buffer_load_dwordx4 v[64:67], v8, s[84:87], s92 offen offset:3072 sc1
    s_waitcnt lgkmcnt(13)
    v_mfma_f32_32x32x16_bf16 v[168:183], v[88:91], v[84:87], v[168:183]
    ds_read_b64_tr_b16 v[116:117], v15 offset:47104
    ds_read_b64_tr_b16 v[118:119], v15 offset:48128
    v_mov_b32 v19, 16
    s_mov_b64 exec, s[64:65]
    ds_write_b32 v9, v19 offset:48
    s_mov_b64 exec, -1
    s_waitcnt lgkmcnt(13)
    v_cmp_gt_u32 vcc, 17, v10
    v_mfma_f32_32x32x16_bf16 v[136:151], v[92:95], v[84:87], v[136:151]
    s_cbranch_vccnz Lslow_241
Lfok_239:
    ds_read_b64_tr_b16 v[88:89], v12 offset:0
    ds_read_b64_tr_b16 v[90:91], v12 offset:1024
    s_waitcnt vmcnt(12) lgkmcnt(13)
    v_mfma_f32_32x32x16_bf16 v[168:183], v[96:99], v[232:235], v[168:183]
    ds_read_b64_tr_b16 v[92:93], v13 offset:0
    ds_read_b64_tr_b16 v[94:95], v13 offset:1024
    s_waitcnt lgkmcnt(13)
    v_mfma_f32_32x32x16_bf16 v[136:151], v[100:103], v[232:235], v[136:151]
    ds_read_b64_tr_b16 v[96:97], v12 offset:2048
    ds_read_b64_tr_b16 v[98:99], v12 offset:3072
    s_waitcnt vmcnt(11) lgkmcnt(13)
    v_mfma_f32_32x32x16_bf16 v[168:183], v[104:107], v[236:239], v[168:183]
    ds_read_b64_tr_b16 v[100:101], v13 offset:2048
    ds_read_b64_tr_b16 v[102:103], v13 offset:3072
    s_waitcnt vmcnt(3)
    v_cmp_ne_u32 vcc, s7, v2
    s_nop 0
    s_cmp_eq_u64 vcc, 0
    s_cbranch_scc0 Lslow_244
Lok_242:
    buffer_load_dwordx4 v[36:39], v1, s[84:87], s93 offen offset:0 sc1
    s_waitcnt lgkmcnt(13)
    v_mfma_f32_32x32x16_bf16 v[136:151], v[108:111], v[236:239], v[136:151]
    ds_read_b64_tr_b16 v[104:105], v12 offset:4096
    ds_read_b64_tr_b16 v[106:107], v12 offset:5120
    buffer_load_dwordx4 v[68:71], v1, s[84:87], s93 offen offset:1024 sc1
    s_waitcnt lgkmcnt(13)
    v_mfma_f32_32x32x16_bf16 v[168:183], v[112:115], v[240:243], v[168:183]
    ds_read_b64_tr_b16 v[108:109], v13 offset:4096
    ds_read_b64_tr_b16 v[110:111], v13 offset:5120
    buffer_load_dwordx4 v[40:43], v1, s[84:87], s93 offen offset:2048 sc1
    s_waitcnt lgkmcnt(13)
    v_mfma_f32_32x32x16_bf16 v[136:151], v[116:119], v[240:243], v[136:151]
    ds_read_b64_tr_b16 v[112:113], v12 offset:6144
    ds_read_b64_tr_b16 v[114:115], v12 offset:7168
    buffer_load_dwordx4 v[72:75], v1, s[84:87], s93 offen offset:3072 sc1
    s_waitcnt lgkmcnt(12)
    v_mfma_f32_32x32x16_bf16 v[168:183], v[88:91], v[244:247], v[168:183]
    ds_read_b64_tr_b16 v[116:117], v13 offset:6144
    ds_read_b64_tr_b16 v[118:119], v13 offset:7168
    s_waitcnt lgkmcnt(12)
    v_mfma_f32_32x32x16_bf16 v[136:151], v[92:95], v[244:247], v[136:151]
    ds_read_b64_tr_b16 v[88:89], v12 offset:8192
    ds_read_b64_tr_b16 v[90:91], v12 offset:9216
    buffer_load_dwordx4 v[44:47], v8, s[84:87], s93 offen offset:0 sc1
    s_waitcnt lgkmcnt(12)
    v_mfma_f32_32x32x16_bf16 v[168:183], v[96:99], v[248:251], v[168:183]
    ds_read_b64_tr_b16 v[92:93], v13 offset:8192
    ds_read_b64_tr_b16 v[94:95], v13 offset:9216
    s_waitcnt lgkmcnt(12)
    v_mfma_f32_32x32x16_bf16 v[136:151], v[100:103], v[248:251], v[136:151]
    ds_read_b32 v10, v9 offset:32
    ds_read_b64_tr_b16 v[96:97], v12 offset:10240
    ds_read_b64_tr_b16 v[98:99], v12 offset:11264
    buffer_load_dwordx4 v[76:79], v8, s[84:87], s93 offen offset:1024 sc1
    s_waitcnt lgkmcnt(13)
    v_mfma_f32_32x32x16_bf16 v[168:183], v[104:107], v[24:27], v[168:183]
    ds_read_b64_tr_b16 v[100:101], v13 offset:10240
    ds_read_b64_tr_b16 v[102:103], v13 offset:11264
    s_waitcnt lgkmcnt(13)
    v_mfma_f32_32x32x16_bf16 v[136:151], v[108:111], v[24:27], v[136:151]
    ds_read_b64_tr_b16 v[104:105], v12 offset:12288
    ds_read_b64_tr_b16 v[106:107], v12 offset:13312
    buffer_load_dwordx4 v[48:51], v8, s[84:87], s93 offen offset:2048 sc1
    s_waitcnt lgkmcnt(13)
    v_mfma_f32_32x32x16_bf16 v[168:183], v[112:115], v[56:59], v[168:183]
    ds_read_b64_tr_b16 v[108:109], v13 offset:12288
    ds_read_b64_tr_b16 v[110:111], v13 offset:13312
    s_waitcnt lgkmcnt(13)
    v_mfma_f32_32x32x16_bf16 v[136:151], v[116:119], v[56:59], v[136:151]
    ds_read_b64_tr_b16 v[112:113], v12 offset:14336
    ds_read_b64_tr_b16 v[114:115], v12 offset:15360
    buffer_load_dwordx4 v[80:83], v8, s[84:87], s93 offen offset:3072 sc1
    s_waitcnt lgkmcnt(13)
    v_mfma_f32_32x32x16_bf16 v[168:183], v[88:91], v[28:31], v[168:183]
    ds_read_b64_tr_b16 v[116:117], v13 offset:14336
    ds_read_b64_tr_b16 v[118:119], v13 offset:15360
    v_mov_b32 v19, 17
    s_mov_b64 exec, s[64:65]
    ds_write_b32 v9, v19 offset:48
    s_mov_b64 exec, -1
    s_waitcnt lgkmcnt(13)
    v_cmp_gt_u32 vcc, 18, v10
    v_mfma_f32_32x32x16_bf16 v[136:151], v[92:95], v[28:31], v[136:151]
    s_cbranch_vccnz Lslow_247
Lfok_245:
    ds_read_b64_tr_b16 v[88:89], v12 offset:32768
    ds_read_b64_tr_b16 v[90:91], v12 offset:33792
    s_add_u32 s93, s93, 8192
    buffer_load_dwordx4 v[52:55], v1, s[84:87], s93 offen offset:0 sc1
    s_waitcnt vmcnt(11) lgkmcnt(13)
    v_mfma_f32_32x32x16_bf16 v[168:183], v[96:99], v[60:63], v[168:183]
    ds_read_b64_tr_b16 v[92:93], v13 offset:32768
    ds_read_b64_tr_b16 v[94:95], v13 offset:33792
    s_waitcnt lgkmcnt(13)
    v_mfma_f32_32x32x16_bf16 v[136:151], v[100:103], v[60:63], v[136:151]
    ds_read_b64_tr_b16 v[96:97], v12 offset:34816
    ds_read_b64_tr_b16 v[98:99], v12 offset:35840
    buffer_load_dwordx4 v[84:87], v1, s[84:87], s93 offen offset:1024 sc1
    s_waitcnt vmcnt(11) lgkmcnt(13)
    v_mfma_f32_32x32x16_bf16 v[168:183], v[104:107], v[32:35], v[168:183]
    ds_read_b64_tr_b16 v[100:101], v13 offset:34816
    ds_read_b64_tr_b16 v[102:103], v13 offset:35840
    s_waitcnt lgkmcnt(13)
    v_mfma_f32_32x32x16_bf16 v[136:151], v[108:111], v[32:35], v[136:151]
    ds_read_b64_tr_b16 v[104:105], v12 offset:36864
    ds_read_b64_tr_b16 v[106:107], v12 offset:37888
    buffer_load_dwordx4 v[232:235], v1, s[84:87], s93 offen offset:2048 sc1
    s_waitcnt vmcnt(11) lgkmcnt(13)
    v_mfma_f32_32x32x16_bf16 v[168:183], v[112:115], v[64:67], v[168:183]
    ds_read_b64_tr_b16 v[108:109], v13 offset:36864
    ds_read_b64_tr_b16 v[110:111], v13 offset:37888
    s_waitcnt lgkmcnt(13)
    v_mfma_f32_32x32x16_bf16 v[136:151], v[116:119], v[64:67], v[136:151]
    ds_read_b64_tr_b16 v[112:113], v12 offset:38912
    ds_read_b64_tr_b16 v[114:115], v12 offset:39936
    buffer_load_dwordx4 v[236:239], v1, s[84:87], s93 offen offset:3072 sc1
    s_waitcnt vmcnt(11) lgkmcnt(12)
    v_mfma_f32_32x32x16_bf16 v[168:183], v[88:91], v[36:39], v[168:183]
    ds_read_b64_tr_b16 v[116:117], v13 offset:38912
    ds_read_b64_tr_b16 v[118:119], v13 offset:39936
    s_waitcnt lgkmcnt(12)
    v_mfma_f32_32x32x16_bf16 v[136:151], v[92:95], v[36:39], v[136:151]
    ds_read_b64_tr_b16 v[88:89], v12 offset:40960
    ds_read_b64_tr_b16 v[90:91], v12 offset:41984
    buffer_load_dwordx4 v[240:243], v8, s[84:87], s93 offen offset:0 sc1
    s_waitcnt vmcnt(11) lgkmcnt(12)
    v_mfma_f32_32x32x16_bf16 v[168:183], v[96:99], v[68:71], v[168:183]
    ds_read_b64_tr_b16 v[92:93], v13 offset:40960
    ds_read_b64_tr_b16 v[94:95], v13 offset:41984
    s_waitcnt lgkmcnt(12)
    v_mfma_f32_32x32x16_bf16 v[136:151], v[100:103], v[68:71], v[136:151]
    ds_read_b32 v10, v9 offset:32
    ds_read_b64_tr_b16 v[96:97], v12 offset:43008
    ds_read_b64_tr_b16 v[98:99], v12 offset:44032
    buffer_load_dword v3, v11, s[84:87], s98 offen offset:1792 sc1
    buffer_load_dwordx4 v[244:247], v8, s[84:87], s93 offen offset:1024 sc1
    s_waitcnt vmcnt(12) lgkmcnt(13)
    v_mfma_f32_32x32x16_bf16 v[168:183], v[104:107], v[40:43], v[168:183]
    ds_read_b64_tr_b16 v[100:101], v13 offset:43008
    ds_read_b64_tr_b16 v[102:103], v13 offset:44032
    s_waitcnt lgkmcnt(13)
    v_mfma_f32_32x32x16_bf16 v[136:151], v[108:111], v[40:43], v[136:151]
    ds_read_b64_tr_b16 v[104:105], v12 offset:45056
    ds_read_b64_tr_b16 v[106:107], v12 offset:46080
    buffer_load_dwordx4 v[248:251], v8, s[84:87], s93 offen offset:2048 sc1
    s_waitcnt vmcnt(12) lgkmcnt(13)
    v_mfma_f32_32x32x16_bf16 v[168:183], v[112:115], v[72:75], v[168:183]
    ds_read_b64_tr_b16 v[108:109], v13 offset:45056
    ds_read_b64_tr_b16 v[110:111], v13 offset:46080
    s_waitcnt lgkmcnt(13)
    v_mfma_f32_32x32x16_bf16 v[136:151], v[116:119], v[72:75], v[136:151]
    ds_read_b64_tr_b16 v[112:113], v12 offset:47104
    ds_read_b64_tr_b16 v[114:115], v12 offset:48128
    buffer_load_dwordx4 v[24:27], v8, s[84:87], s93 offen offset:3072 sc1
    s_waitcnt vmcnt(12) lgkmcnt(13)
    v_mfma_f32_32x32x16_bf16 v[168:183], v[88:91], v[44:47], v[168:183]
    ds_read_b64_tr_b16 v[116:117], v13 offset:47104
    ds_read_b64_tr_b16 v[118:119], v13 offset:48128
    s_waitcnt lgkmcnt(12)
    v_cmp_gt_u32 vcc, 19, v10
    v_mfma_f32_32x32x16_bf16 v[136:151], v[92:95], v[44:47], v[136:151]
    s_cbranch_vccnz Lslow_250
Lfok_248:
    ds_read_b64_tr_b16 v[88:89], v14 offset:0
    ds_read_b64_tr_b16 v[90:91], v14 offset:1024
    s_waitcnt vmcnt(11) lgkmcnt(12)
    v_mfma_f32_32x32x16_bf16 v[168:183], v[96:99], v[76:79], v[168:183]
    ds_read_b64_tr_b16 v[92:93], v15 offset:0
    ds_read_b64_tr_b16 v[94:95], v15 offset:1024
    s_waitcnt lgkmcnt(12)
    v_mfma_f32_32x32x16_bf16 v[136:151], v[100:103], v[76:79], v[136:151]
    ds_read_b64_tr_b16 v[96:97], v14 offset:2048
    ds_read_b64_tr_b16 v[98:99], v14 offset:3072
    s_waitcnt vmcnt(10) lgkmcnt(12)
    v_mfma_f32_32x32x16_bf16 v[168:183], v[104:107], v[48:51], v[168:183]
    ds_read_b64_tr_b16 v[100:101], v15 offset:2048
    ds_read_b64_tr_b16 v[102:103], v15 offset:3072
    s_waitcnt vmcnt(3)
    v_cmp_ne_u32 vcc, s7, v3
    s_nop 0
    s_cmp_eq_u64 vcc, 0
    s_cbranch_scc0 Lslow_253
Lok_251:
    buffer_load_dwordx4 v[56:59], v1, s[84:87], s94 offen offset:0 sc1
    s_waitcnt lgkmcnt(12)
    v_mfma_f32_32x32x16_bf16 v[136:151], v[108:111], v[48:51], v[136:151]
    ds_read_b64_tr_b16 v[104:105], v14 offset:4096
    ds_read_b64_tr_b16 v[106:107], v14 offset:5120
    buffer_load_dwordx4 v[28:31], v1, s[84:87], s94 offen offset:1024 sc1
    s_waitcnt lgkmcnt(12)
    v_mfma_f32_32x32x16_bf16 v[168:183], v[112:115], v[80:83], v[168:183]
    ds_read_b64_tr_b16 v[108:109], v15 offset:4096
    ds_read_b64_tr_b16 v[110:111], v15 offset:5120
    buffer_load_dwordx4 v[60:63], v1, s[84:87], s94 offen offset:2048 sc1
    s_waitcnt lgkmcnt(12)
    v_mfma_f32_32x32x16_bf16 v[136:151], v[116:119], v[80:83], v[136:151]
    ds_read_b64_tr_b16 v[112:113], v14 offset:6144
    ds_read_b64_tr_b16 v[114:115], v14 offset:7168
    buffer_load_dwordx4 v[32:35], v1, s[84:87], s94 offen offset:3072 sc1
    s_waitcnt lgkmcnt(12)
    v_mfma_f32_32x32x16_bf16 v[168:183], v[88:91], v[52:55], v[168:183]
    ds_read_b64_tr_b16 v[116:117], v15 offset:6144
    ds_read_b64_tr_b16 v[118:119], v15 offset:7168
    s_waitcnt lgkmcnt(12)
    v_mfma_f32_32x32x16_bf16 v[136:151], v[92:95], v[52:55], v[136:151]
    ds_read_b64_tr_b16 v[88:89], v14 offset:8192
    ds_read_b64_tr_b16 v[90:91], v14 offset:9216
    buffer_load_dwordx4 v[64:67], v8, s[84:87], s94 offen offset:0 sc1
    s_waitcnt lgkmcnt(12)
    v_mfma_f32_32x32x16_bf16 v[168:183], v[96:99], v[84:87], v[168:183]
    ds_read_b64_tr_b16 v[92:93], v15 offset:8192
    ds_read_b64_tr_b16 v[94:95], v15 offset:9216
    s_waitcnt lgkmcnt(12)
    v_mfma_f32_32x32x16_bf16 v[136:151], v[100:103], v[84:87], v[136:151]
    ds_read_b32 v10, v9 offset:32
    ds_read_b64_tr_b16 v[96:97], v14 offset:10240
    ds_read_b64_tr_b16 v[98:99], v14 offset:11264
    buffer_load_dwordx4 v[36:39], v8, s[84:87], s94 offen offset:1024 sc1
    s_waitcnt lgkmcnt(13)
    v_mfma_f32_32x32x16_bf16 v[168:183], v[104:107], v[232:235], v[168:183]
    ds_read_b64_tr_b16 v[100:101], v15 offset:10240
    ds_read_b64_tr_b16 v[102:103], v15 offset:11264
    s_waitcnt lgkmcnt(13)
    v_mfma_f32_32x32x16_bf16 v[136:151], v[108:111], v[232:235], v[136:151]
    ds_read_b64_tr_b16 v[104:105], v14 offset:12288
    ds_read_b64_tr_b16 v[106:107], v14 offset:13312
    buffer_load_dwordx4 v[68:71], v8, s[84:87], s94 offen offset:2048 sc1
    s_waitcnt lgkmcnt(13)
    v_mfma_f32_32x32x16_bf16 v[168:183], v[112:115], v[236:239], v[168:183]
    ds_read_b64_tr_b16 v[108:109], v15 offset:12288
    ds_read_b64_tr_b16 v[110:111], v15 offset:13312
    s_waitcnt lgkmcnt(13)
    v_mfma_f32_32x32x16_bf16 v[136:151], v[116:119], v[236:239], v[136:151]
    ds_read_b64_tr_b16 v[112:113], v14 offset:14336
    ds_read_b64_tr_b16 v[114:115], v14 offset:15360
    buffer_load_dwordx4 v[40:43], v8, s[84:87], s94 offen offset:3072 sc1
    s_waitcnt lgkmcnt(13)
    v_mfma_f32_32x32x16_bf16 v[168:183], v[88:91], v[240:243], v[168:183]
    ds_read_b64_tr_b16 v[116:117], v15 offset:14336
    ds_read_b64_tr_b16 v[118:119], v15 offset:15360
    ds_read_b128 v[120:123], v18 offset:9984
    ds_read_b128 v[124:127], v18 offset:10016
    ds_read_b128 v[128:131], v18 offset:10048
    ds_read_b128 v[132:135], v18 offset:10080
    s_waitcnt lgkmcnt(14)
    v_cmp_gt_u32 vcc, 20, v10
    v_mfma_f32_32x32x16_bf16 v[136:151], v[92:95], v[240:243], v[136:151]
    s_cbranch_vccnz Lslow_256
Lfok_254:
    ds_read_b64_tr_b16 v[88:89], v14 offset:32768
    ds_read_b64_tr_b16 v[90:91], v14 offset:33792
    s_waitcnt vmcnt(10) lgkmcnt(14)
    v_mfma_f32_32x32x16_bf16 v[168:183], v[96:99], v[244:247], v[168:183]
    ds_read_b64_tr_b16 v[92:93], v15 offset:32768
    ds_read_b64_tr_b16 v[94:95], v15 offset:33792
    s_waitcnt lgkmcnt(14)
    v_mfma_f32_32x32x16_bf16 v[136:151], v[100:103], v[244:247], v[136:151]
    ds_read_b64_tr_b16 v[96:97], v14 offset:34816
    ds_read_b64_tr_b16 v[98:99], v14 offset:35840
    s_waitcnt vmcnt(9) lgkmcnt(14)
    v_mfma_f32_32x32x16_bf16 v[168:183], v[104:107], v[248:251], v[168:183]
    ds_read_b64_tr_b16 v[100:101], v15 offset:34816
    ds_read_b64_tr_b16 v[102:103], v15 offset:35840
    s_waitcnt lgkmcnt(14)
    v_mfma_f32_32x32x16_bf16 v[136:151], v[108:111], v[248:251], v[136:151]
    ds_read_b64_tr_b16 v[104:105], v14 offset:36864
    ds_read_b64_tr_b16 v[106:107], v14 offset:37888
    s_waitcnt vmcnt(8) lgkmcnt(14)
    v_mfma_f32_32x32x16_bf16 v[168:183], v[112:115], v[24:27], v[168:183]
    ds_read_b64_tr_b16 v[108:109], v15 offset:36864
    ds_read_b64_tr_b16 v[110:111], v15 offset:37888
    s_waitcnt lgkmcnt(14)
    v_mfma_f32_32x32x16_bf16 v[136:151], v[116:119], v[24:27], v[136:151]
    ds_read_b64_tr_b16 v[112:113], v14 offset:38912
    ds_read_b64_tr_b16 v[114:115], v14 offset:39936
    s_waitcnt vmcnt(7) lgkmcnt(12)
    v_mfma_f32_32x32x16_bf16 v[168:183], v[88:91], v[56:59], v[168:183]
    ds_read_b64_tr_b16 v[116:117], v15 offset:38912
    ds_read_b64_tr_b16 v[118:119], v15 offset:39936
    s_waitcnt lgkmcnt(12)
    v_mfma_f32_32x32x16_bf16 v[136:151], v[92:95], v[56:59], v[136:151]
    ds_read_b64_tr_b16 v[88:89], v15 offset:40960
    ds_read_b64_tr_b16 v[90:91], v15 offset:41984
    ds_read_b32 v10, v9 offset:80
    s_waitcnt vmcnt(6) lgkmcnt(13)
    v_mfma_f32_32x32x16_bf16 v[168:183], v[96:99], v[28:31], v[168:183]
    ds_read_b64_tr_b16 v[92:93], v15 offset:43008
    ds_read_b64_tr_b16 v[94:95], v15 offset:44032
    s_waitcnt lgkmcnt(13)
    v_mfma_f32_32x32x16_bf16 v[136:151], v[100:103], v[28:31], v[136:151]
    ds_read_b64_tr_b16 v[96:97], v15 offset:45056
    ds_read_b64_tr_b16 v[98:99], v15 offset:46080
    s_waitcnt vmcnt(5) lgkmcnt(13)
    v_mfma_f32_32x32x16_bf16 v[168:183], v[104:107], v[60:63], v[168:183]
    ds_read_b64_tr_b16 v[100:101], v15 offset:47104
    ds_read_b64_tr_b16 v[102:103], v15 offset:48128
    s_waitcnt lgkmcnt(13)
    v_mfma_f32_32x32x16_bf16 v[136:151], v[108:111], v[60:63], v[136:151]
    ds_read_b64_tr_b16 v[104:105], v14 offset:40960
    ds_read_b64_tr_b16 v[106:107], v14 offset:41984
    s_waitcnt vmcnt(4) lgkmcnt(13)
    v_mfma_f32_32x32x16_bf16 v[168:183], v[112:115], v[32:35], v[168:183]
    ds_read_b64_tr_b16 v[108:109], v14 offset:43008
    ds_read_b64_tr_b16 v[110:111], v14 offset:44032
    s_waitcnt lgkmcnt(10)
    v_cmp_gt_u32 vcc, 8, v10
    s_nop 0
    s_and_b64 vcc, vcc, s[50:51]
    s_cbranch_scc1 Lslow_259
Lfok_257:
    v_mfma_f32_32x32x16_bf16 v[136:151], v[116:119], v[32:35], v[136:151]
    ds_read_b64_tr_b16 v[112:113], v14 offset:45056
    ds_read_b64_tr_b16 v[114:115], v14 offset:46080
    s_waitcnt vmcnt(3)
    v_mfma_f32_32x32x16_bf16 v[136:151], v[88:91], v[64:67], v[136:151]
    ds_read_b64_tr_b16 v[116:117], v14 offset:47104
    ds_read_b64_tr_b16 v[118:119], v14 offset:48128
    s_waitcnt vmcnt(2) lgkmcnt(12)
    v_mfma_f32_32x32x16_bf16 v[136:151], v[92:95], v[36:39], v[136:151]
    s_waitcnt vmcnt(1) lgkmcnt(10)
    v_mfma_f32_32x32x16_bf16 v[136:151], v[96:99], v[68:71], v[136:151]
    s_waitcnt vmcnt(0) lgkmcnt(8)
    v_mfma_f32_32x32x16_bf16 v[136:151], v[100:103], v[40:43], v[136:151]
    s_waitcnt lgkmcnt(6)
    v_mfma_f32_32x32x16_bf16 v[168:183], v[104:107], v[64:67], v[168:183]
    s_waitcnt lgkmcnt(4)
    v_mfma_f32_32x32x16_bf16 v[168:183], v[108:111], v[36:39], v[168:183]
    s_nop 7
    ds_write_b128 v22, v[136:139] offset:0
    ds_write_b128 v22, v[140:143] offset:1024
    s_waitcnt lgkmcnt(4)
    v_mfma_f32_32x32x16_bf16 v[168:183], v[112:115], v[68:71], v[168:183]
    ds_write_b128 v22, v[144:147] offset:2048
    ds_write_b128 v22, v[148:151] offset:3072
    v_mov_b32 v19, 9
    s_mov_b64 exec, s[64:65]
    ds_write_b32 v9, v19 offset:64
    s_mov_b64 exec, -1
    s_waitcnt lgkmcnt(5)
    v_mfma_f32_32x32x16_bf16 v[168:183], v[116:119], v[40:43], v[168:183]
    ds_read_b32 v10, v9 offset:64
    ds_read_b128 v[152:155], v23 offset:0
    ds_read_b128 v[156:159], v23 offset:1024
    ds_read_b128 v[160:163], v23 offset:2048
    ds_read_b128 v[164:167], v23 offset:3072
    s_waitcnt lgkmcnt(4)
    v_cmp_gt_u32 vcc, 9, v10
    s_nop 0
    s_and_b64 vcc, vcc, s[50:51]
    s_cbranch_scc1 Lslow_262
Lfok_260:
    v_mov_b32 v19, 9
    s_mov_b64 exec, s[64:65]
    ds_write_b32 v9, v19 offset:80
    s_mov_b64 exec, -1
    v_pk_fma_f32 v[184:185], v[168:169], v[120:121], v[184:185]
    v_pk_fma_f32 v[186:187], v[170:171], v[122:123], v[186:187]
    v_pk_fma_f32 v[188:189], v[172:173], v[124:125], v[188:189]
    v_pk_fma_f32 v[190:191], v[174:175], v[126:127], v[190:191]
    v_pk_fma_f32 v[192:193], v[176:177], v[128:129], v[192:193]
    v_pk_fma_f32 v[194:195], v[178:179], v[130:131], v[194:195]
    v_pk_fma_f32 v[196:197], v[180:181], v[132:133], v[196:197]
    v_pk_fma_f32 v[198:199], v[182:183], v[134:135], v[198:199]
    s_waitcnt lgkmcnt(4)
    v_pk_fma_f32 v[184:185], v[152:153], v[120:121], v[184:185]
    v_pk_fma_f32 v[186:187], v[154:155], v[122:123], v[186:187]
    v_cvt_pk_bf16_f32 v248, v184, v185
    v_cvt_pk_bf16_f32 v249, v186, v187
    s_waitcnt lgkmcnt(3)
    v_pk_fma_f32 v[188:189], v[156:157], v[124:125], v[188:189]
    v_pk_fma_f32 v[190:191], v[158:159], v[126:127], v[190:191]
    v_cvt_pk_bf16_f32 v250, v188, v189
    v_cvt_pk_bf16_f32 v251, v190, v191
    s_nop 0
    v_permlane32_swap_b32 v248, v250
    v_permlane32_swap_b32 v249, v251
    s_waitcnt lgkmcnt(2)
    v_pk_fma_f32 v[192:193], v[160:161], v[128:129], v[192:193]
    v_pk_fma_f32 v[194:195], v[162:163], v[130:131], v[194:195]
    v_cvt_pk_bf16_f32 v252, v192, v193
    v_cvt_pk_bf16_f32 v253, v194, v195
    s_waitcnt lgkmcnt(1)
    v_pk_fma_f32 v[196:197], v[164:165], v[132:133], v[196:197]
    v_pk_fma_f32 v[198:199], v[166:167], v[134:135], v[198:199]
    v_cvt_pk_bf16_f32 v254, v196, v197
    v_cvt_pk_bf16_f32 v255, v198, v199
    s_nop 0
    v_permlane32_swap_b32 v252, v254
    v_permlane32_swap_b32 v253, v255
    s_nop 0
    v_permlane16_swap_b32 v248, v252
    v_permlane16_swap_b32 v249, v253
    v_permlane16_swap_b32 v250, v254
    v_permlane16_swap_b32 v251, v255
    buffer_store_dwordx4 v[248:251], v5, s[80:83], s11 offen
    buffer_store_dwordx4 v[252:255], v5, s[80:83], s12 offen
    s_endpgm
L_helper:
    s_sub_u32 s13, s6, 4
    s_mul_i32 s3, s13, 20
    v_lshrrev_b32 v69, 4, v0
    v_add_u32 v69, s3, v69
    v_and_b32 v70, 15, v0
    s_lshl_b32 s8, s4, 6
    s_sub_u32 s8, s8, 16
    v_add_u32 v2, s8, v69
    v_lshlrev_b32 v2, 10, v2
    v_lshl_add_u32 v2, v70, 4, v2
    s_cmp_ge_u32 s5, 5
    s_cselect_b32 s3, 5, 0
    s_sub_u32 s3, s5, s3
    s_lshl_b32 s92, s3, 2
    s_lshl_b32 s3, s92, 10
    v_add_u32 v64, s3, v2
    s_add_u32 s93, s92, 4
    s_cmp_ge_u32 s93, 20
    s_cselect_b32 s93, 0, s93
    s_lshl_b32 s3, s93, 10
    v_add_u32 v65, s3, v2
    s_add_u32 s94, s93, 4
    s_cmp_ge_u32 s94, 20
    s_cselect_b32 s94, 0, s94
    s_lshl_b32 s3, s94, 10
    v_add_u32 v66, s3, v2
    s_add_u32 s95, s94, 4
    s_cmp_ge_u32 s95, 20
    s_cselect_b32 s95, 0, s95
    s_lshl_b32 s3, s95, 10
    v_add_u32 v67, s3, v2
    s_add_u32 s96, s95, 4
    s_cmp_ge_u32 s96, 20
    s_cselect_b32 s96, 0, s96
    s_lshl_b32 s3, s96, 10
    v_add_u32 v68, s3, v2
    v_and_b32 v22, 3, v0
    v_lshlrev_b32 v22, 2, v22
    v_add_u32 v22, 159488, v22
    s_lshl_b64 s[90:91], 1, s13
    s_mul_i32 s40, s4, 524288
    s_add_u32 s40, s40, 4194304
    s_lshr_b32 s101, s4, 1
    s_mul_i32 s101, s101, 79104
    s_add_u32 s101, s101, 65536
    s_waitcnt lgkmcnt(0)
    v_lshlrev_b32 v5, 16, v0
    s_lshl_b32 s3, s5, 2
    s_add_u32 s3, s3, s13
    s_lshl_b32 s3, s3, 7
    s_add_u32 s8, s3, s40
    s_mov_b64 exec, 0xb
    buffer_load_dword v31, v5, s[84:87], s8 offen
    s_mov_b64 exec, 3
    s_add_u32 s8, s3, 2129920
    buffer_load_dword v31, v5, s[84:87], s8 offen
    s_mov_b64 exec, 1
    s_add_u32 s8, s3, s40
    s_add_u32 s8, s8, 319488
    buffer_load_dword v31, v5, s[84:87], s8 offen sc1
    s_lshl_b32 s8, s4, 16
    s_add_u32 s8, s8, s3
    buffer_load_dword v31, v5, s[80:83], s8 offen
    s_mov_b64 exec, -1
    s_lshl_b32 s3, s2, 9
    s_lshl_b32 s8, s13, 7
    s_add_u32 s3, s3, s8
    s_mov_b64 exec, 1
    buffer_load_dword v31, off, s[52:55], s3
    buffer_load_dword v31, off, s[56:59], s3
    buffer_load_dword v31, off, s[60:63], s3
    buffer_load_dword v31, off, s[64:67], s3
    buffer_load_dword v31, off, s[68:71], s3
    s_add_u32 s3, s3, 0x200000
    buffer_load_dword v31, off, s[76:79], s3
    s_mov_b64 exec, -1
    s_barrier
    s_setprio 3
    s_lshr_b32 s3, s2, 3
    s_lshl_b32 s3, s3, 2
    s_add_u32 s3, s3, s13
    s_mul_i32 s3, s3, 12288
    v_lshlrev_b32 v5, 10, v0
    s_mov_b64 exec, 0xfff
    buffer_load_dword v31, v5, s[48:51], s3 offen offset:384
    s_mov_b64 exec, -1
    s_load_dword s7, s[84:85], 0
    buffer_load_dwordx4 v[100:103], v64, s[44:47], 0 offen offset:0
    buffer_load_dwordx4 v[140:143], v64, s[44:47], 0 offen offset:256
    buffer_load_dwordx4 v[180:183], v64, s[44:47], 0 offen offset:512
    buffer_load_dwordx4 v[220:223], v64, s[44:47], 0 offen offset:768
    buffer_load_dwordx4 v[108:111], v65, s[44:47], 0 offen offset:0
    buffer_load_dwordx4 v[148:151], v65, s[44:47], 0 offen offset:256
    buffer_load_dwordx4 v[188:191], v65, s[44:47], 0 offen offset:512
    buffer_load_dwordx4 v[228:231], v65, s[44:47], 0 offen offset:768
    buffer_load_dwordx4 v[116:119], v66, s[44:47], 0 offen offset:0
    buffer_load_dwordx4 v[156:159], v66, s[44:47], 0 offen offset:256
    buffer_load_dwordx4 v[196:199], v66, s[44:47], 0 offen offset:512
    buffer_load_dwordx4 v[236:239], v66, s[44:47], 0 offen offset:768
    buffer_load_dwordx4 v[124:127], v67, s[44:47], 0 offen offset:0
    buffer_load_dwordx4 v[164:167], v67, s[44:47], 0 offen offset:256
    buffer_load_dwordx4 v[204:207], v67, s[44:47], 0 offen offset:512
    buffer_load_dwordx4 v[244:247], v67, s[44:47], 0 offen offset:768
    buffer_load_dwordx4 v[132:135], v68, s[44:47], 0 offen offset:0
    buffer_load_dwordx4 v[172:175], v68, s[44:47], 0 offen offset:256
    buffer_load_dwordx4 v[212:215], v68, s[44:47], 0 offen offset:512
    buffer_load_dwordx4 v[252:255], v68, s[44:47], 0 offen offset:768
    s_setprio 0
    s_mul_i32 s40, s4, 524288
    s_add_u32 s40, s40, 4194304
    s_lshr_b32 s101, s4, 1
    s_mul_i32 s101, s101, 79104
    s_add_u32 s101, s101, 65536
    v_lshrrev_b32 v2, 3, v0
    s_lshl_b32 s3, s13, 3
    v_add_u32 v27, s3, v2
    v_mul_u32_u24 v27, 3072, v27
    v_and_b32 v2, 2, v2
    s_and_b32 s3, s13, 1
    s_lshl_b32 s3, s3, 2
    v_or_b32 v2, s3, v2
    v_and_b32 v3, 7, v0
    v_xor_b32 v2, v2, v3
    v_lshl_add_u32 v27, v2, 4, v27
    s_lshl_b32 s3, s5, 7
    v_add_u32 v27, s3, v27
    s_lshl_b32 s12, s13, 10
    v_mov_b32 v17, 0x3f803f80
    v_lshrrev_b32 v2, 2, v0
    v_and_b32 v2, 4, v2
    v_and_b32 v3, 7, v0
    v_xor_b32 v3, v2, v3
    v_lshrrev_b32 v2, 3, v0
    s_lshr_b32 s8, s13, 1
    s_and_b32 s9, s13, 1
    s_lshl_b32 s3, s8, 8
    s_lshl_b32 s10, s9, 6
    s_add_u32 s3, s3, s10
    v_add_u32 v9, s3, v2
    v_lshlrev_b32 v8, 10, v9
    v_lshl_add_u32 v8, v3, 4, v8
    s_lshl_b32 s10, s5, 7
    v_add_u32 v8, s10, v8
    s_lshl_b32 s3, s8, 2
    s_add_u32 s3, s3, s9
    s_mul_i32 s3, s3, 224
    s_lshl_b32 s11, s9, 5
    s_add_u32 s3, s3, s11
    v_add_u32 v11, s3, v2
    v_lshlrev_b32 v11, 10, v11
    v_lshl_add_u32 v11, v3, 4, v11
    v_add_u32 v11, s10, v11
    s_mul_i32 s15, s9, 196608
    s_lshl_b32 s3, s4, 6
    s_lshl_b32 s11, s13, 4
    s_add_u32 s3, s3, s11
    v_add_u32 v29, s3, v2
    v_lshlrev_b32 v29, 10, v29
    v_and_b32 v4, 7, v0
    v_xor_b32 v4, v4, v2
    v_lshl_add_u32 v29, v4, 4, v29
    v_add_u32 v29, s10, v29
    v_lshrrev_b32 v2, 2, v0
    v_and_b32 v2, 4, v2
    v_and_b32 v3, 7, v0
    v_xor_b32 v3, v2, v3
    s_lshr_b32 s8, s13, 1
    v_mul_u32_u24 v9, 3584, v9
    s_mul_i32 s11, s5, 448
    v_add_u32 v9, s11, v9
    v_mov_b32 v10, v9
    v_lshl_add_u32 v9, v3, 4, v9
    s_and_b32 s9, s5, 1
    s_lshl_b32 s3, s9, 6
    v_add_u32 v9, s3, v9
    s_mul_i32 s3, s8, 6
    v_xor_b32 v5, s3, v3
    v_and_b32 v2, 3, v5
    v_lshl_add_u32 v10, v2, 4, v10
    v_lshrrev_b32 v5, 2, v5
    v_mul_u32_u24 v5, 458752, v5
    v_add_u32 v10, v5, v10
    s_xor_b32 s9, s9, 1
    s_mul_i32 s3, s9, 384
    v_add_u32 v10, s3, v10
    v_add_u32 v26, s12, v1
    v_add_u32 v30, 81920, v26
    s_waitcnt lgkmcnt(0)
    s_add_u32 s7, s7, 0x9e3779b9
    v_mov_b32 v6, s7
    s_getreg_b32 s3, hwreg(HW_REG_XCC_ID)
    v_mov_b32 v7, s3
    s_lshl_b32 s3, s4, 6
    s_lshl_b32 s8, s5, 3
    s_add_u32 s3, s3, s8
    s_add_u32 s3, s3, 2048
    s_cmp_eq_u32 s13, 0
    s_cselect_b32 s3, s3, 0x7fffffff
    s_mov_b64 exec, 1
    buffer_store_dwordx2 v[6:7], off, s[84:87], s3 sc1
    s_mov_b64 exec, -1
    s_waitcnt vmcnt(20)
    v_dot2_f32_bf16 v82, v100, v17, 0
    v_dot2_f32_bf16 v72, v100, v100, 0
    v_dot2_f32_bf16 v82, v101, v17, v82
    v_dot2_f32_bf16 v72, v101, v101, v72
    v_dot2_f32_bf16 v82, v102, v17, v82
    v_dot2_f32_bf16 v72, v102, v102, v72
    v_dot2_f32_bf16 v82, v103, v17, v82
    v_dot2_f32_bf16 v72, v103, v103, v72
    v_lshlrev_b32 v96, 16, v100
    v_and_b32 v97, 0xffff0000, v100
    v_lshlrev_b32 v98, 16, v101
    v_and_b32 v99, 0xffff0000, v101
    v_lshlrev_b32 v100, 16, v102
    v_and_b32 v101, 0xffff0000, v102
    v_lshlrev_b32 v102, 16, v103
    v_and_b32 v103, 0xffff0000, v103
    s_waitcnt vmcnt(19)
    s_nop 0
    v_dot2_f32_bf16 v82, v140, v17, v82
    v_dot2_f32_bf16 v72, v140, v140, v72
    v_dot2_f32_bf16 v82, v141, v17, v82
    v_dot2_f32_bf16 v72, v141, v141, v72
    v_dot2_f32_bf16 v82, v142, v17, v82
    v_dot2_f32_bf16 v72, v142, v142, v72
    v_dot2_f32_bf16 v82, v143, v17, v82
    v_dot2_f32_bf16 v72, v143, v143, v72
    v_lshlrev_b32 v136, 16, v140
    v_and_b32 v137, 0xffff0000, v140
    v_lshlrev_b32 v138, 16, v141
    v_and_b32 v139, 0xffff0000, v141
    v_lshlrev_b32 v140, 16, v142
    v_and_b32 v141, 0xffff0000, v142
    v_lshlrev_b32 v142, 16, v143
    v_and_b32 v143, 0xffff0000, v143
    s_waitcnt vmcnt(18)
    s_nop 0
    v_dot2_f32_bf16 v82, v180, v17, v82
    v_dot2_f32_bf16 v72, v180, v180, v72
    v_dot2_f32_bf16 v82, v181, v17, v82
    v_dot2_f32_bf16 v72, v181, v181, v72
    v_dot2_f32_bf16 v82, v182, v17, v82
    v_dot2_f32_bf16 v72, v182, v182, v72
    v_dot2_f32_bf16 v82, v183, v17, v82
    v_dot2_f32_bf16 v72, v183, v183, v72
    v_lshlrev_b32 v176, 16, v180
    v_and_b32 v177, 0xffff0000, v180
    v_lshlrev_b32 v178, 16, v181
    v_and_b32 v179, 0xffff0000, v181
    v_lshlrev_b32 v180, 16, v182
    v_and_b32 v181, 0xffff0000, v182
    v_lshlrev_b32 v182, 16, v183
    v_and_b32 v183, 0xffff0000, v183
    s_waitcnt vmcnt(17)
    s_nop 0
    v_dot2_f32_bf16 v82, v220, v17, v82
    v_dot2_f32_bf16 v72, v220, v220, v72
    v_dot2_f32_bf16 v82, v221, v17, v82
    v_dot2_f32_bf16 v72, v221, v221, v72
    v_dot2_f32_bf16 v82, v222, v17, v82
    v_dot2_f32_bf16 v72, v222, v222, v72
    v_dot2_f32_bf16 v82, v223, v17, v82
    v_dot2_f32_bf16 v72, v223, v223, v72
    v_lshlrev_b32 v216, 16, v220
    v_and_b32 v217, 0xffff0000, v220
    v_lshlrev_b32 v218, 16, v221
    v_and_b32 v219, 0xffff0000, v221
    v_lshlrev_b32 v220, 16, v222
    v_and_b32 v221, 0xffff0000, v222
    v_lshlrev_b32 v222, 16, v223
    v_and_b32 v223, 0xffff0000, v223
    s_waitcnt vmcnt(16)
    s_nop 0
    v_dot2_f32_bf16 v84, v108, v17, 0
    v_dot2_f32_bf16 v74, v108, v108, 0
    v_dot2_f32_bf16 v84, v109, v17, v84
    v_dot2_f32_bf16 v74, v109, v109, v74
    v_dot2_f32_bf16 v84, v110, v17, v84
    v_dot2_f32_bf16 v74, v110, v110, v74
    v_dot2_f32_bf16 v84, v111, v17, v84
    v_dot2_f32_bf16 v74, v111, v111, v74
    v_lshlrev_b32 v104, 16, v108
    v_and_b32 v105, 0xffff0000, v108
    v_lshlrev_b32 v106, 16, v109
    v_and_b32 v107, 0xffff0000, v109
    v_lshlrev_b32 v108, 16, v110
    v_and_b32 v109, 0xffff0000, v110
    v_lshlrev_b32 v110, 16, v111
    v_and_b32 v111, 0xffff0000, v111
    s_waitcnt vmcnt(15)
    s_nop 0
    v_dot2_f32_bf16 v84, v148, v17, v84
    v_dot2_f32_bf16 v74, v148, v148, v74
    v_dot2_f32_bf16 v84, v149, v17, v84
    v_dot2_f32_bf16 v74, v149, v149, v74
    v_dot2_f32_bf16 v84, v150, v17, v84
    v_dot2_f32_bf16 v74, v150, v150, v74
    v_dot2_f32_bf16 v84, v151, v17, v84
    v_dot2_f32_bf16 v74, v151, v151, v74
    v_lshlrev_b32 v144, 16, v148
    v_and_b32 v145, 0xffff0000, v148
    v_lshlrev_b32 v146, 16, v149
    v_and_b32 v147, 0xffff0000, v149
    v_lshlrev_b32 v148, 16, v150
    v_and_b32 v149, 0xffff0000, v150
    v_lshlrev_b32 v150, 16, v151
    v_and_b32 v151, 0xffff0000, v151
    s_waitcnt vmcnt(14)
    s_nop 0
    v_dot2_f32_bf16 v84, v188, v17, v84
    v_dot2_f32_bf16 v74, v188, v188, v74
    v_dot2_f32_bf16 v84, v189, v17, v84
    v_dot2_f32_bf16 v74, v189, v189, v74
    v_dot2_f32_bf16 v84, v190, v17, v84
    v_dot2_f32_bf16 v74, v190, v190, v74
    v_dot2_f32_bf16 v84, v191, v17, v84
    v_dot2_f32_bf16 v74, v191, v191, v74
    v_lshlrev_b32 v184, 16, v188
    v_and_b32 v185, 0xffff0000, v188
    v_lshlrev_b32 v186, 16, v189
    v_and_b32 v187, 0xffff0000, v189
    v_lshlrev_b32 v188, 16, v190
    v_and_b32 v189, 0xffff0000, v190
    v_lshlrev_b32 v190, 16, v191
    v_and_b32 v191, 0xffff0000, v191
    s_waitcnt vmcnt(13)
    s_nop 0
    v_dot2_f32_bf16 v84, v228, v17, v84
    v_dot2_f32_bf16 v74, v228, v228, v74
    v_dot2_f32_bf16 v84, v229, v17, v84
    v_dot2_f32_bf16 v74, v229, v229, v74
    v_dot2_f32_bf16 v84, v230, v17, v84
    v_dot2_f32_bf16 v74, v230, v230, v74
    v_dot2_f32_bf16 v84, v231, v17, v84
    v_dot2_f32_bf16 v74, v231, v231, v74
    v_lshlrev_b32 v224, 16, v228
    v_and_b32 v225, 0xffff0000, v228
    v_lshlrev_b32 v226, 16, v229
    v_and_b32 v227, 0xffff0000, v229
    v_lshlrev_b32 v228, 16, v230
    v_and_b32 v229, 0xffff0000, v230
    v_lshlrev_b32 v230, 16, v231
    v_and_b32 v231, 0xffff0000, v231
    s_waitcnt vmcnt(12)
    s_nop 0
    v_dot2_f32_bf16 v86, v116, v17, 0
    v_dot2_f32_bf16 v76, v116, v116, 0
    v_dot2_f32_bf16 v86, v117, v17, v86
    v_dot2_f32_bf16 v76, v117, v117, v76
    v_dot2_f32_bf16 v86, v118, v17, v86
    v_dot2_f32_bf16 v76, v118, v118, v76
    v_dot2_f32_bf16 v86, v119, v17, v86
    v_dot2_f32_bf16 v76, v119, v119, v76
    v_lshlrev_b32 v112, 16, v116
    v_and_b32 v113, 0xffff0000, v116
    v_lshlrev_b32 v114, 16, v117
    v_and_b32 v115, 0xffff0000, v117
    v_lshlrev_b32 v116, 16, v118
    v_and_b32 v117, 0xffff0000, v118
    v_lshlrev_b32 v118, 16, v119
    v_and_b32 v119, 0xffff0000, v119
    s_waitcnt vmcnt(11)
    s_nop 0
    v_dot2_f32_bf16 v86, v156, v17, v86
    v_dot2_f32_bf16 v76, v156, v156, v76
    v_dot2_f32_bf16 v86, v157, v17, v86
    v_dot2_f32_bf16 v76, v157, v157, v76
    v_dot2_f32_bf16 v86, v158, v17, v86
    v_dot2_f32_bf16 v76, v158, v158, v76
    v_dot2_f32_bf16 v86, v159, v17, v86
    v_dot2_f32_bf16 v76, v159, v159, v76
    v_lshlrev_b32 v152, 16, v156
    v_and_b32 v153, 0xffff0000, v156
    v_lshlrev_b32 v154, 16, v157
    v_and_b32 v155, 0xffff0000, v157
    v_lshlrev_b32 v156, 16, v158
    v_and_b32 v157, 0xffff0000, v158
    v_lshlrev_b32 v158, 16, v159
    v_and_b32 v159, 0xffff0000, v159
    s_waitcnt vmcnt(10)
    s_nop 0
    v_dot2_f32_bf16 v86, v196, v17, v86
    v_dot2_f32_bf16 v76, v196, v196, v76
    v_dot2_f32_bf16 v86, v197, v17, v86
    v_dot2_f32_bf16 v76, v197, v197, v76
    v_dot2_f32_bf16 v86, v198, v17, v86
    v_dot2_f32_bf16 v76, v198, v198, v76
    v_dot2_f32_bf16 v86, v199, v17, v86
    v_dot2_f32_bf16 v76, v199, v199, v76
    v_lshlrev_b32 v192, 16, v196
    v_and_b32 v193, 0xffff0000, v196
    v_lshlrev_b32 v194, 16, v197
    v_and_b32 v195, 0xffff0000, v197
    v_lshlrev_b32 v196, 16, v198
    v_and_b32 v197, 0xffff0000, v198
    v_lshlrev_b32 v198, 16, v199
    v_and_b32 v199, 0xffff0000, v199
    s_waitcnt vmcnt(9)
    s_nop 0
    v_dot2_f32_bf16 v86, v236, v17, v86
    v_dot2_f32_bf16 v76, v236, v236, v76
    v_dot2_f32_bf16 v86, v237, v17, v86
    v_dot2_f32_bf16 v76, v237, v237, v76
    v_dot2_f32_bf16 v86, v238, v17, v86
    v_dot2_f32_bf16 v76, v238, v238, v76
    v_dot2_f32_bf16 v86, v239, v17, v86
    v_dot2_f32_bf16 v76, v239, v239, v76
    v_lshlrev_b32 v232, 16, v236
    v_and_b32 v233, 0xffff0000, v236
    v_lshlrev_b32 v234, 16, v237
    v_and_b32 v235, 0xffff0000, v237
    v_lshlrev_b32 v236, 16, v238
    v_and_b32 v237, 0xffff0000, v238
    v_lshlrev_b32 v238, 16, v239
    v_and_b32 v239, 0xffff0000, v239
    s_waitcnt vmcnt(8)
    s_nop 0
    v_dot2_f32_bf16 v88, v124, v17, 0
    v_dot2_f32_bf16 v78, v124, v124, 0
    v_dot2_f32_bf16 v88, v125, v17, v88
    v_dot2_f32_bf16 v78, v125, v125, v78
    v_dot2_f32_bf16 v88, v126, v17, v88
    v_dot2_f32_bf16 v78, v126, v126, v78
    v_dot2_f32_bf16 v88, v127, v17, v88
    v_dot2_f32_bf16 v78, v127, v127, v78
    v_lshlrev_b32 v120, 16, v124
    v_and_b32 v121, 0xffff0000, v124
    v_lshlrev_b32 v122, 16, v125
    v_and_b32 v123, 0xffff0000, v125
    v_lshlrev_b32 v124, 16, v126
    v_and_b32 v125, 0xffff0000, v126
    v_lshlrev_b32 v126, 16, v127
    v_and_b32 v127, 0xffff0000, v127
    s_waitcnt vmcnt(7)
    s_nop 0
    v_dot2_f32_bf16 v88, v164, v17, v88
    v_dot2_f32_bf16 v78, v164, v164, v78
    v_dot2_f32_bf16 v88, v165, v17, v88
    v_dot2_f32_bf16 v78, v165, v165, v78
    v_dot2_f32_bf16 v88, v166, v17, v88
    v_dot2_f32_bf16 v78, v166, v166, v78
    v_dot2_f32_bf16 v88, v167, v17, v88
    v_dot2_f32_bf16 v78, v167, v167, v78
    v_lshlrev_b32 v160, 16, v164
    v_and_b32 v161, 0xffff0000, v164
    v_lshlrev_b32 v162, 16, v165
    v_and_b32 v163, 0xffff0000, v165
    v_lshlrev_b32 v164, 16, v166
    v_and_b32 v165, 0xffff0000, v166
    v_lshlrev_b32 v166, 16, v167
    v_and_b32 v167, 0xffff0000, v167
    s_waitcnt vmcnt(6)
    s_nop 0
    v_dot2_f32_bf16 v88, v204, v17, v88
    v_dot2_f32_bf16 v78, v204, v204, v78
    v_dot2_f32_bf16 v88, v205, v17, v88
    v_dot2_f32_bf16 v78, v205, v205, v78
    v_dot2_f32_bf16 v88, v206, v17, v88
    v_dot2_f32_bf16 v78, v206, v206, v78
    v_dot2_f32_bf16 v88, v207, v17, v88
    v_dot2_f32_bf16 v78, v207, v207, v78
    v_lshlrev_b32 v200, 16, v204
    v_and_b32 v201, 0xffff0000, v204
    v_lshlrev_b32 v202, 16, v205
    v_and_b32 v203, 0xffff0000, v205
    v_lshlrev_b32 v204, 16, v206
    v_and_b32 v205, 0xffff0000, v206
    v_lshlrev_b32 v206, 16, v207
    v_and_b32 v207, 0xffff0000, v207
    s_waitcnt vmcnt(5)
    s_nop 0
    v_dot2_f32_bf16 v88, v244, v17, v88
    v_dot2_f32_bf16 v78, v244, v244, v78
    v_dot2_f32_bf16 v88, v245, v17, v88
    v_dot2_f32_bf16 v78, v245, v245, v78
    v_dot2_f32_bf16 v88, v246, v17, v88
    v_dot2_f32_bf16 v78, v246, v246, v78
    v_dot2_f32_bf16 v88, v247, v17, v88
    v_dot2_f32_bf16 v78, v247, v247, v78
    v_lshlrev_b32 v240, 16, v244
    v_and_b32 v241, 0xffff0000, v244
    v_lshlrev_b32 v242, 16, v245
    v_and_b32 v243, 0xffff0000, v245
    v_lshlrev_b32 v244, 16, v246
    v_and_b32 v245, 0xffff0000, v246
    v_lshlrev_b32 v246, 16, v247
    v_and_b32 v247, 0xffff0000, v247
    s_waitcnt vmcnt(4)
    s_nop 0
    v_dot2_f32_bf16 v90, v132, v17, 0
    v_dot2_f32_bf16 v80, v132, v132, 0
    v_dot2_f32_bf16 v90, v133, v17, v90
    v_dot2_f32_bf16 v80, v133, v133, v80
    v_dot2_f32_bf16 v90, v134, v17, v90
    v_dot2_f32_bf16 v80, v134, v134, v80
    v_dot2_f32_bf16 v90, v135, v17, v90
    v_dot2_f32_bf16 v80, v135, v135, v80
    v_lshlrev_b32 v128, 16, v132
    v_and_b32 v129, 0xffff0000, v132
    v_lshlrev_b32 v130, 16, v133
    v_and_b32 v131, 0xffff0000, v133
    v_lshlrev_b32 v132, 16, v134
    v_and_b32 v133, 0xffff0000, v134
    v_lshlrev_b32 v134, 16, v135
    v_and_b32 v135, 0xffff0000, v135
    s_waitcnt vmcnt(3)
    s_nop 0
    v_dot2_f32_bf16 v90, v172, v17, v90
    v_dot2_f32_bf16 v80, v172, v172, v80
    v_dot2_f32_bf16 v90, v173, v17, v90
    v_dot2_f32_bf16 v80, v173, v173, v80
    v_dot2_f32_bf16 v90, v174, v17, v90
    v_dot2_f32_bf16 v80, v174, v174, v80
    v_dot2_f32_bf16 v90, v175, v17, v90
    v_dot2_f32_bf16 v80, v175, v175, v80
    v_lshlrev_b32 v168, 16, v172
    v_and_b32 v169, 0xffff0000, v172
    v_lshlrev_b32 v170, 16, v173
    v_and_b32 v171, 0xffff0000, v173
    v_lshlrev_b32 v172, 16, v174
    v_and_b32 v173, 0xffff0000, v174
    v_lshlrev_b32 v174, 16, v175
    v_and_b32 v175, 0xffff0000, v175
    s_waitcnt vmcnt(2)
    s_nop 0
    v_dot2_f32_bf16 v90, v212, v17, v90
    v_dot2_f32_bf16 v80, v212, v212, v80
    v_dot2_f32_bf16 v90, v213, v17, v90
    v_dot2_f32_bf16 v80, v213, v213, v80
    v_dot2_f32_bf16 v90, v214, v17, v90
    v_dot2_f32_bf16 v80, v214, v214, v80
    v_dot2_f32_bf16 v90, v215, v17, v90
    v_dot2_f32_bf16 v80, v215, v215, v80
    v_lshlrev_b32 v208, 16, v212
    v_and_b32 v209, 0xffff0000, v212
    v_lshlrev_b32 v210, 16, v213
    v_and_b32 v211, 0xffff0000, v213
    v_lshlrev_b32 v212, 16, v214
    v_and_b32 v213, 0xffff0000, v214
    v_lshlrev_b32 v214, 16, v215
    v_and_b32 v215, 0xffff0000, v215
    s_waitcnt vmcnt(1)
    s_nop 0
    v_dot2_f32_bf16 v90, v252, v17, v90
    v_dot2_f32_bf16 v80, v252, v252, v80
    v_dot2_f32_bf16 v90, v253, v17, v90
    v_dot2_f32_bf16 v80, v253, v253, v80
    v_dot2_f32_bf16 v90, v254, v17, v90
    v_dot2_f32_bf16 v80, v254, v254, v80
    v_dot2_f32_bf16 v90, v255, v17, v90
    v_dot2_f32_bf16 v80, v255, v255, v80
    v_lshlrev_b32 v248, 16, v252
    v_and_b32 v249, 0xffff0000, v252
    v_lshlrev_b32 v250, 16, v253
    v_and_b32 v251, 0xffff0000, v253
    v_lshlrev_b32 v252, 16, v254
    v_and_b32 v253, 0xffff0000, v254
    v_lshlrev_b32 v254, 16, v255
    v_and_b32 v255, 0xffff0000, v255
    v_add_f32_dpp v82, v82, v82 row_ror:8 row_mask:0xf bank_mask:0xf
    v_add_f32_dpp v72, v72, v72 row_ror:8 row_mask:0xf bank_mask:0xf
    v_add_f32_dpp v84, v84, v84 row_ror:8 row_mask:0xf bank_mask:0xf
    v_add_f32_dpp v74, v74, v74 row_ror:8 row_mask:0xf bank_mask:0xf
    v_add_f32_dpp v86, v86, v86 row_ror:8 row_mask:0xf bank_mask:0xf
    v_add_f32_dpp v76, v76, v76 row_ror:8 row_mask:0xf bank_mask:0xf
    v_add_f32_dpp v88, v88, v88 row_ror:8 row_mask:0xf bank_mask:0xf
    v_add_f32_dpp v78, v78, v78 row_ror:8 row_mask:0xf bank_mask:0xf
    v_add_f32_dpp v90, v90, v90 row_ror:8 row_mask:0xf bank_mask:0xf
    v_add_f32_dpp v80, v80, v80 row_ror:8 row_mask:0xf bank_mask:0xf
    v_add_f32_dpp v82, v82, v82 row_ror:4 row_mask:0xf bank_mask:0xf
    v_add_f32_dpp v72, v72, v72 row_ror:4 row_mask:0xf bank_mask:0xf
    v_add_f32_dpp v84, v84, v84 row_ror:4 row_mask:0xf bank_mask:0xf
    v_add_f32_dpp v74, v74, v74 row_ror:4 row_mask:0xf bank_mask:0xf
    v_add_f32_dpp v86, v86, v86 row_ror:4 row_mask:0xf bank_mask:0xf
    v_add_f32_dpp v76, v76, v76 row_ror:4 row_mask:0xf bank_mask:0xf
    v_add_f32_dpp v88, v88, v88 row_ror:4 row_mask:0xf bank_mask:0xf
    v_add_f32_dpp v78, v78, v78 row_ror:4 row_mask:0xf bank_mask:0xf
    v_add_f32_dpp v90, v90, v90 row_ror:4 row_mask:0xf bank_mask:0xf
    v_add_f32_dpp v80, v80, v80 row_ror:4 row_mask:0xf bank_mask:0xf
    v_add_f32_dpp v82, v82, v82 row_ror:2 row_mask:0xf bank_mask:0xf
    v_add_f32_dpp v72, v72, v72 row_ror:2 row_mask:0xf bank_mask:0xf
    v_add_f32_dpp v84, v84, v84 row_ror:2 row_mask:0xf bank_mask:0xf
    v_add_f32_dpp v74, v74, v74 row_ror:2 row_mask:0xf bank_mask:0xf
    v_add_f32_dpp v86, v86, v86 row_ror:2 row_mask:0xf bank_mask:0xf
    v_add_f32_dpp v76, v76, v76 row_ror:2 row_mask:0xf bank_mask:0xf
    v_add_f32_dpp v88, v88, v88 row_ror:2 row_mask:0xf bank_mask:0xf
    v_add_f32_dpp v78, v78, v78 row_ror:2 row_mask:0xf bank_mask:0xf
    v_add_f32_dpp v90, v90, v90 row_ror:2 row_mask:0xf bank_mask:0xf
    v_add_f32_dpp v80, v80, v80 row_ror:2 row_mask:0xf bank_mask:0xf
    v_add_f32_dpp v82, v82, v82 row_ror:1 row_mask:0xf bank_mask:0xf
    v_add_f32_dpp v72, v72, v72 row_ror:1 row_mask:0xf bank_mask:0xf
    v_add_f32_dpp v84, v84, v84 row_ror:1 row_mask:0xf bank_mask:0xf
    v_add_f32_dpp v74, v74, v74 row_ror:1 row_mask:0xf bank_mask:0xf
    v_add_f32_dpp v86, v86, v86 row_ror:1 row_mask:0xf bank_mask:0xf
    v_add_f32_dpp v76, v76, v76 row_ror:1 row_mask:0xf bank_mask:0xf
    v_add_f32_dpp v88, v88, v88 row_ror:1 row_mask:0xf bank_mask:0xf
    v_add_f32_dpp v78, v78, v78 row_ror:1 row_mask:0xf bank_mask:0xf
    v_add_f32_dpp v90, v90, v90 row_ror:1 row_mask:0xf bank_mask:0xf
    v_add_f32_dpp v80, v80, v80 row_ror:1 row_mask:0xf bank_mask:0xf
    v_mul_f32 v82, 0x3b000000, v82
    v_mul_f32 v72, 0x3b000000, v72
    v_mul_f32 v84, 0x3b000000, v84
    v_mul_f32 v74, 0x3b000000, v74
    v_mul_f32 v86, 0x3b000000, v86
    v_mul_f32 v76, 0x3b000000, v76
    v_mul_f32 v88, 0x3b000000, v88
    v_mul_f32 v78, 0x3b000000, v78
    v_mul_f32 v90, 0x3b000000, v90
    v_mul_f32 v80, 0x3b000000, v80
    v_fma_f32 v72, -v82, v82, v72
    v_fma_f32 v74, -v84, v84, v74
    v_fma_f32 v76, -v86, v86, v76
    v_fma_f32 v78, -v88, v88, v78
    v_fma_f32 v80, -v90, v90, v80
    v_max_f32 v72, 0, v72
    v_max_f32 v74, 0, v74
    v_max_f32 v76, 0, v76
    v_max_f32 v78, 0, v78
    v_max_f32_e64 v80, 0, v80
    v_add_f32 v72, 0x3727c5ac, v72
    v_add_f32 v74, 0x3727c5ac, v74
    v_add_f32 v76, 0x3727c5ac, v76
    v_add_f32 v78, 0x3727c5ac, v78
    v_add_f32 v80, 0x3727c5ac, v80
    v_rsq_f32 v72, v72
    v_rsq_f32 v74, v74
    v_rsq_f32 v76, v76
    v_rsq_f32 v78, v78
    v_rsq_f32 v80, v80
    v_mul_f32 v82, v82, v72
    v_mul_f32 v84, v84, v74
    v_mul_f32 v86, v86, v76
    v_mul_f32 v88, v88, v78
    v_mul_f32 v90, v90, v80
    v_pk_fma_f32 v[96:97], v[96:97], v[72:73], v[82:83] op_sel_hi:[1,0,0] neg_lo:[0,0,1] neg_hi:[0,0,1]
    v_pk_fma_f32 v[98:99], v[98:99], v[72:73], v[82:83] op_sel_hi:[1,0,0] neg_lo:[0,0,1] neg_hi:[0,0,1]
    v_pk_fma_f32 v[100:101], v[100:101], v[72:73], v[82:83] op_sel_hi:[1,0,0] neg_lo:[0,0,1] neg_hi:[0,0,1]
    v_pk_fma_f32 v[102:103], v[102:103], v[72:73], v[82:83] op_sel_hi:[1,0,0] neg_lo:[0,0,1] neg_hi:[0,0,1]
    v_pk_fma_f32 v[104:105], v[104:105], v[74:75], v[84:85] op_sel_hi:[1,0,0] neg_lo:[0,0,1] neg_hi:[0,0,1]
    v_pk_fma_f32 v[106:107], v[106:107], v[74:75], v[84:85] op_sel_hi:[1,0,0] neg_lo:[0,0,1] neg_hi:[0,0,1]
    v_pk_fma_f32 v[108:109], v[108:109], v[74:75], v[84:85] op_sel_hi:[1,0,0] neg_lo:[0,0,1] neg_hi:[0,0,1]
    v_pk_fma_f32 v[110:111], v[110:111], v[74:75], v[84:85] op_sel_hi:[1,0,0] neg_lo:[0,0,1] neg_hi:[0,0,1]
    v_pk_fma_f32 v[112:113], v[112:113], v[76:77], v[86:87] op_sel_hi:[1,0,0] neg_lo:[0,0,1] neg_hi:[0,0,1]
    v_pk_fma_f32 v[114:115], v[114:115], v[76:77], v[86:87] op_sel_hi:[1,0,0] neg_lo:[0,0,1] neg_hi:[0,0,1]
    v_pk_fma_f32 v[116:117], v[116:117], v[76:77], v[86:87] op_sel_hi:[1,0,0] neg_lo:[0,0,1] neg_hi:[0,0,1]
    v_pk_fma_f32 v[118:119], v[118:119], v[76:77], v[86:87] op_sel_hi:[1,0,0] neg_lo:[0,0,1] neg_hi:[0,0,1]
    v_pk_fma_f32 v[120:121], v[120:121], v[78:79], v[88:89] op_sel_hi:[1,0,0] neg_lo:[0,0,1] neg_hi:[0,0,1]
    v_pk_fma_f32 v[122:123], v[122:123], v[78:79], v[88:89] op_sel_hi:[1,0,0] neg_lo:[0,0,1] neg_hi:[0,0,1]
    v_pk_fma_f32 v[124:125], v[124:125], v[78:79], v[88:89] op_sel_hi:[1,0,0] neg_lo:[0,0,1] neg_hi:[0,0,1]
    v_pk_fma_f32 v[126:127], v[126:127], v[78:79], v[88:89] op_sel_hi:[1,0,0] neg_lo:[0,0,1] neg_hi:[0,0,1]
    v_pk_fma_f32 v[128:129], v[128:129], v[80:81], v[90:91] op_sel_hi:[1,0,0] neg_lo:[0,0,1] neg_hi:[0,0,1]
    v_pk_fma_f32 v[130:131], v[130:131], v[80:81], v[90:91] op_sel_hi:[1,0,0] neg_lo:[0,0,1] neg_hi:[0,0,1]
    v_pk_fma_f32 v[132:133], v[132:133], v[80:81], v[90:91] op_sel_hi:[1,0,0] neg_lo:[0,0,1] neg_hi:[0,0,1]
    v_pk_fma_f32 v[134:135], v[134:135], v[80:81], v[90:91] op_sel_hi:[1,0,0] neg_lo:[0,0,1] neg_hi:[0,0,1]
    v_pk_fma_f32 v[136:137], v[136:137], v[72:73], v[82:83] op_sel_hi:[1,0,0] neg_lo:[0,0,1] neg_hi:[0,0,1]
    v_pk_fma_f32 v[138:139], v[138:139], v[72:73], v[82:83] op_sel_hi:[1,0,0] neg_lo:[0,0,1] neg_hi:[0,0,1]
    v_pk_fma_f32 v[140:141], v[140:141], v[72:73], v[82:83] op_sel_hi:[1,0,0] neg_lo:[0,0,1] neg_hi:[0,0,1]
    v_pk_fma_f32 v[142:143], v[142:143], v[72:73], v[82:83] op_sel_hi:[1,0,0] neg_lo:[0,0,1] neg_hi:[0,0,1]
    v_pk_fma_f32 v[144:145], v[144:145], v[74:75], v[84:85] op_sel_hi:[1,0,0] neg_lo:[0,0,1] neg_hi:[0,0,1]
    v_pk_fma_f32 v[146:147], v[146:147], v[74:75], v[84:85] op_sel_hi:[1,0,0] neg_lo:[0,0,1] neg_hi:[0,0,1]
    v_pk_fma_f32 v[148:149], v[148:149], v[74:75], v[84:85] op_sel_hi:[1,0,0] neg_lo:[0,0,1] neg_hi:[0,0,1]
    v_pk_fma_f32 v[150:151], v[150:151], v[74:75], v[84:85] op_sel_hi:[1,0,0] neg_lo:[0,0,1] neg_hi:[0,0,1]
    v_pk_fma_f32 v[152:153], v[152:153], v[76:77], v[86:87] op_sel_hi:[1,0,0] neg_lo:[0,0,1] neg_hi:[0,0,1]
    v_pk_fma_f32 v[154:155], v[154:155], v[76:77], v[86:87] op_sel_hi:[1,0,0] neg_lo:[0,0,1] neg_hi:[0,0,1]
    v_pk_fma_f32 v[156:157], v[156:157], v[76:77], v[86:87] op_sel_hi:[1,0,0] neg_lo:[0,0,1] neg_hi:[0,0,1]
    v_pk_fma_f32 v[158:159], v[158:159], v[76:77], v[86:87] op_sel_hi:[1,0,0] neg_lo:[0,0,1] neg_hi:[0,0,1]
    v_pk_fma_f32 v[160:161], v[160:161], v[78:79], v[88:89] op_sel_hi:[1,0,0] neg_lo:[0,0,1] neg_hi:[0,0,1]
    v_pk_fma_f32 v[162:163], v[162:163], v[78:79], v[88:89] op_sel_hi:[1,0,0] neg_lo:[0,0,1] neg_hi:[0,0,1]
    v_pk_fma_f32 v[164:165], v[164:165], v[78:79], v[88:89] op_sel_hi:[1,0,0] neg_lo:[0,0,1] neg_hi:[0,0,1]
    v_pk_fma_f32 v[166:167], v[166:167], v[78:79], v[88:89] op_sel_hi:[1,0,0] neg_lo:[0,0,1] neg_hi:[0,0,1]
    v_pk_fma_f32 v[168:169], v[168:169], v[80:81], v[90:91] op_sel_hi:[1,0,0] neg_lo:[0,0,1] neg_hi:[0,0,1]
    v_pk_fma_f32 v[170:171], v[170:171], v[80:81], v[90:91] op_sel_hi:[1,0,0] neg_lo:[0,0,1] neg_hi:[0,0,1]
    v_pk_fma_f32 v[172:173], v[172:173], v[80:81], v[90:91] op_sel_hi:[1,0,0] neg_lo:[0,0,1] neg_hi:[0,0,1]
    v_pk_fma_f32 v[174:175], v[174:175], v[80:81], v[90:91] op_sel_hi:[1,0,0] neg_lo:[0,0,1] neg_hi:[0,0,1]
    v_pk_fma_f32 v[176:177], v[176:177], v[72:73], v[82:83] op_sel_hi:[1,0,0] neg_lo:[0,0,1] neg_hi:[0,0,1]
    v_pk_fma_f32 v[178:179], v[178:179], v[72:73], v[82:83] op_sel_hi:[1,0,0] neg_lo:[0,0,1] neg_hi:[0,0,1]
    v_pk_fma_f32 v[180:181], v[180:181], v[72:73], v[82:83] op_sel_hi:[1,0,0] neg_lo:[0,0,1] neg_hi:[0,0,1]
    v_pk_fma_f32 v[182:183], v[182:183], v[72:73], v[82:83] op_sel_hi:[1,0,0] neg_lo:[0,0,1] neg_hi:[0,0,1]
    v_pk_fma_f32 v[184:185], v[184:185], v[74:75], v[84:85] op_sel_hi:[1,0,0] neg_lo:[0,0,1] neg_hi:[0,0,1]
    v_pk_fma_f32 v[186:187], v[186:187], v[74:75], v[84:85] op_sel_hi:[1,0,0] neg_lo:[0,0,1] neg_hi:[0,0,1]
    v_pk_fma_f32 v[188:189], v[188:189], v[74:75], v[84:85] op_sel_hi:[1,0,0] neg_lo:[0,0,1] neg_hi:[0,0,1]
    v_pk_fma_f32 v[190:191], v[190:191], v[74:75], v[84:85] op_sel_hi:[1,0,0] neg_lo:[0,0,1] neg_hi:[0,0,1]
    v_pk_fma_f32 v[192:193], v[192:193], v[76:77], v[86:87] op_sel_hi:[1,0,0] neg_lo:[0,0,1] neg_hi:[0,0,1]
    v_pk_fma_f32 v[194:195], v[194:195], v[76:77], v[86:87] op_sel_hi:[1,0,0] neg_lo:[0,0,1] neg_hi:[0,0,1]
    v_pk_fma_f32 v[196:197], v[196:197], v[76:77], v[86:87] op_sel_hi:[1,0,0] neg_lo:[0,0,1] neg_hi:[0,0,1]
    v_pk_fma_f32 v[198:199], v[198:199], v[76:77], v[86:87] op_sel_hi:[1,0,0] neg_lo:[0,0,1] neg_hi:[0,0,1]
    v_pk_fma_f32 v[200:201], v[200:201], v[78:79], v[88:89] op_sel_hi:[1,0,0] neg_lo:[0,0,1] neg_hi:[0,0,1]
    v_pk_fma_f32 v[202:203], v[202:203], v[78:79], v[88:89] op_sel_hi:[1,0,0] neg_lo:[0,0,1] neg_hi:[0,0,1]
    v_pk_fma_f32 v[204:205], v[204:205], v[78:79], v[88:89] op_sel_hi:[1,0,0] neg_lo:[0,0,1] neg_hi:[0,0,1]
    v_pk_fma_f32 v[206:207], v[206:207], v[78:79], v[88:89] op_sel_hi:[1,0,0] neg_lo:[0,0,1] neg_hi:[0,0,1]
    v_pk_fma_f32 v[208:209], v[208:209], v[80:81], v[90:91] op_sel_hi:[1,0,0] neg_lo:[0,0,1] neg_hi:[0,0,1]
    v_pk_fma_f32 v[210:211], v[210:211], v[80:81], v[90:91] op_sel_hi:[1,0,0] neg_lo:[0,0,1] neg_hi:[0,0,1]
    v_pk_fma_f32 v[212:213], v[212:213], v[80:81], v[90:91] op_sel_hi:[1,0,0] neg_lo:[0,0,1] neg_hi:[0,0,1]
    v_pk_fma_f32 v[214:215], v[214:215], v[80:81], v[90:91] op_sel_hi:[1,0,0] neg_lo:[0,0,1] neg_hi:[0,0,1]
    v_pk_fma_f32 v[216:217], v[216:217], v[72:73], v[82:83] op_sel_hi:[1,0,0] neg_lo:[0,0,1] neg_hi:[0,0,1]
    v_pk_fma_f32 v[218:219], v[218:219], v[72:73], v[82:83] op_sel_hi:[1,0,0] neg_lo:[0,0,1] neg_hi:[0,0,1]
    v_pk_fma_f32 v[220:221], v[220:221], v[72:73], v[82:83] op_sel_hi:[1,0,0] neg_lo:[0,0,1] neg_hi:[0,0,1]
    v_pk_fma_f32 v[222:223], v[222:223], v[72:73], v[82:83] op_sel_hi:[1,0,0] neg_lo:[0,0,1] neg_hi:[0,0,1]
    v_pk_fma_f32 v[224:225], v[224:225], v[74:75], v[84:85] op_sel_hi:[1,0,0] neg_lo:[0,0,1] neg_hi:[0,0,1]
    v_pk_fma_f32 v[226:227], v[226:227], v[74:75], v[84:85] op_sel_hi:[1,0,0] neg_lo:[0,0,1] neg_hi:[0,0,1]
    v_pk_fma_f32 v[228:229], v[228:229], v[74:75], v[84:85] op_sel_hi:[1,0,0] neg_lo:[0,0,1] neg_hi:[0,0,1]
    v_pk_fma_f32 v[230:231], v[230:231], v[74:75], v[84:85] op_sel_hi:[1,0,0] neg_lo:[0,0,1] neg_hi:[0,0,1]
    v_pk_fma_f32 v[232:233], v[232:233], v[76:77], v[86:87] op_sel_hi:[1,0,0] neg_lo:[0,0,1] neg_hi:[0,0,1]
    v_pk_fma_f32 v[234:235], v[234:235], v[76:77], v[86:87] op_sel_hi:[1,0,0] neg_lo:[0,0,1] neg_hi:[0,0,1]
    v_pk_fma_f32 v[236:237], v[236:237], v[76:77], v[86:87] op_sel_hi:[1,0,0] neg_lo:[0,0,1] neg_hi:[0,0,1]
    v_pk_fma_f32 v[238:239], v[238:239], v[76:77], v[86:87] op_sel_hi:[1,0,0] neg_lo:[0,0,1] neg_hi:[0,0,1]
    v_pk_fma_f32 v[240:241], v[240:241], v[78:79], v[88:89] op_sel_hi:[1,0,0] neg_lo:[0,0,1] neg_hi:[0,0,1]
    v_pk_fma_f32 v[242:243], v[242:243], v[78:79], v[88:89] op_sel_hi:[1,0,0] neg_lo:[0,0,1] neg_hi:[0,0,1]
    v_pk_fma_f32 v[244:245], v[244:245], v[78:79], v[88:89] op_sel_hi:[1,0,0] neg_lo:[0,0,1] neg_hi:[0,0,1]
    v_pk_fma_f32 v[246:247], v[246:247], v[78:79], v[88:89] op_sel_hi:[1,0,0] neg_lo:[0,0,1] neg_hi:[0,0,1]
    v_pk_fma_f32 v[248:249], v[248:249], v[80:81], v[90:91] op_sel_hi:[1,0,0] neg_lo:[0,0,1] neg_hi:[0,0,1]
    v_pk_fma_f32 v[250:251], v[250:251], v[80:81], v[90:91] op_sel_hi:[1,0,0] neg_lo:[0,0,1] neg_hi:[0,0,1]
    v_pk_fma_f32 v[252:253], v[252:253], v[80:81], v[90:91] op_sel_hi:[1,0,0] neg_lo:[0,0,1] neg_hi:[0,0,1]
    v_pk_fma_f32 v[254:255], v[254:255], v[80:81], v[90:91] op_sel_hi:[1,0,0] neg_lo:[0,0,1] neg_hi:[0,0,1]
    v_lshrrev_b32 v2, 2, v70
    v_mul_u32_u24 v2, 5120, v2
    v_and_b32 v3, 3, v70
    v_lshl_add_u32 v2, v3, 8, v2
    v_and_b32 v3, 15, v70
    v_add_u32 v5, s92, v69
    v_lshrrev_b32 v64, 4, v5
    v_lshl_add_u32 v64, v64, 10, v2
    v_and_b32 v5, 15, v5
    v_xor_b32 v5, v5, v3
    v_lshl_add_u32 v64, v5, 4, v64
    v_add_u32 v5, s93, v69
    v_lshrrev_b32 v65, 4, v5
    v_lshl_add_u32 v65, v65, 10, v2
    v_and_b32 v5, 15, v5
    v_xor_b32 v5, v5, v3
    v_lshl_add_u32 v65, v5, 4, v65
    v_add_u32 v5, s94, v69
    v_lshrrev_b32 v66, 4, v5
    v_lshl_add_u32 v66, v66, 10, v2
    v_and_b32 v5, 15, v5
    v_xor_b32 v5, v5, v3
    v_lshl_add_u32 v66, v5, 4, v66
    v_add_u32 v5, s95, v69
    v_lshrrev_b32 v67, 4, v5
    v_lshl_add_u32 v67, v67, 10, v2
    v_and_b32 v5, 15, v5
    v_xor_b32 v5, v5, v3
    v_lshl_add_u32 v67, v5, 4, v67
    v_add_u32 v5, s96, v69
    v_lshrrev_b32 v68, 4, v5
    v_lshl_add_u32 v68, v68, 10, v2
    v_and_b32 v5, 15, v5
    v_xor_b32 v5, v5, v3
    v_lshl_add_u32 v68, v5, 4, v68
    v_lshlrev_b32 v28, 5, v70
    v_add_u32 v28, 147456, v28
    v_and_b32 v69, 7, v0
    v_lshlrev_b32 v69, 3, v69
    s_lshl_b32 s3, s4, 6
    s_add_u32 s94, s3, 2048
    s_and_b32 s9, s13, 1
    s_lshl_b32 s3, s9, 11
    s_add_u32 s3, s3, 147456
    v_add_u32 v14, s3, v1
    v_and_b32 v2, 31, v0
    s_lshl_b32 s3, s9, 10
    s_add_u32 s3, s3, 159744
    v_lshl_add_u32 v15, v2, 5, s3
    v_and_b32 v2, 15, v0
    v_lshrrev_b32 v3, 4, v0
    v_mov_b32 v75, 151552
    v_mov_b32 v4, 152576
    v_cmp_eq_u32 vcc, 1, v2
    s_nop 1
    v_cndmask_b32 v75, v75, v4, vcc
    v_mov_b32 v4, 155648
    v_cmp_eq_u32 vcc, 0, v2
    s_nop 1
    v_cndmask_b32 v75, v75, v4, vcc
    v_lshl_add_u32 v75, v3, 3, v75
    s_lshl_b32 s3, s9, 7
    s_add_u32 s3, s3, 158720
    v_lshl_add_u32 v77, v2, 8, s3
    v_lshl_add_u32 v77, v3, 4, v77
    v_lshrrev_b32 v2, 2, v0
    v_lshrrev_b32 v4, 1, v2
    v_xor_b32 v4, s9, v4
    v_and_b32 v4, 1, v4
    v_lshlrev_b32 v4, 6, v4
    v_lshl_add_u32 v4, v2, 7, v4
    v_and_b32_e64 v2, 3, v0
    v_lshl_add_u32 v4, v2, 3, v4
    v_add_u32 v76, 0x10000, v4
    v_mov_b32 v16, 0x7fffffff
    v_cmp_eq_u32 vcc, 0, v0
    s_nop 1
    v_cndmask_b32 v16, v16, v0, vcc
    s_lshl_b32 s3, s13, 13
    v_add_u32 v12, s3, v1
    v_add_u32 v13, 0x10000, v12
    s_lshr_b32 s8, s13, 1
    s_lshl_b32 s8, s8, 12
    s_lshl_b32 s3, s13, 11
    s_add_u32 s3, s3, s8
    s_add_u32 s3, s3, 131072
    v_add_u32 v78, s3, v1
    s_barrier
    s_nop 0
    ds_read_b128 v[32:35], v28 offset:0
    ds_read_b128 v[40:43], v28 offset:2048
    ds_read_b128 v[36:39], v28 offset:16
    ds_read_b128 v[44:47], v28 offset:2064
    ds_read_b128 v[48:51], v28 offset:512
    ds_read_b128 v[56:59], v28 offset:2560
    ds_read_b128 v[52:55], v28 offset:528
    ds_read_b128 v[60:63], v28 offset:2576
    s_waitcnt lgkmcnt(4)
    s_nop 0
    v_pk_fma_f32 v[96:97], v[96:97], v[40:41], v[32:33]
    v_pk_fma_f32 v[98:99], v[98:99], v[42:43], v[34:35]
    v_pk_fma_f32 v[100:101], v[100:101], v[44:45], v[36:37]
    v_pk_fma_f32 v[102:103], v[102:103], v[46:47], v[38:39]
    v_cvt_pk_bf16_f32 v96, v96, v97
    v_cvt_pk_bf16_f32 v97, v98, v99
    v_cvt_pk_bf16_f32 v98, v100, v101
    v_cvt_pk_bf16_f32 v99, v102, v103
    ds_write_b128 v64, v[96:99] offset:0
    v_pk_fma_f32 v[104:105], v[104:105], v[40:41], v[32:33]
    v_pk_fma_f32 v[106:107], v[106:107], v[42:43], v[34:35]
    v_pk_fma_f32 v[108:109], v[108:109], v[44:45], v[36:37]
    v_pk_fma_f32 v[110:111], v[110:111], v[46:47], v[38:39]
    v_cvt_pk_bf16_f32 v104, v104, v105
    v_cvt_pk_bf16_f32 v105, v106, v107
    v_cvt_pk_bf16_f32 v106, v108, v109
    v_cvt_pk_bf16_f32 v107, v110, v111
    ds_write_b128 v65, v[104:107] offset:0
    v_pk_fma_f32 v[112:113], v[112:113], v[40:41], v[32:33]
    v_pk_fma_f32 v[114:115], v[114:115], v[42:43], v[34:35]
    v_pk_fma_f32 v[116:117], v[116:117], v[44:45], v[36:37]
    v_pk_fma_f32 v[118:119], v[118:119], v[46:47], v[38:39]
    v_cvt_pk_bf16_f32 v112, v112, v113
    v_cvt_pk_bf16_f32 v113, v114, v115
    v_cvt_pk_bf16_f32 v114, v116, v117
    v_cvt_pk_bf16_f32 v115, v118, v119
    ds_write_b128 v66, v[112:115] offset:0
    v_pk_fma_f32 v[120:121], v[120:121], v[40:41], v[32:33]
    v_pk_fma_f32 v[122:123], v[122:123], v[42:43], v[34:35]
    v_pk_fma_f32 v[124:125], v[124:125], v[44:45], v[36:37]
    v_pk_fma_f32 v[126:127], v[126:127], v[46:47], v[38:39]
    v_cvt_pk_bf16_f32 v120, v120, v121
    v_cvt_pk_bf16_f32 v121, v122, v123
    v_cvt_pk_bf16_f32 v122, v124, v125
    v_cvt_pk_bf16_f32 v123, v126, v127
    ds_write_b128 v67, v[120:123] offset:0
    v_pk_fma_f32 v[128:129], v[128:129], v[40:41], v[32:33]
    v_pk_fma_f32 v[130:131], v[130:131], v[42:43], v[34:35]
    v_pk_fma_f32 v[132:133], v[132:133], v[44:45], v[36:37]
    v_pk_fma_f32 v[134:135], v[134:135], v[46:47], v[38:39]
    ds_read_b128 v[32:35], v28 offset:1024
    ds_read_b128 v[40:43], v28 offset:3072
    ds_read_b128 v[36:39], v28 offset:1040
    ds_read_b128 v[44:47], v28 offset:3088
    v_cvt_pk_bf16_f32 v128, v128, v129
    v_cvt_pk_bf16_f32 v129, v130, v131
    v_cvt_pk_bf16_f32 v130, v132, v133
    v_cvt_pk_bf16_f32 v131, v134, v135
    ds_write_b128 v68, v[128:131] offset:0
    s_waitcnt lgkmcnt(9)
    s_nop 0
    v_pk_fma_f32 v[136:137], v[136:137], v[56:57], v[48:49]
    v_pk_fma_f32 v[138:139], v[138:139], v[58:59], v[50:51]
    v_pk_fma_f32 v[140:141], v[140:141], v[60:61], v[52:53]
    v_pk_fma_f32 v[142:143], v[142:143], v[62:63], v[54:55]
    v_cvt_pk_bf16_f32 v136, v136, v137
    v_cvt_pk_bf16_f32 v137, v138, v139
    v_cvt_pk_bf16_f32 v138, v140, v141
    v_cvt_pk_bf16_f32 v139, v142, v143
    v_pk_fma_f32 v[144:145], v[144:145], v[56:57], v[48:49]
    v_pk_fma_f32 v[146:147], v[146:147], v[58:59], v[50:51]
    v_pk_fma_f32 v[148:149], v[148:149], v[60:61], v[52:53]
    v_pk_fma_f32 v[150:151], v[150:151], v[62:63], v[54:55]
    v_cvt_pk_bf16_f32 v144, v144, v145
    v_cvt_pk_bf16_f32 v145, v146, v147
    v_cvt_pk_bf16_f32 v146, v148, v149
    v_cvt_pk_bf16_f32 v147, v150, v151
    v_pk_fma_f32 v[152:153], v[152:153], v[56:57], v[48:49]
    v_pk_fma_f32 v[154:155], v[154:155], v[58:59], v[50:51]
    v_pk_fma_f32 v[156:157], v[156:157], v[60:61], v[52:53]
    v_pk_fma_f32 v[158:159], v[158:159], v[62:63], v[54:55]
    v_cvt_pk_bf16_f32 v152, v152, v153
    v_cvt_pk_bf16_f32 v153, v154, v155
    v_cvt_pk_bf16_f32 v154, v156, v157
    v_cvt_pk_bf16_f32 v155, v158, v159
    s_barrier
    s_nop 0
    v_pk_fma_f32 v[160:161], v[160:161], v[56:57], v[48:49]
    v_pk_fma_f32 v[162:163], v[162:163], v[58:59], v[50:51]
    v_pk_fma_f32 v[164:165], v[164:165], v[60:61], v[52:53]
    v_pk_fma_f32 v[166:167], v[166:167], v[62:63], v[54:55]
    ds_write_b128 v64, v[136:139] offset:20480
    v_cvt_pk_bf16_f32 v160, v160, v161
    v_cvt_pk_bf16_f32 v161, v162, v163
    v_cvt_pk_bf16_f32 v162, v164, v165
    v_cvt_pk_bf16_f32 v163, v166, v167
    v_pk_fma_f32 v[168:169], v[168:169], v[56:57], v[48:49]
    v_pk_fma_f32 v[170:171], v[170:171], v[58:59], v[50:51]
    v_pk_fma_f32 v[172:173], v[172:173], v[60:61], v[52:53]
    v_pk_fma_f32 v[174:175], v[174:175], v[62:63], v[54:55]
    ds_read_b128 v[48:51], v28 offset:1536
    ds_read_b128 v[56:59], v28 offset:3584
    ds_read_b128 v[52:55], v28 offset:1552
    ds_read_b128 v[60:63], v28 offset:3600
    ds_write_b128 v65, v[144:147] offset:20480
    v_cvt_pk_bf16_f32 v168, v168, v169
    v_cvt_pk_bf16_f32 v169, v170, v171
    v_cvt_pk_bf16_f32 v170, v172, v173
    v_cvt_pk_bf16_f32 v171, v174, v175
    s_waitcnt lgkmcnt(7)
    s_nop 0
    v_pk_fma_f32 v[176:177], v[176:177], v[40:41], v[32:33]
    v_pk_fma_f32 v[178:179], v[178:179], v[42:43], v[34:35]
    v_pk_fma_f32 v[180:181], v[180:181], v[44:45], v[36:37]
    v_pk_fma_f32 v[182:183], v[182:183], v[46:47], v[38:39]
    ds_write_b128 v66, v[152:155] offset:20480
    v_cvt_pk_bf16_f32 v176, v176, v177
    v_cvt_pk_bf16_f32 v177, v178, v179
    v_cvt_pk_bf16_f32 v178, v180, v181
    v_cvt_pk_bf16_f32 v179, v182, v183
    v_pk_fma_f32 v[184:185], v[184:185], v[40:41], v[32:33]
    v_pk_fma_f32 v[186:187], v[186:187], v[42:43], v[34:35]
    v_pk_fma_f32 v[188:189], v[188:189], v[44:45], v[36:37]
    v_pk_fma_f32 v[190:191], v[190:191], v[46:47], v[38:39]
    ds_write_b128 v67, v[160:163] offset:20480
    v_cvt_pk_bf16_f32 v184, v184, v185
    v_cvt_pk_bf16_f32 v185, v186, v187
    v_cvt_pk_bf16_f32 v186, v188, v189
    v_cvt_pk_bf16_f32 v187, v190, v191
    v_pk_fma_f32 v[192:193], v[192:193], v[40:41], v[32:33]
    v_pk_fma_f32 v[194:195], v[194:195], v[42:43], v[34:35]
    v_pk_fma_f32 v[196:197], v[196:197], v[44:45], v[36:37]
    v_pk_fma_f32 v[198:199], v[198:199], v[46:47], v[38:39]
    ds_write_b128 v68, v[168:171] offset:20480
    v_cvt_pk_bf16_f32 v192, v192, v193
    v_cvt_pk_bf16_f32 v193, v194, v195
    v_cvt_pk_bf16_f32 v194, v196, v197
    v_cvt_pk_bf16_f32 v195, v198, v199
    v_pk_fma_f32 v[200:201], v[200:201], v[40:41], v[32:33]
    v_pk_fma_f32 v[202:203], v[202:203], v[42:43], v[34:35]
    v_pk_fma_f32 v[204:205], v[204:205], v[44:45], v[36:37]
    v_pk_fma_f32 v[206:207], v[206:207], v[46:47], v[38:39]
    ds_write_b128 v64, v[176:179] offset:40960
    v_cvt_pk_bf16_f32 v200, v200, v201
    v_cvt_pk_bf16_f32 v201, v202, v203
    v_cvt_pk_bf16_f32 v202, v204, v205
    v_cvt_pk_bf16_f32 v203, v206, v207
    v_pk_fma_f32 v[208:209], v[208:209], v[40:41], v[32:33]
    v_pk_fma_f32 v[210:211], v[210:211], v[42:43], v[34:35]
    v_pk_fma_f32 v[212:213], v[212:213], v[44:45], v[36:37]
    v_pk_fma_f32 v[214:215], v[214:215], v[46:47], v[38:39]
    ds_write_b128 v65, v[184:187] offset:40960
    v_cvt_pk_bf16_f32 v208, v208, v209
    v_cvt_pk_bf16_f32 v209, v210, v211
    v_cvt_pk_bf16_f32 v210, v212, v213
    v_cvt_pk_bf16_f32 v211, v214, v215
    s_waitcnt lgkmcnt(6)
    s_nop 0
    v_pk_fma_f32 v[216:217], v[216:217], v[56:57], v[48:49]
    v_pk_fma_f32 v[218:219], v[218:219], v[58:59], v[50:51]
    v_pk_fma_f32 v[220:221], v[220:221], v[60:61], v[52:53]
    v_pk_fma_f32 v[222:223], v[222:223], v[62:63], v[54:55]
    ds_write_b128 v66, v[192:195] offset:40960
    v_cvt_pk_bf16_f32 v216, v216, v217
    v_cvt_pk_bf16_f32 v217, v218, v219
    v_cvt_pk_bf16_f32 v218, v220, v221
    v_cvt_pk_bf16_f32 v219, v222, v223
    v_pk_fma_f32 v[224:225], v[224:225], v[56:57], v[48:49]
    v_pk_fma_f32 v[226:227], v[226:227], v[58:59], v[50:51]
    v_pk_fma_f32 v[228:229], v[228:229], v[60:61], v[52:53]
    v_pk_fma_f32 v[230:231], v[230:231], v[62:63], v[54:55]
    ds_write_b128 v67, v[200:203] offset:40960
    v_cvt_pk_bf16_f32 v224, v224, v225
    v_cvt_pk_bf16_f32 v225, v226, v227
    v_cvt_pk_bf16_f32 v226, v228, v229
    v_cvt_pk_bf16_f32 v227, v230, v231
    v_pk_fma_f32 v[232:233], v[232:233], v[56:57], v[48:49]
    v_pk_fma_f32 v[234:235], v[234:235], v[58:59], v[50:51]
    v_pk_fma_f32 v[236:237], v[236:237], v[60:61], v[52:53]
    v_pk_fma_f32 v[238:239], v[238:239], v[62:63], v[54:55]
    ds_write_b128 v68, v[208:211] offset:40960
    v_cvt_pk_bf16_f32 v232, v232, v233
    v_cvt_pk_bf16_f32 v233, v234, v235
    v_cvt_pk_bf16_f32 v234, v236, v237
    v_cvt_pk_bf16_f32 v235, v238, v239
    v_pk_fma_f32 v[240:241], v[240:241], v[56:57], v[48:49]
    v_pk_fma_f32 v[242:243], v[242:243], v[58:59], v[50:51]
    v_pk_fma_f32 v[244:245], v[244:245], v[60:61], v[52:53]
    v_pk_fma_f32 v[246:247], v[246:247], v[62:63], v[54:55]
    ds_write_b128 v64, v[216:219] offset:61440
    v_cvt_pk_bf16_f32 v240, v240, v241
    v_cvt_pk_bf16_f32 v241, v242, v243
    v_cvt_pk_bf16_f32 v242, v244, v245
    v_cvt_pk_bf16_f32 v243, v246, v247
    v_pk_fma_f32 v[248:249], v[248:249], v[56:57], v[48:49]
    v_pk_fma_f32 v[250:251], v[250:251], v[58:59], v[50:51]
    v_pk_fma_f32 v[252:253], v[252:253], v[60:61], v[52:53]
    v_pk_fma_f32 v[254:255], v[254:255], v[62:63], v[54:55]
    ds_write_b128 v65, v[224:227] offset:61440
    v_cvt_pk_bf16_f32 v248, v248, v249
    v_cvt_pk_bf16_f32 v249, v250, v251
    v_cvt_pk_bf16_f32 v250, v252, v253
    v_cvt_pk_bf16_f32 v251, v254, v255
    ds_write_b128 v66, v[232:235] offset:61440
    ds_write_b128 v67, v[240:243] offset:61440
    ds_write_b128 v68, v[248:251] offset:61440
    s_waitcnt lgkmcnt(0)
    s_barrier
    buffer_load_dwordx2 v[70:71], v69, s[84:87], s94 offen sc1
    s_lshl_b32 s3, s2, 2
    s_add_u32 s3, s3, 0x1000
    s_cmp_eq_u32 s13, 3
    s_cselect_b32 s3, s3, 0x7fffffff
    buffer_store_dword v6, v16, s[84:87], s3 offen sc1
    s_add_u32 m0, s12, 81920
    s_mov_b32 s14, 884736
    buffer_load_dwordx4 v27, s[48:51], s14 offen lds
    s_add_u32 m0, s12, 86016
    s_mov_b32 s14, 885760
    buffer_load_dwordx4 v27, s[48:51], s14 offen lds
    s_add_u32 m0, s12, 90112
    s_mov_b32 s14, 886784
    buffer_load_dwordx4 v27, s[48:51], s14 offen lds
    s_add_u32 m0, s12, 94208
    s_mov_b32 s14, 983040
    buffer_load_dwordx4 v27, s[48:51], s14 offen lds
    s_add_u32 m0, s12, 98304
    s_mov_b32 s14, 984064
    buffer_load_dwordx4 v27, s[48:51], s14 offen lds
    s_add_u32 m0, s12, 102400
    s_mov_b32 s14, 985088
    buffer_load_dwordx4 v27, s[48:51], s14 offen lds
    s_add_u32 m0, s12, 106496
    s_mov_b32 s14, 1081344
    buffer_load_dwordx4 v27, s[48:51], s14 offen lds
    s_add_u32 m0, s12, 110592
    s_mov_b32 s14, 1082368
    buffer_load_dwordx4 v27, s[48:51], s14 offen lds
    s_add_u32 m0, s12, 114688
    s_mov_b32 s14, 1083392
    buffer_load_dwordx4 v27, s[48:51], s14 offen lds
    s_add_u32 m0, s12, 118784
    s_mov_b32 s14, 1179648
    buffer_load_dwordx4 v27, s[48:51], s14 offen lds
    s_add_u32 m0, s12, 122880
    s_mov_b32 s14, 1180672
    buffer_load_dwordx4 v27, s[48:51], s14 offen lds
    s_add_u32 m0, s12, 126976
    s_mov_b32 s14, 1181696
    buffer_load_dwordx4 v27, s[48:51], s14 offen lds
    s_add_u32 m0, s12, 131072
    s_mov_b32 s14, 1277952
    buffer_load_dwordx4 v27, s[48:51], s14 offen lds
    s_add_u32 m0, s12, 135168
    s_mov_b32 s14, 1278976
    buffer_load_dwordx4 v27, s[48:51], s14 offen lds
    s_add_u32 m0, s12, 139264
    s_mov_b32 s14, 1280000
    buffer_load_dwordx4 v27, s[48:51], s14 offen lds
    s_barrier
    s_add_u32 m0, s12, 0
    s_mov_b32 s14, 1376256
    buffer_load_dwordx4 v27, s[48:51], s14 offen lds
    s_add_u32 m0, s12, 4096
    s_mov_b32 s14, 1377280
    buffer_load_dwordx4 v27, s[48:51], s14 offen lds
    s_add_u32 m0, s12, 8192
    s_mov_b32 s14, 1378304
    buffer_load_dwordx4 v27, s[48:51], s14 offen lds
    s_add_u32 m0, s12, 12288
    s_mov_b32 s14, 1474560
    buffer_load_dwordx4 v27, s[48:51], s14 offen lds
    s_add_u32 m0, s12, 16384
    s_mov_b32 s14, 1475584
    buffer_load_dwordx4 v27, s[48:51], s14 offen lds
    s_add_u32 m0, s12, 20480
    s_mov_b32 s14, 1476608
    buffer_load_dwordx4 v27, s[48:51], s14 offen lds
    s_lshr_b32 s3, s2, 3
    s_lshl_b32 s3, s3, 2
    s_add_u32 s3, s3, s13
    s_mul_i32 s3, s3, 4096
    v_lshlrev_b32 v5, 10, v0
    s_mov_b64 exec, 0xf
    buffer_load_dword v31, v5, s[52:55], s3 offen offset:384
    buffer_load_dword v31, v5, s[56:59], s3 offen offset:384
    buffer_load_dword v31, v5, s[60:63], s3 offen offset:384
    s_mov_b64 exec, -1
    s_waitcnt vmcnt(3)
    v_cmp_ne_u32 vcc, s7, v70
    s_nop 0
    s_cmp_eq_u64 vcc, 0
    s_cbranch_scc0 Lslow_3
Lok_1:
    v_cmp_ne_u32 vcc, v71, v7
    s_nop 0
    s_cmp_eq_u64 vcc, 0
    s_cselect_b32 s3, 1, 0
    v_mov_b32 v3, s3
    v_mov_b32 v2, 159488
    ds_write_b32 v2, v3 offset:4
    s_mov_b32 s72, s84
    s_mov_b32 s73, s85
    s_mov_b32 s76, s84
    s_mov_b32 s77, s85
    s_cmp_eq_u32 s3, 1
    s_cselect_b32 s74, 22020096, 0
    s_cselect_b32 s78, 0, 22020096
    v_mov_b32 v24, 2
    s_mov_b64 exec, s[90:91]
    ds_write_b32 v22, v24 offset:96
    s_mov_b64 exec, -1
    v_lshrrev_b32 v2, 5, v0
    v_mul_u32_u24 v72, 12288, v2
    v_and_b32 v3, 31, v0
    v_lshl_add_u32 v72, v3, 4, v72
    v_lshrrev_b32 v2, 4, v0
    v_and_b32 v3, 15, v0
    v_mul_u32_u24 v73, 12288, v2
    v_lshl_add_u32 v73, v3, 4, v73
    v_min_u32 v3, 13, v3
    s_and_b32 s3, s5, 1
    s_lshl_b32 s3, s3, 7
    s_mul_i32 s8, s13, 224
    s_add_u32 s3, s3, s8
    v_lshl_add_u32 v3, v3, 4, s3
    v_subrev_u32 v4, 896, v3
    v_min_u32 v3, v3, v4
    v_mul_u32_u24 v74, 7168, v2
    v_add_u32 v74, v3, v74
    s_lshl_b32 s3, s13, 9
    s_add_u32 s3, s3, s101
    s_add_u32 s92, s3, 6144
    s_add_u32 s93, s92, 24576
    s_lshl_b32 s3, s13, 11
    s_lshl_b32 s8, s5, 8
    s_add_u32 s3, s3, s8
    s_add_u32 s3, s3, s101
    s_add_u32 s94, s3, 4096
    s_mul_i32 s3, s5, 896
    s_add_u32 s3, s3, s101
    s_add_u32 s95, s3, 49152
    s_and_b32 s97, s7, 0xff
    s_bfe_u32 s88, s7, 0x80008
    s_bfe_u32 s89, s7, 0x80010
    s_lshr_b32 s96, s7, 24
    buffer_load_dwordx4 v[192:195], v72, s[84:87], s92 offen sc1
    buffer_load_dwordx4 v[196:199], v72, s[84:87], s93 offen sc1
    buffer_load_dwordx4 v[200:203], v72, s[84:87], s92 offen offset:2048 sc1
    buffer_load_dwordx4 v[204:207], v72, s[84:87], s93 offen offset:2048 sc1
    buffer_load_dwordx4 v[208:211], v73, s[84:87], s94 offen sc1
    buffer_load_dwordx4 v[212:215], v74, s[84:87], s95 offen sc1
    s_waitcnt lgkmcnt(0)
    s_barrier
    buffer_load_dwordx4 v[40:43], v29, s[44:47], 0 offen
    s_movk_i32 s14, 8192
    buffer_load_dwordx4 v[44:47], v29, s[44:47], s14 offen
    s_lshl_b32 s3, s2, 2
    s_add_u32 s3, s3, s13
    s_mul_i32 s3, s3, 512
    v_lshlrev_b32 v2, 7, v0
    s_mov_b64 exec, 0xf
    buffer_load_dword v31, v2, s[56:59], s3 offen
    buffer_load_dword v31, v2, s[60:63], s3 offen
    s_mov_b64 exec, -1
    s_mov_b32 s14, 0
    s_nop 0
    buffer_load_dwordx4 v[96:99], v8, s[52:55], s14 offen
    s_mov_b32 s14, 8192
    buffer_load_dwordx4 v[100:103], v8, s[52:55], s14 offen
    s_mov_b32 s14, 16384
    buffer_load_dwordx4 v[104:107], v8, s[52:55], s14 offen
    s_mov_b32 s14, 24576
    buffer_load_dwordx4 v[108:111], v8, s[52:55], s14 offen
    s_mov_b32 s14, 32768
    buffer_load_dwordx4 v[112:115], v8, s[52:55], s14 offen
    s_mov_b32 s14, 40960
    buffer_load_dwordx4 v[116:119], v8, s[52:55], s14 offen
    s_mov_b32 s14, 49152
    buffer_load_dwordx4 v[120:123], v8, s[52:55], s14 offen
    s_mov_b32 s14, 57344
    buffer_load_dwordx4 v[124:127], v8, s[52:55], s14 offen
    s_mov_b32 s14, 131072
    buffer_load_dwordx4 v[128:131], v8, s[52:55], s14 offen
    s_mov_b32 s14, 139264
    buffer_load_dwordx4 v[132:135], v8, s[52:55], s14 offen
    s_mov_b32 s14, 147456
    buffer_load_dwordx4 v[136:139], v8, s[52:55], s14 offen
    s_mov_b32 s14, 155648
    buffer_load_dwordx4 v[140:143], v8, s[52:55], s14 offen
    s_mov_b32 s14, 163840
    buffer_load_dwordx4 v[144:147], v8, s[52:55], s14 offen
    s_mov_b32 s14, 172032
    buffer_load_dwordx4 v[148:151], v8, s[52:55], s14 offen
    s_mov_b32 s14, 180224
    buffer_load_dwordx4 v[152:155], v8, s[52:55], s14 offen
    s_mov_b32 s14, 188416
    buffer_load_dwordx4 v[156:159], v8, s[52:55], s14 offen
    s_lshl_b32 s3, s2, 2
    s_add_u32 s3, s3, s13
    s_mul_i32 s3, s3, 1792
    v_lshlrev_b32 v2, 7, v0
    s_mov_b64 exec, 0x3fff
    buffer_load_dword v31, v2, s[68:71], s3 offen
    s_mov_b64 exec, -1
    s_lshl_b32 s12, s13, 13
    s_waitcnt vmcnt(21)
    v_xor_b32 v192, s97, v192
    v_xor_b32 v193, s88, v193
    v_xor_b32 v194, s89, v194
    v_xor_b32 v195, s96, v195
    v_xor_b32 v196, s97, v196
    v_xor_b32 v197, s88, v197
    v_xor_b32 v198, s89, v198
    v_xor_b32 v199, s96, v199
    v_xor_b32 v200, s97, v200
    v_xor_b32 v201, s88, v201
    v_xor_b32 v202, s89, v202
    v_xor_b32 v203, s96, v203
    v_xor_b32 v204, s97, v204
    v_xor_b32 v205, s88, v205
    v_xor_b32 v206, s89, v206
    v_xor_b32 v207, s96, v207
    v_xor_b32 v208, s97, v208
    v_xor_b32 v209, s88, v209
    v_xor_b32 v210, s89, v210
    v_xor_b32 v211, s96, v211
    v_xor_b32 v212, s97, v212
    v_xor_b32 v213, s88, v213
    v_xor_b32 v214, s89, v214
    v_xor_b32 v215, s96, v215
    v_or_b32_e64 v2, v192, v193
    v_or3_b32 v2, v2, v194, v195
    v_or3_b32 v2, v2, v196, v197
    v_or3_b32 v2, v2, v198, v199
    v_or3_b32 v2, v2, v200, v201
    v_or3_b32 v2, v2, v202, v203
    v_or3_b32 v2, v2, v204, v205
    v_or3_b32 v2, v2, v206, v207
    v_or3_b32 v2, v2, v208, v209
    v_or3_b32 v2, v2, v210, v211
    v_or3_b32 v2, v2, v212, v213
    v_or3_b32 v2, v2, v214, v215
    v_and_b32 v2, 0xff, v2
    v_cmp_ne_u32 vcc, 0, v2
    s_nop 0
    s_cmp_eq_u64 vcc, 0
    s_cbranch_scc0 Lslow_6
Lok_4:
    v_add_f32 v192, v192, v196
    v_add_f32 v200, v200, v204
    v_add_f32 v193, v193, v197
    v_add_f32 v201, v201, v205
    v_add_f32 v194, v194, v198
    v_add_f32 v202, v202, v206
    v_add_f32 v195, v195, v199
    v_add_f32 v203, v203, v207
    v_permlane32_swap_b32 v192, v200
    v_permlane32_swap_b32 v193, v201
    v_permlane32_swap_b32 v194, v202
    v_permlane32_swap_b32 v195, v203
    v_permlane32_swap_b32 v208, v212
    v_permlane32_swap_b32 v209, v213
    v_permlane32_swap_b32 v210, v214
    v_permlane32_swap_b32 v211, v215
    v_add_f32 v192, v192, v200
    v_add_f32 v208, v208, v212
    v_add_f32 v193, v193, v201
    v_add_f32 v209, v209, v213
    v_add_f32 v194, v194, v202
    v_add_f32 v210, v210, v214
    v_add_f32 v195, v195, v203
    v_add_f32 v211, v211, v215
    v_mov_b32 v212, v208
    v_mov_b32 v213, v209
    v_mov_b32 v214, v210
    v_mov_b32 v215, v211
    v_permlane16_swap_b32 v208, v212
    v_permlane16_swap_b32 v209, v213
    v_permlane16_swap_b32 v210, v214
    v_permlane16_swap_b32 v211, v215
    v_add_f32 v208, v208, v212
    v_add_f32 v209, v209, v213
    v_add_f32 v210, v210, v214
    v_add_f32 v211, v211, v215
    v_cvt_pk_bf16_f32 v32, v192, v193
    v_cvt_pk_bf16_f32 v33, v194, v195
    v_cvt_pk_bf16_f32 v34, v208, v209
    v_cvt_pk_bf16_f32 v35, v210, v211
    v_lshrrev_b32 v2, 5, v0
    v_cvt_f32_u32 v3, v2
    s_cmp_eq_u32 s13, 2
    s_cselect_b32 s3, 1.0, 0
    v_lshlrev_b32 v192, 16, v32
    v_and_b32 v193, 0xffff0000, v32
    v_lshlrev_b32 v194, 16, v33
    v_and_b32 v195, 0xffff0000, v33
    v_lshlrev_b32 v200, 16, v34
    v_and_b32 v201, 0xffff0000, v34
    v_lshlrev_b32 v202, 16, v35
    v_and_b32 v203, 0xffff0000, v35
    v_add_f32 v192, v192, v3
    v_add_f32 v200, s3, v200
    v_add_f32 v193, v193, v3
    v_add_f32 v201, s3, v201
    v_add_f32 v194, v194, v3
    v_add_f32 v202, s3, v202
    v_add_f32 v195, v195, v3
    v_add_f32 v203, s3, v203
    v_cvt_pk_bf16_f32 v32, v192, v193
    v_cvt_pk_bf16_f32 v33, v194, v195
    v_cvt_pk_bf16_f32 v34, v200, v201
    v_cvt_pk_bf16_f32 v35, v202, v203
    v_and_b32 v3, 31, v0
    v_lshlrev_b32 v3, 3, v3
    v_lshl_add_u32 v3, v2, 10, v3
    s_lshl_b32 s3, s13, 8
    s_add_u32 s3, s3, 151552
    v_add_u32 v3, s3, v3
    ds_write_b64 v3, v[32:33]
    v_cmp_eq_u32 vcc, 0, v2
    v_lshlrev_b32 v200, 16, v34
    v_and_b32 v201, 0xffff0000, v34
    v_lshlrev_b32 v202, 16, v35
    v_and_b32 v203, 0xffff0000, v35
    v_cndmask_b32 v208, v208, v200, vcc
    v_cndmask_b32 v209, v209, v201, vcc
    v_cndmask_b32 v210, v210, v202, vcc
    v_cndmask_b32 v211, v211, v203, vcc
    v_and_b32 v3, 15, v0
    v_min_u32 v4, 13, v3
    s_lshl_b32 s3, s13, 8
    s_add_u32 s3, s3, 156672
    v_lshl_add_u32 v3, v3, 4, s3
    s_mul_i32 s3, s13, 224
    s_add_u32 s3, s3, 157696
    v_lshl_add_u32 v4, v4, 4, s3
    v_cndmask_b32 v3, v4, v3, vcc
    ds_write_b128 v3, v[208:211]
    v_mov_b32 v24, 3
    s_mov_b64 exec, s[90:91]
    ds_write_b32 v22, v24 offset:96
    s_mov_b64 exec, -1
    s_and_b32 s9, s13, 1
    s_lshl_b32 s3, s9, 14
    s_add_u32 s3, s3, s40
    s_add_u32 s97, s3, 262144
    s_add_u32 s98, s97, 4096
    s_lshl_b32 s8, s5, 10
    s_add_u32 s99, s97, s8
    s_add_u32 s100, s97, 8192
    s_lshl_b32 s8, s5, 9
    s_add_u32 s101, s100, s8
    s_lshl_b32 s3, s9, 1
    s_lshl_b64 s[88:89], 3, s3
    s_mov_b32 s14, 0
    buffer_load_dwordx4 v[160:163], v8, s[56:59], s14 offen
    s_mov_b32 s14, 8192
    buffer_load_dwordx4 v[164:167], v8, s[56:59], s14 offen
    s_mov_b32 s14, 16384
    buffer_load_dwordx4 v[168:171], v8, s[56:59], s14 offen
    s_mov_b32 s14, 24576
    buffer_load_dwordx4 v[172:175], v8, s[56:59], s14 offen
    s_mov_b32 s14, 32768
    buffer_load_dwordx4 v[176:179], v8, s[56:59], s14 offen
    s_mov_b32 s14, 40960
    buffer_load_dwordx4 v[180:183], v8, s[56:59], s14 offen
    s_mov_b32 s14, 49152
    buffer_load_dwordx4 v[184:187], v8, s[56:59], s14 offen
    s_mov_b32 s14, 57344
    buffer_load_dwordx4 v[188:191], v8, s[56:59], s14 offen
    s_mov_b32 s0, 0x40000
Lfsp_8:
    s_sleep 1
    ds_read_b32 v23, v22 offset:112
    s_sub_u32 s0, s0, 1
    s_cbranch_scc1 Lfok_7
    s_waitcnt lgkmcnt(0)
    v_cmp_gt_u32 vcc, 1, v23
    s_cbranch_vccnz Lfsp_8
Lfok_7:
    s_waitcnt vmcnt(27)
    ds_write_b128 v78, v[40:43]
    ds_write_b128 v78, v[44:47] offset:1024
    s_waitcnt vmcnt(17)
    ds_write_b128 v12, v[96:99] offset:0
    ds_write_b128 v12, v[100:103] offset:1024
    ds_write_b128 v12, v[104:107] offset:2048
    ds_write_b128 v12, v[108:111] offset:3072
    ds_write_b128 v12, v[112:115] offset:4096
    ds_write_b128 v12, v[116:119] offset:5120
    ds_write_b128 v12, v[120:123] offset:6144
    ds_write_b128 v12, v[124:127] offset:7168
    v_mov_b32 v24, 1
    s_mov_b64 exec, s[90:91]
    ds_write_b32 v22, v24 offset:32
    s_mov_b64 exec, -1
    s_waitcnt vmcnt(9)
    ds_write_b128 v12, v[128:131] offset:32768
    ds_write_b128 v12, v[132:135] offset:33792
    ds_write_b128 v12, v[136:139] offset:34816
    ds_write_b128 v12, v[140:143] offset:35840
    ds_write_b128 v12, v[144:147] offset:36864
    ds_write_b128 v12, v[148:151] offset:37888
    ds_write_b128 v12, v[152:155] offset:38912
    ds_write_b128 v12, v[156:159] offset:39936
    v_mov_b32 v24, 2
    s_mov_b64 exec, s[90:91]
    ds_write_b32 v22, v24 offset:32
    s_mov_b64 exec, -1
    s_waitcnt vmcnt(0)
    ds_write_b128 v13, v[160:163] offset:0
    ds_write_b128 v13, v[164:167] offset:1024
    ds_write_b128 v13, v[168:171] offset:2048
    ds_write_b128 v13, v[172:175] offset:3072
    ds_write_b128 v13, v[176:179] offset:4096
    ds_write_b128 v13, v[180:183] offset:5120
    ds_write_b128 v13, v[184:187] offset:6144
    ds_write_b128 v13, v[188:191] offset:7168
    s_mov_b32 s0, 0x40000
Lfsp_10:
    s_sleep 1
    ds_read_b32 v23, v22 offset:96
    s_sub_u32 s0, s0, 1
    s_cbranch_scc1 Lfok_9
    s_waitcnt lgkmcnt(0)
    v_cmp_gt_u32 vcc, 3, v23
    s_cbranch_vccnz Lfsp_10
Lfok_9:
    s_setprio 3
    s_nop 0
    ds_read_b64 v[32:33], v75 offset:0
    ds_read_b64 v[34:35], v75 offset:32
    ds_read_b64 v[36:37], v75 offset:64
    ds_read_b64 v[38:39], v75 offset:96
    ds_read_b64 v[40:41], v75 offset:128
    ds_read_b64 v[42:43], v75 offset:160
    ds_read_b64 v[44:45], v75 offset:192
    ds_read_b64 v[46:47], v75 offset:224
    ds_read_b64 v[48:49], v75 offset:256
    ds_read_b64 v[50:51], v75 offset:288
    ds_read_b64 v[52:53], v75 offset:320
    ds_read_b64 v[54:55], v75 offset:352
    s_waitcnt lgkmcnt(10)
    v_mfma_f32_16x16x32_bf16 v[88:91], v[32:35], v[32:35], 0
    ds_read_b64 v[56:57], v75 offset:384
    ds_read_b64 v[58:59], v75 offset:416
    s_waitcnt lgkmcnt(10)
    v_mfma_f32_16x16x32_bf16 v[88:91], v[36:39], v[36:39], v[88:91]
    ds_read_b64 v[60:61], v75 offset:448
    ds_read_b64 v[62:63], v75 offset:480
    s_waitcnt lgkmcnt(10)
    v_mfma_f32_16x16x32_bf16 v[88:91], v[40:43], v[40:43], v[88:91]
    ds_read_b64 v[32:33], v75 offset:512
    ds_read_b64 v[34:35], v75 offset:544
    s_waitcnt lgkmcnt(10)
    v_mfma_f32_16x16x32_bf16 v[88:91], v[44:47], v[44:47], v[88:91]
    ds_read_b64 v[36:37], v75 offset:576
    ds_read_b64 v[38:39], v75 offset:608
    s_waitcnt lgkmcnt(10)
    v_mfma_f32_16x16x32_bf16 v[88:91], v[48:51], v[48:51], v[88:91]
    ds_read_b64 v[40:41], v75 offset:640
    ds_read_b64 v[42:43], v75 offset:672
    s_waitcnt lgkmcnt(10)
    v_mfma_f32_16x16x32_bf16 v[88:91], v[52:55], v[52:55], v[88:91]
    ds_read_b64 v[44:45], v75 offset:704
    ds_read_b64 v[46:47], v75 offset:736
    s_waitcnt lgkmcnt(10)
    v_mfma_f32_16x16x32_bf16 v[88:91], v[56:59], v[56:59], v[88:91]
    ds_read_b64 v[48:49], v75 offset:768
    ds_read_b64 v[50:51], v75 offset:800
    s_waitcnt lgkmcnt(10)
    v_mfma_f32_16x16x32_bf16 v[88:91], v[60:63], v[60:63], v[88:91]
    ds_read_b64 v[52:53], v75 offset:832
    ds_read_b64 v[54:55], v75 offset:864
    s_waitcnt lgkmcnt(10)
    v_mfma_f32_16x16x32_bf16 v[88:91], v[32:35], v[32:35], v[88:91]
    ds_read_b64 v[56:57], v75 offset:896
    ds_read_b64 v[58:59], v75 offset:928
    s_waitcnt lgkmcnt(10)
    v_mfma_f32_16x16x32_bf16 v[88:91], v[36:39], v[36:39], v[88:91]
    ds_read_b64 v[60:61], v75 offset:960
    ds_read_b64 v[62:63], v75 offset:992
    s_waitcnt lgkmcnt(10)
    v_mfma_f32_16x16x32_bf16 v[88:91], v[40:43], v[40:43], v[88:91]
    s_waitcnt lgkmcnt(8)
    v_mfma_f32_16x16x32_bf16 v[88:91], v[44:47], v[44:47], v[88:91]
    s_waitcnt lgkmcnt(6)
    v_mfma_f32_16x16x32_bf16 v[88:91], v[48:51], v[48:51], v[88:91]
    s_waitcnt lgkmcnt(4)
    v_mfma_f32_16x16x32_bf16 v[88:91], v[52:55], v[52:55], v[88:91]
    s_waitcnt lgkmcnt(2)
    v_mfma_f32_16x16x32_bf16 v[88:91], v[56:59], v[56:59], v[88:91]
    s_waitcnt lgkmcnt(0)
    v_mfma_f32_16x16x32_bf16 v[88:91], v[60:63], v[60:63], v[88:91]
    s_setprio 0
    s_nop 6
    v_readlane_b32 s92, v88, 1
    v_readlane_b32 s93, v89, 1
    v_readlane_b32 s94, v89, 2
    v_readlane_b32 s95, v88, 2
    v_readlane_b32 s96, v90, 2
    s_mov_b32 s0, 0x40000
Lfsp_12:
    s_sleep 1
    ds_read_b32 v23, v22 offset:112
    s_sub_u32 s0, s0, 1
    s_cbranch_scc1 Lfok_11
    s_waitcnt lgkmcnt(0)
    v_cmp_gt_u32 vcc, 2, v23
    s_cbranch_vccnz Lfsp_12
Lfok_11:
    s_lshr_b32 s3, s2, 3
    s_lshl_b32 s3, s3, 2
    s_add_u32 s3, s3, s13
    s_mul_i32 s3, s3, 14336
    v_lshlrev_b32 v5, 10, v0
    s_mov_b64 exec, 0x3fff
    buffer_load_dword v31, v5, s[64:67], s3 offen offset:384
    s_mov_b64 exec, -1
    s_nop 0
    s_mov_b32 s14, 131072
    buffer_load_dwordx4 v[224:227], v8, s[56:59], s14 offen
    s_mov_b32 s14, 139264
    buffer_load_dwordx4 v[228:231], v8, s[56:59], s14 offen
    s_mov_b32 s14, 147456
    buffer_load_dwordx4 v[232:235], v8, s[56:59], s14 offen
    s_mov_b32 s14, 155648
    buffer_load_dwordx4 v[236:239], v8, s[56:59], s14 offen
    s_mov_b32 s14, 163840
    buffer_load_dwordx4 v[240:243], v8, s[56:59], s14 offen
    s_mov_b32 s14, 172032
    buffer_load_dwordx4 v[244:247], v8, s[56:59], s14 offen
    s_mov_b32 s14, 180224
    buffer_load_dwordx4 v[248:251], v8, s[56:59], s14 offen
    s_mov_b32 s14, 188416
    buffer_load_dwordx4 v[252:255], v8, s[56:59], s14 offen
    s_mov_b32 s14, 0
    s_nop 0
    buffer_load_dwordx4 v[96:99], v9, s[64:67], s14 offen
    s_mov_b32 s14, 28672
    buffer_load_dwordx4 v[100:103], v9, s[64:67], s14 offen
    s_mov_b32 s14, 57344
    buffer_load_dwordx4 v[104:107], v9, s[64:67], s14 offen
    s_mov_b32 s14, 86016
    buffer_load_dwordx4 v[108:111], v9, s[64:67], s14 offen
    s_mov_b32 s14, 114688
    buffer_load_dwordx4 v[112:115], v9, s[64:67], s14 offen
    s_mov_b32 s14, 143360
    buffer_load_dwordx4 v[116:119], v9, s[64:67], s14 offen
    s_mov_b32 s14, 172032
    buffer_load_dwordx4 v[120:123], v9, s[64:67], s14 offen
    s_mov_b32 s14, 200704
    buffer_load_dwordx4 v[124:127], v9, s[64:67], s14 offen
    s_waitcnt vmcnt(8)
    s_nop 0
    ds_write_b128 v13, v[224:227] offset:32768
    ds_write_b128 v13, v[228:231] offset:33792
    ds_write_b128 v13, v[232:235] offset:34816
    ds_write_b128 v13, v[236:239] offset:35840
    ds_write_b128 v13, v[240:243] offset:36864
    ds_write_b128 v13, v[244:247] offset:37888
    ds_write_b128 v13, v[248:251] offset:38912
    ds_write_b128 v13, v[252:255] offset:39936
    v_mov_b32 v24, 4
    s_mov_b64 exec, s[90:91]
    ds_write_b32 v22, v24 offset:32
    s_mov_b64 exec, -1
    s_mov_b32 s10, 0
    s_mov_b32 s11, -1
    s_cmp_ge_u32 s13, 2
    s_cbranch_scc1 Lspec_13
    s_mov_b32 s0, 0x40000
Lfsp_16:
    ds_read_b32 v23, v22 offset:112
    ds_read_b128 v[80:83], v14
    ds_read_b128 v[84:87], v14 offset:1024
    s_sub_u32 s0, s0, 1
    s_cbranch_scc1 Lfok_15
    s_waitcnt lgkmcnt(0)
    v_cmp_gt_u32 vcc, 3, v23
    s_nop 0
    s_and_b64 vcc, vcc, s[88:89]
    s_cbranch_scc1 Lfsp_16
Lfok_15:
    v_add_f32 v80, v80, v84
    v_add_f32 v81, v81, v85
    v_add_f32 v82, v82, v86
    v_mov_b32 v83, s7
    buffer_store_dwordx4 v[80:83], v1, s[72:75], s99 offen
    s_cmp_eq_u32 s78, 0
    s_cbranch_scc0 Lslow_18
Lfs_17:
    s_movk_i32 s0, 20000
Lspin_20:
    buffer_load_dwordx4 v[32:35], v1, s[84:87], s97 offen offset:0 sc1
    buffer_load_dwordx4 v[36:39], v1, s[84:87], s97 offen offset:1024 sc1
    buffer_load_dwordx4 v[40:43], v1, s[84:87], s97 offen offset:2048 sc1
    buffer_load_dwordx4 v[44:47], v1, s[84:87], s97 offen offset:3072 sc1
    buffer_load_dwordx4 v[48:51], v1, s[84:87], s98 offen offset:0 sc1
    buffer_load_dwordx4 v[52:55], v1, s[84:87], s98 offen offset:1024 sc1
    buffer_load_dwordx4 v[56:59], v1, s[84:87], s98 offen offset:2048 sc1
    buffer_load_dwordx4 v[60:63], v1, s[84:87], s98 offen offset:3072 sc1
    s_sub_u32 s0, s0, 1
    s_cbranch_scc1 Lok_19
    s_waitcnt vmcnt(0)
    v_xor_b32_e64 v2, s7, v35
    v_bitop3_b32 v2, v2, v39, s7 bitop3:0xf6
    v_bitop3_b32 v2, v2, v43, s7 bitop3:0xf6
    v_bitop3_b32 v2, v2, v47, s7 bitop3:0xf6
    v_bitop3_b32 v2, v2, v51, s7 bitop3:0xf6
    v_bitop3_b32 v2, v2, v55, s7 bitop3:0xf6
    v_bitop3_b32 v2, v2, v59, s7 bitop3:0xf6
    v_bitop3_b32 v2, v2, v63, s7 bitop3:0xf6
    v_cmp_ne_u32 vcc, 0, v2
    s_nop 0
    s_cmp_eq_u64 vcc, 0
    s_cbranch_scc0 Lspin_20
Lok_19:
    v_add_f32 v32, v32, v36
    v_add_f32 v33, v33, v37
    v_add_f32 v34, v34, v38
    v_add_f32 v32, v32, v40
    v_add_f32 v33, v33, v41
    v_add_f32 v34, v34, v42
    v_add_f32 v32, v32, v44
    v_add_f32 v33, v33, v45
    v_add_f32 v34, v34, v46
    v_add_f32 v32, v32, v48
    v_add_f32 v33, v33, v49
    v_add_f32 v34, v34, v50
    v_add_f32 v32, v32, v52
    v_add_f32 v33, v33, v53
    v_add_f32 v34, v34, v54
    v_add_f32 v32, v32, v56
    v_add_f32 v33, v33, v57
    v_add_f32 v34, v34, v58
    v_add_f32 v32, v32, v60
    v_add_f32 v33, v33, v61
    v_add_f32 v34, v34, v62
    v_mov_b32 v36, v32
    v_mov_b32 v37, v33
    v_mov_b32 v38, v34
    v_permlane32_swap_b32 v32, v36
    v_permlane32_swap_b32 v33, v37
    v_permlane32_swap_b32 v34, v38
    v_mul_f32 v41, 0x3b000000, v32
    v_mul_f32 v49, 0x3b000000, v33
    v_fma_f32 v49, -v41, v41, v49
    v_max_f32 v49, 0, v49
    v_add_f32 v49, 0x3727c5ac, v49
    v_rsq_f32 v42, v49
    v_sqrt_f32 v44, v49
    v_fma_f32 v48, -v41, s92, v34
    v_mul_f32_e64 v49, s93, v41
    v_fma_f32 v49, v37, -2.0, v49
    v_fma_f32 v49, v49, v41, v36
    v_fma_f32 v50, -v41, s94, v38
    v_add_f32_e64 v50, v50, v50
    v_fma_f32 v48, v48, v42, s95
    v_mul_f32 v48, 0x3b000000, v48
    v_fma_f32 v49, v49, v42, v50
    v_fma_f32 v49, v49, v42, s96
    v_mul_f32 v49, 0x3b000000, v49
    v_fma_f32 v49, -v48, v48, v49
    v_max_f32 v49, 0, v49
    v_add_f32 v49, 0x3727c5ac, v49
    v_rsq_f32 v43, v49
    s_nop 0
    v_mul_f32 v40, v43, v42
    ds_write_b128 v15, v[40:43]
    v_mul_f32 v49, v48, v44
    v_cndmask_b32 v49, v41, v49, s[10:11]
    v_sub_f32 v49, 0, v49
    v_cndmask_b32 v50, v44, 0, s[10:11]
    v_cvt_pk_bf16_f32 v56, v49, v50
    v_lshlrev_b32 v57, 16, v56
    v_and_b32 v58, 0xffff0000, v56
    v_sub_f32 v49, v49, v57
    v_sub_f32 v50, v50, v58
    v_cvt_pk_bf16_f32 v52, v57, v49
    v_mov_b32 v53, v56
    v_cvt_pk_bf16_f32 v54, v50, v58
    v_mov_b32 v55, 0
    ds_write_b128 v14, v[52:55]
    s_branch Ljoin_14
Lspec_13:
    s_mov_b32 s0, 0x40000
Lfsp_22:
    s_sleep 1
    ds_read_b32 v23, v22 offset:32
    s_sub_u32 s0, s0, 1
    s_cbranch_scc1 Lfok_21
    s_waitcnt lgkmcnt(0)
    v_cmp_gt_u32 vcc, 4, v23
    s_cbranch_vccnz Lfsp_22
Lfok_21:
    s_mov_b32 s0, 0x40000
Lfsp_24:
    s_sleep 1
    ds_read_b32 v23, v22 offset:112
    s_sub_u32 s0, s0, 1
    s_cbranch_scc1 Lfok_23
    s_waitcnt lgkmcnt(0)
    v_cmp_gt_u32 vcc, 3, v23
    s_nop 0
    s_and_b64 vcc, vcc, s[90:91]
    s_cbranch_scc1 Lfsp_24
Lfok_23:
    ds_read_b64_tr_b16 v[192:193], v76 offset:0
    ds_read_b64_tr_b16 v[194:195], v76 offset:2048
    ds_read_b64_tr_b16 v[196:197], v76 offset:32
    ds_read_b64_tr_b16 v[198:199], v76 offset:2080
    ds_read_b64 v[200:201], v75 offset:0
    ds_read_b64 v[202:203], v75 offset:32
    ds_read_b64_tr_b16 v[204:205], v76 offset:4096
    ds_read_b64_tr_b16 v[206:207], v76 offset:6144
    ds_read_b64_tr_b16 v[208:209], v76 offset:4128
    ds_read_b64_tr_b16 v[210:211], v76 offset:6176
    ds_read_b64 v[212:213], v75 offset:64
    ds_read_b64 v[214:215], v75 offset:96
    s_waitcnt lgkmcnt(6)
    v_mfma_f32_16x16x32_bf16 v[80:83], v[192:195], v[200:203], 0
    v_mfma_f32_16x16x32_bf16 v[84:87], v[196:199], v[200:203], 0
    ds_read_b64_tr_b16 v[32:33], v76 offset:8192
    ds_read_b64_tr_b16 v[34:35], v76 offset:10240
    ds_read_b64_tr_b16 v[36:37], v76 offset:8224
    ds_read_b64_tr_b16 v[38:39], v76 offset:10272
    ds_read_b64 v[40:41], v75 offset:128
    ds_read_b64 v[42:43], v75 offset:160
    s_waitcnt lgkmcnt(6)
    v_mfma_f32_16x16x32_bf16 v[80:83], v[204:207], v[212:215], v[80:83]
    v_mfma_f32_16x16x32_bf16 v[84:87], v[208:211], v[212:215], v[84:87]
    ds_read_b64_tr_b16 v[192:193], v76 offset:12288
    ds_read_b64_tr_b16 v[194:195], v76 offset:14336
    ds_read_b64_tr_b16 v[196:197], v76 offset:12320
    ds_read_b64_tr_b16 v[198:199], v76 offset:14368
    ds_read_b64 v[200:201], v75 offset:192
    ds_read_b64 v[202:203], v75 offset:224
    s_waitcnt lgkmcnt(6)
    v_mfma_f32_16x16x32_bf16 v[80:83], v[32:35], v[40:43], v[80:83]
    v_mfma_f32_16x16x32_bf16 v[84:87], v[36:39], v[40:43], v[84:87]
    ds_read_b64_tr_b16 v[204:205], v76 offset:32768
    ds_read_b64_tr_b16 v[206:207], v76 offset:34816
    ds_read_b64_tr_b16 v[208:209], v76 offset:32800
    ds_read_b64_tr_b16 v[210:211], v76 offset:34848
    ds_read_b64 v[212:213], v75 offset:256
    ds_read_b64 v[214:215], v75 offset:288
    s_waitcnt lgkmcnt(6)
    v_mfma_f32_16x16x32_bf16 v[80:83], v[192:195], v[200:203], v[80:83]
    v_mfma_f32_16x16x32_bf16 v[84:87], v[196:199], v[200:203], v[84:87]
    ds_read_b64_tr_b16 v[32:33], v76 offset:36864
    ds_read_b64_tr_b16 v[34:35], v76 offset:38912
    ds_read_b64_tr_b16 v[36:37], v76 offset:36896
    ds_read_b64_tr_b16 v[38:39], v76 offset:38944
    ds_read_b64 v[40:41], v75 offset:320
    ds_read_b64 v[42:43], v75 offset:352
    s_waitcnt lgkmcnt(6)
    v_mfma_f32_16x16x32_bf16 v[80:83], v[204:207], v[212:215], v[80:83]
    v_mfma_f32_16x16x32_bf16 v[84:87], v[208:211], v[212:215], v[84:87]
    ds_read_b64_tr_b16 v[192:193], v76 offset:40960
    ds_read_b64_tr_b16 v[194:195], v76 offset:43008
    ds_read_b64_tr_b16 v[196:197], v76 offset:40992
    ds_read_b64_tr_b16 v[198:199], v76 offset:43040
    ds_read_b64 v[200:201], v75 offset:384
    ds_read_b64 v[202:203], v75 offset:416
    s_waitcnt lgkmcnt(6)
    v_mfma_f32_16x16x32_bf16 v[80:83], v[32:35], v[40:43], v[80:83]
    v_mfma_f32_16x16x32_bf16 v[84:87], v[36:39], v[40:43], v[84:87]
    ds_read_b64_tr_b16 v[204:205], v76 offset:45056
    ds_read_b64_tr_b16 v[206:207], v76 offset:47104
    ds_read_b64_tr_b16 v[208:209], v76 offset:45088
    ds_read_b64_tr_b16 v[210:211], v76 offset:47136
    ds_read_b64 v[212:213], v75 offset:448
    ds_read_b64 v[214:215], v75 offset:480
    s_waitcnt lgkmcnt(6)
    v_mfma_f32_16x16x32_bf16 v[80:83], v[192:195], v[200:203], v[80:83]
    v_mfma_f32_16x16x32_bf16 v[84:87], v[196:199], v[200:203], v[84:87]
    ds_read_b64_tr_b16 v[32:33], v76 offset:16384
    ds_read_b64_tr_b16 v[34:35], v76 offset:18432
    ds_read_b64_tr_b16 v[36:37], v76 offset:16416
    ds_read_b64_tr_b16 v[38:39], v76 offset:18464
    ds_read_b64 v[40:41], v75 offset:512
    ds_read_b64 v[42:43], v75 offset:544
    s_waitcnt lgkmcnt(6)
    v_mfma_f32_16x16x32_bf16 v[80:83], v[204:207], v[212:215], v[80:83]
    v_mfma_f32_16x16x32_bf16 v[84:87], v[208:211], v[212:215], v[84:87]
    ds_read_b64_tr_b16 v[192:193], v76 offset:20480
    ds_read_b64_tr_b16 v[194:195], v76 offset:22528
    ds_read_b64_tr_b16 v[196:197], v76 offset:20512
    ds_read_b64_tr_b16 v[198:199], v76 offset:22560
    ds_read_b64 v[200:201], v75 offset:576
    ds_read_b64 v[202:203], v75 offset:608
    s_waitcnt lgkmcnt(6)
    v_mfma_f32_16x16x32_bf16 v[80:83], v[32:35], v[40:43], v[80:83]
    v_mfma_f32_16x16x32_bf16 v[84:87], v[36:39], v[40:43], v[84:87]
    ds_read_b64_tr_b16 v[204:205], v76 offset:24576
    ds_read_b64_tr_b16 v[206:207], v76 offset:26624
    ds_read_b64_tr_b16 v[208:209], v76 offset:24608
    ds_read_b64_tr_b16 v[210:211], v76 offset:26656
    ds_read_b64 v[212:213], v75 offset:640
    ds_read_b64 v[214:215], v75 offset:672
    s_waitcnt lgkmcnt(6)
    v_mfma_f32_16x16x32_bf16 v[80:83], v[192:195], v[200:203], v[80:83]
    v_mfma_f32_16x16x32_bf16 v[84:87], v[196:199], v[200:203], v[84:87]
    ds_read_b64_tr_b16 v[32:33], v76 offset:28672
    ds_read_b64_tr_b16 v[34:35], v76 offset:30720
    ds_read_b64_tr_b16 v[36:37], v76 offset:28704
    ds_read_b64_tr_b16 v[38:39], v76 offset:30752
    ds_read_b64 v[40:41], v75 offset:704
    ds_read_b64 v[42:43], v75 offset:736
    s_waitcnt lgkmcnt(6)
    v_mfma_f32_16x16x32_bf16 v[80:83], v[204:207], v[212:215], v[80:83]
    v_mfma_f32_16x16x32_bf16 v[84:87], v[208:211], v[212:215], v[84:87]
    ds_read_b64_tr_b16 v[192:193], v76 offset:49152
    ds_read_b64_tr_b16 v[194:195], v76 offset:51200
    ds_read_b64_tr_b16 v[196:197], v76 offset:49184
    ds_read_b64_tr_b16 v[198:199], v76 offset:51232
    ds_read_b64 v[200:201], v75 offset:768
    ds_read_b64 v[202:203], v75 offset:800
    s_waitcnt lgkmcnt(6)
    v_mfma_f32_16x16x32_bf16 v[80:83], v[32:35], v[40:43], v[80:83]
    v_mfma_f32_16x16x32_bf16 v[84:87], v[36:39], v[40:43], v[84:87]
    ds_read_b64_tr_b16 v[204:205], v76 offset:53248
    ds_read_b64_tr_b16 v[206:207], v76 offset:55296
    ds_read_b64_tr_b16 v[208:209], v76 offset:53280
    ds_read_b64_tr_b16 v[210:211], v76 offset:55328
    ds_read_b64 v[212:213], v75 offset:832
    ds_read_b64 v[214:215], v75 offset:864
    s_waitcnt lgkmcnt(6)
    v_mfma_f32_16x16x32_bf16 v[80:83], v[192:195], v[200:203], v[80:83]
    v_mfma_f32_16x16x32_bf16 v[84:87], v[196:199], v[200:203], v[84:87]
    ds_read_b64_tr_b16 v[32:33], v76 offset:57344
    ds_read_b64_tr_b16 v[34:35], v76 offset:59392
    ds_read_b64_tr_b16 v[36:37], v76 offset:57376
    ds_read_b64_tr_b16 v[38:39], v76 offset:59424
    ds_read_b64 v[40:41], v75 offset:896
    ds_read_b64 v[42:43], v75 offset:928
    s_waitcnt lgkmcnt(6)
    v_mfma_f32_16x16x32_bf16 v[80:83], v[204:207], v[212:215], v[80:83]
    v_mfma_f32_16x16x32_bf16 v[84:87], v[208:211], v[212:215], v[84:87]
    ds_read_b64_tr_b16 v[192:193], v76 offset:61440
    ds_read_b64_tr_b16 v[194:195], v76 offset:63488
    ds_read_b64_tr_b16 v[196:197], v76 offset:61472
    ds_read_b64_tr_b16 v[198:199], v76 offset:63520
    ds_read_b64 v[200:201], v75 offset:960
    ds_read_b64 v[202:203], v75 offset:992
    s_waitcnt lgkmcnt(6)
    v_mfma_f32_16x16x32_bf16 v[80:83], v[32:35], v[40:43], v[80:83]
    v_mfma_f32_16x16x32_bf16 v[84:87], v[36:39], v[40:43], v[84:87]
    s_waitcnt lgkmcnt(0)
    v_mfma_f32_16x16x32_bf16 v[80:83], v[192:195], v[200:203], v[80:83]
    v_mfma_f32_16x16x32_bf16 v[84:87], v[196:199], v[200:203], v[84:87]
    s_mov_b32 s8, 0x00070007
    s_mov_b32 s9, 0x00070007
    s_mov_b64 exec, s[8:9]
    s_nop 3
    ds_write_b128 v77, v[80:83]
    ds_write_b128 v77, v[84:87] offset:64
    s_mov_b64 exec, -1
    s_and_b32 s9, s13, 1
    s_lshl_b32 s3, s9, 7
    s_add_u32 s3, s3, 158720
    v_and_b32 v2, 31, v0
    v_lshl_add_u32 v2, v2, 2, s3
    v_add_u32 v3, 256, v2
    v_cndmask_b32 v3, v3, v2, s[10:11]
    ds_read_b32 v32, v3
    ds_read_b32 v33, v2 offset:512
    s_lshl_b32 s3, s9, 10
    s_add_u32 s3, s3, 161792
    v_add_u32 v2, s3, v1
    s_waitcnt lgkmcnt(0)
    v_cndmask_b32 v33, v33, 0, s[10:11]
    v_cvt_pk_bf16_f32 v40, v32, v33
    v_lshlrev_b32 v41, 16, v40
    v_and_b32 v42, 0xffff0000, v40
    v_sub_f32 v32, v32, v41
    v_sub_f32 v33, v33, v42
    v_cvt_pk_bf16_f32 v36, v41, v41
    v_cvt_pk_bf16_f32 v37, v32, v42
    v_cvt_pk_bf16_f32 v38, v42, v33
    v_mov_b32 v39, 0
    ds_write_b128 v2, v[36:39]
Ljoin_14:
    v_mov_b32 v24, 4
    s_mov_b64 exec, s[90:91]
    ds_write_b32 v22, v24 offset:96
    s_mov_b64 exec, -1
    s_bitcmp1_b32 s5, 1
    s_cselect_b32 s3, -1, 1
    s_cselect_b32 s8, 3, 12
    s_mov_b32 s92, s8
    s_mov_b32 s93, 0
    s_add_u32 s3, s3, s4
    s_lshl_b32 s8, s3, 12
    s_lshl_b32 s9, s5, 9
    s_add_u32 s8, s8, s9
    s_add_u32 s94, s8, 2097152
    s_cmp_lt_u32 s3, 32
    s_cselect_b32 s94, s94, 0x7fffffff
    s_lshl_b32 s8, s4, 12
    s_lshl_b32 s9, s13, 10
    s_add_u32 s8, s8, s9
    s_add_u32 s95, s8, 2097152
    s_and_b32 s9, s13, 1
    s_mul_i32 s96, s9, 31
    v_lshlrev_b32 v32, 2, v0
    v_add_u32 v32, 153600, v32
    v_lshlrev_b32 v33, 3, v0
    s_lshl_b32 s3, s13, 9
    s_add_u32 s3, s3, 161792
    v_add_u32 v40, s3, v33
    v_mov_b32 v35, s7
    v_mov_b32 v36, 0
    v_mov_b32 v37, 0
    s_mov_b32 s0, 0x40000
Lfsp_26:
    s_sleep 1
    ds_read_b32 v23, v22 offset:112
    s_sub_u32 s0, s0, 1
    s_cbranch_scc1 Lfok_25
    s_waitcnt lgkmcnt(0)
    v_cmp_gt_u32 vcc, 4, v23
    s_cbranch_vccnz Lfsp_26
Lfok_25:
    s_add_u32 m0, s12, 0
    s_mov_b32 s14, 0
    buffer_load_dwordx4 v8, s[60:63], s14 offen lds
    s_waitcnt vmcnt(4)
    s_add_u32 m0, s12, 1024
    s_mov_b32 s14, 8192
    buffer_load_dwordx4 v8, s[60:63], s14 offen lds
    s_mov_b32 s14, 458752
    buffer_load_dwordx4 v[128:131], v9, s[64:67], s14 offen
    s_add_u32 m0, s12, 2048
    s_mov_b32 s14, 16384
    buffer_load_dwordx4 v8, s[60:63], s14 offen lds
    s_waitcnt vmcnt(4)
    s_add_u32 m0, s12, 3072
    s_mov_b32 s14, 24576
    buffer_load_dwordx4 v8, s[60:63], s14 offen lds
    s_mov_b32 s14, 487424
    buffer_load_dwordx4 v[132:135], v9, s[64:67], s14 offen
    s_add_u32 m0, s12, 4096
    s_mov_b32 s14, 32768
    buffer_load_dwordx4 v8, s[60:63], s14 offen lds
    s_waitcnt vmcnt(4)
    s_add_u32 m0, s12, 5120
    s_mov_b32 s14, 40960
    buffer_load_dwordx4 v8, s[60:63], s14 offen lds
    s_mov_b32 s14, 516096
    buffer_load_dwordx4 v[136:139], v9, s[64:67], s14 offen
    s_add_u32 m0, s12, 6144
    s_mov_b32 s14, 49152
    buffer_load_dwordx4 v8, s[60:63], s14 offen lds
    s_waitcnt vmcnt(4)
    s_add_u32 m0, s12, 7168
    s_mov_b32 s14, 57344
    buffer_load_dwordx4 v8, s[60:63], s14 offen lds
    s_mov_b32 s14, 544768
    buffer_load_dwordx4 v[140:143], v9, s[64:67], s14 offen
    s_add_u32 m0, s12, 32768
    s_mov_b32 s14, 131072
    buffer_load_dwordx4 v8, s[60:63], s14 offen lds
    s_waitcnt vmcnt(4)
    s_add_u32 m0, s12, 33792
    s_mov_b32 s14, 139264
    buffer_load_dwordx4 v8, s[60:63], s14 offen lds
    s_mov_b32 s14, 573440
    buffer_load_dwordx4 v[144:147], v9, s[64:67], s14 offen
    s_add_u32 m0, s12, 34816
    s_mov_b32 s14, 147456
    buffer_load_dwordx4 v8, s[60:63], s14 offen lds
    s_waitcnt vmcnt(4)
    s_add_u32 m0, s12, 35840
    s_mov_b32 s14, 155648
    buffer_load_dwordx4 v8, s[60:63], s14 offen lds
    s_mov_b32 s14, 602112
    buffer_load_dwordx4 v[148:151], v9, s[64:67], s14 offen
    s_add_u32 m0, s12, 36864
    s_mov_b32 s14, 163840
    buffer_load_dwordx4 v8, s[60:63], s14 offen lds
    s_waitcnt vmcnt(4)
    s_add_u32 m0, s12, 37888
    s_mov_b32 s14, 172032
    buffer_load_dwordx4 v8, s[60:63], s14 offen lds
    s_mov_b32 s14, 630784
    buffer_load_dwordx4 v[152:155], v9, s[64:67], s14 offen
    s_add_u32 m0, s12, 38912
    s_mov_b32 s14, 180224
    buffer_load_dwordx4 v8, s[60:63], s14 offen lds
    s_waitcnt vmcnt(4)
    s_add_u32 m0, s12, 39936
    s_mov_b32 s14, 188416
    buffer_load_dwordx4 v8, s[60:63], s14 offen lds
    s_mov_b32 s14, 659456
    buffer_load_dwordx4 v[156:159], v9, s[64:67], s14 offen
    s_waitcnt vmcnt(1)
    v_mov_b32 v24, 6
    s_mov_b64 exec, s[90:91]
    ds_write_b32 v22, v24 offset:32
    s_mov_b64 exec, -1
    s_cmp_lg_u32 s13, 2
    s_cbranch_scc1 Lns_27
    s_mov_b32 s0, 0x40000
Lfsp_29:
    ds_read_b32 v23, v22 offset:112
    ds_read_b32 v34, v32
    s_sub_u32 s0, s0, 1
    s_cbranch_scc1 Lfok_28
    s_waitcnt lgkmcnt(0)
    v_cmp_gt_u32 vcc, 5, v23
    s_nop 0
    s_and_b64 vcc, vcc, s[92:93]
    s_cbranch_scc1 Lfsp_29
Lfok_28:
    buffer_store_dwordx2 v[34:35], v33, s[84:87], s94 offen sc1
Lns_27:
    s_mov_b32 s0, 0x40000
Lfsp_31:
    s_sleep 1
    ds_read_b32 v23, v22 offset:80
    s_sub_u32 s0, s0, 1
    s_cbranch_scc1 Lfok_30
    s_waitcnt lgkmcnt(0)
    v_cmp_gt_u32 vcc, 3, v23
    s_cbranch_vccnz Lfsp_31
Lfok_30:
    s_nop 0
    ds_write_b128 v13, v[96:99] offset:0
    ds_write_b128 v13, v[100:103] offset:1024
    ds_write_b128 v13, v[104:107] offset:2048
    ds_write_b128 v13, v[108:111] offset:3072
    ds_write_b128 v13, v[112:115] offset:4096
    ds_write_b128 v13, v[116:119] offset:5120
    ds_write_b128 v13, v[120:123] offset:6144
    ds_write_b128 v13, v[124:127] offset:7168
    s_waitcnt vmcnt(0)
    s_nop 0
    ds_write_b128 v13, v[128:131] offset:32768
    ds_write_b128 v13, v[132:135] offset:33792
    ds_write_b128 v13, v[136:139] offset:34816
    ds_write_b128 v13, v[140:143] offset:35840
    ds_write_b128 v13, v[144:147] offset:36864
    ds_write_b128 v13, v[148:151] offset:37888
    ds_write_b128 v13, v[152:155] offset:38912
    ds_write_b128 v13, v[156:159] offset:39936
    v_mov_b32 v24, 8
    s_mov_b64 exec, s[90:91]
    ds_write_b32 v22, v24 offset:32
    s_mov_b64 exec, -1
    s_cmp_eq_u32 s4, s96
    s_cbranch_scc1 Lnr_32
    s_movk_i32 s0, 20000
Lspin_34:
    s_sleep 2
    buffer_load_dwordx4 v[36:39], v1, s[84:87], s95 offen sc1
    s_sub_u32 s0, s0, 1
    s_cbranch_scc1 Lok_33
    s_waitcnt vmcnt(0)
    v_cmp_ne_u32 vcc, s7, v37
    v_cmp_ne_u32 s[8:9], s7, v39
    s_nop 0
    s_or_b64 vcc, vcc, s[8:9]
    s_cmp_eq_u64 vcc, 0
    s_cbranch_scc0 Lspin_34
Lok_33:
    v_mov_b32 v37, v38
Lnr_32:
    ds_write_b64 v40, v[36:37]
    v_mov_b32 v24, 5
    s_mov_b64 exec, s[90:91]
    ds_write_b32 v22, v24 offset:96
    s_mov_b64 exec, -1
    s_mov_b32 s0, 0x40000
Lfsp_36:
    s_sleep 1
    ds_read_b32 v23, v22 offset:112
    s_sub_u32 s0, s0, 1
    s_cbranch_scc1 Lfok_35
    s_waitcnt lgkmcnt(0)
    v_cmp_gt_u32 vcc, 6, v23
    s_cbranch_vccnz Lfsp_36
Lfok_35:
    s_lshr_b32 s3, s2, 3
    s_lshl_b32 s3, s3, 2
    s_add_u32 s3, s3, s13
    s_mul_i32 s3, s3, 14336
    v_lshlrev_b32 v5, 10, v0
    s_mov_b64 exec, 0x3fff
    buffer_load_dword v31, v5, s[68:71], s3 offen offset:384
    s_mov_b64 exec, -1
    s_mov_b32 s14, 128
    buffer_load_dwordx4 v[160:163], v9, s[64:67], s14 offen
    s_mov_b32 s14, 28800
    buffer_load_dwordx4 v[164:167], v9, s[64:67], s14 offen
    s_mov_b32 s14, 57472
    buffer_load_dwordx4 v[168:171], v9, s[64:67], s14 offen
    s_mov_b32 s14, 86144
    buffer_load_dwordx4 v[172:175], v9, s[64:67], s14 offen
    s_mov_b32 s14, 114816
    buffer_load_dwordx4 v[176:179], v9, s[64:67], s14 offen
    s_mov_b32 s14, 143488
    buffer_load_dwordx4 v[180:183], v9, s[64:67], s14 offen
    s_mov_b32 s14, 172160
    buffer_load_dwordx4 v[184:187], v9, s[64:67], s14 offen
    s_mov_b32 s14, 200832
    buffer_load_dwordx4 v[188:191], v9, s[64:67], s14 offen
    s_mov_b32 s14, 458880
    buffer_load_dwordx4 v[224:227], v9, s[64:67], s14 offen
    s_mov_b32 s14, 487552
    buffer_load_dwordx4 v[228:231], v9, s[64:67], s14 offen
    s_mov_b32 s14, 516224
    buffer_load_dwordx4 v[232:235], v9, s[64:67], s14 offen
    s_mov_b32 s14, 544896
    buffer_load_dwordx4 v[236:239], v9, s[64:67], s14 offen
    s_mov_b32 s14, 573568
    buffer_load_dwordx4 v[240:243], v9, s[64:67], s14 offen
    s_mov_b32 s14, 602240
    buffer_load_dwordx4 v[244:247], v9, s[64:67], s14 offen
    s_mov_b32 s14, 630912
    buffer_load_dwordx4 v[248:251], v9, s[64:67], s14 offen
    s_mov_b32 s14, 659584
    buffer_load_dwordx4 v[252:255], v9, s[64:67], s14 offen
    s_cmp_ge_u32 s13, 2
    s_cbranch_scc1 Ljoin_37
    s_mov_b32 s0, 0x40000
Lfsp_39:
    s_sleep 1
    ds_read_b32 v23, v22 offset:112
    ds_read_b64 v[32:33], v14
    ds_read_b64 v[36:37], v14 offset:1024
    s_sub_u32 s0, s0, 1
    s_cbranch_scc1 Lfok_38
    s_waitcnt lgkmcnt(0)
    v_cmp_gt_u32 vcc, 7, v23
    s_nop 0
    s_and_b64 vcc, vcc, s[88:89]
    s_cbranch_scc1 Lfsp_39
Lfok_38:
    v_pk_add_f32 v[32:33], v[32:33], v[36:37]
    v_mov_b32 v36, v32
    v_mov_b32 v37, v33
    v_mov_b32 v34, s7
    v_mov_b32 v35, s7
    v_permlane32_swap_b32 v32, v36
    v_permlane32_swap_b32 v33, v37
    v_pk_add_f32 v[32:33], v[32:33], v[36:37]
    s_mov_b32 s8, -1
    s_mov_b32 s9, 0
    s_mov_b64 exec, s[8:9]
    buffer_store_dwordx4 v[32:35], v1, s[72:75], s101 offen
    s_cmp_eq_u32 s78, 0
    s_cbranch_scc0 Lslow_41
Lfs_40:
    s_mov_b64 exec, -1
Ljoin_37:
    s_mov_b32 s0, 0x40000
Lfsp_43:
    s_sleep 1
    ds_read_b32 v23, v22 offset:112
    s_sub_u32 s0, s0, 1
    s_cbranch_scc1 Lfok_42
    s_waitcnt lgkmcnt(0)
    v_cmp_gt_u32 vcc, 7, v23
    s_cbranch_vccnz Lfsp_43
Lfok_42:
    s_waitcnt vmcnt(8)
    s_nop 0
    ds_write_b128 v12, v[160:163] offset:0
    ds_write_b128 v12, v[164:167] offset:1024
    ds_write_b128 v12, v[168:171] offset:2048
    ds_write_b128 v12, v[172:175] offset:3072
    ds_write_b128 v12, v[176:179] offset:4096
    ds_write_b128 v12, v[180:183] offset:5120
    ds_write_b128 v12, v[184:187] offset:6144
    ds_write_b128 v12, v[188:191] offset:7168
    v_mov_b32 v24, 9
    s_mov_b64 exec, s[90:91]
    ds_write_b32 v22, v24 offset:32
    s_mov_b64 exec, -1
    s_cmp_ge_u32 s13, 2
    s_cbranch_scc1 Lne_44
    s_movk_i32 s0, 20000
Lspin_46:
    s_sleep 2
    buffer_load_dwordx4 v[40:43], v1, s[84:87], s100 offen offset:0 sc1
    buffer_load_dwordx4 v[44:47], v1, s[84:87], s100 offen offset:1024 sc1
    buffer_load_dwordx4 v[48:51], v1, s[84:87], s100 offen offset:2048 sc1
    buffer_load_dwordx4 v[52:55], v1, s[84:87], s100 offen offset:3072 sc1
    s_sub_u32 s0, s0, 1
    s_cbranch_scc1 Lok_45
    s_waitcnt vmcnt(0)
    v_cmp_ne_u32 vcc, s7, v43
    v_cmp_ne_u32 s[8:9], s7, v47
    s_nop 0
    s_or_b64 vcc, vcc, s[8:9]
    v_cmp_ne_u32 s[8:9], s7, v51
    s_nop 0
    s_or_b64 vcc, vcc, s[8:9]
    v_cmp_ne_u32 s[8:9], s7, v55
    s_nop 0
    s_or_b64 vcc, vcc, s[8:9]
    s_cmp_eq_u64 vcc, 0
    s_cbranch_scc0 Lspin_46
Lok_45:
    v_add_f32 v40, v40, v44
    v_add_f32 v41, v41, v45
    v_add_f32 v40, v40, v48
    v_add_f32 v41, v41, v49
    v_add_f32 v40, v40, v52
    v_add_f32 v41, v41, v53
    v_mov_b32 v44, v40
    v_mov_b32 v45, v41
    s_nop 0
    v_permlane32_swap_b32 v40, v44
    v_permlane32_swap_b32 v41, v45
    v_add_f32 v40, v40, v44
    v_add_f32 v41, v41, v45
    v_mul_f32 v32, 0x3b000000, v40
    v_mul_f32 v41, 0x3b000000, v41
    v_fma_f32 v41, -v32, v32, v41
    v_max_f32 v41, 0, v41
    v_add_f32 v41, 0x3727c5ac, v41
    v_rsq_f32 v42, v41
    v_sqrt_f32_e64 v35, v41
    v_mul_f32 v33, 0xc0135761, v42
    v_mul_f32 v34, 0xbdd2d3e8, v42
    v_mul_f32 v34, v34, v42
    v_mul_f32 v34, v34, v42
    ds_write_b128 v15, v[32:35]
Lne_44:
    v_mov_b32 v24, 6
    s_mov_b64 exec, s[90:91]
    ds_write_b32 v22, v24 offset:96
    s_mov_b64 exec, -1
    s_waitcnt vmcnt(0)
    ds_write_b128 v12, v[224:227] offset:32768
    ds_write_b128 v12, v[228:231] offset:33792
    ds_write_b128 v12, v[232:235] offset:34816
    ds_write_b128 v12, v[236:239] offset:35840
    ds_write_b128 v12, v[240:243] offset:36864
    ds_write_b128 v12, v[244:247] offset:37888
    ds_write_b128 v12, v[248:251] offset:38912
    ds_write_b128 v12, v[252:255] offset:39936
    v_mov_b32 v24, 10
    s_mov_b64 exec, s[90:91]
    ds_write_b32 v22, v24 offset:32
    s_mov_b64 exec, -1
    s_mov_b32 s0, 0x40000
Lfsp_48:
    s_sleep 1
    ds_read_b32 v23, v22 offset:48
    s_sub_u32 s0, s0, 1
    s_cbranch_scc1 Lfok_47
    s_waitcnt lgkmcnt(0)
    v_cmp_gt_u32 vcc, 7, v23
    s_cbranch_vccnz Lfsp_48
Lfok_47:
    s_add_u32 m0, s12, 65536
    s_mov_b32 s14, 256
    buffer_load_dwordx4 v9, s[64:67], s14 offen lds
    s_waitcnt vmcnt(4)
    s_add_u32 m0, s12, 66560
    s_mov_b32 s14, 28928
    buffer_load_dwordx4 v9, s[64:67], s14 offen lds
    s_waitcnt vmcnt(4)
    s_add_u32 m0, s12, 67584
    s_mov_b32 s14, 57600
    buffer_load_dwordx4 v9, s[64:67], s14 offen lds
    s_waitcnt vmcnt(4)
    s_add_u32 m0, s12, 68608
    s_mov_b32 s14, 86272
    buffer_load_dwordx4 v9, s[64:67], s14 offen lds
    s_waitcnt vmcnt(4)
    s_add_u32 m0, s12, 69632
    s_mov_b32 s14, 114944
    buffer_load_dwordx4 v9, s[64:67], s14 offen lds
    s_waitcnt vmcnt(4)
    s_add_u32 m0, s12, 70656
    s_mov_b32 s14, 143616
    buffer_load_dwordx4 v9, s[64:67], s14 offen lds
    s_waitcnt vmcnt(4)
    s_add_u32 m0, s12, 71680
    s_mov_b32 s14, 172288
    buffer_load_dwordx4 v9, s[64:67], s14 offen lds
    ds_read_b32 v23, v22 offset:48
    s_waitcnt vmcnt(4)
    s_add_u32 m0, s12, 72704
    s_mov_b32 s14, 200960
    buffer_load_dwordx4 v9, s[64:67], s14 offen lds
    s_waitcnt vmcnt(4)
    s_waitcnt lgkmcnt(0)
    v_cmp_gt_u32 vcc, 8, v23
    s_cbranch_vccnz Lslow_51
Lfok_49:
    s_add_u32 m0, s12, 98304
    s_mov_b32 s14, 459008
    buffer_load_dwordx4 v9, s[64:67], s14 offen lds
    s_waitcnt vmcnt(4)
    s_add_u32 m0, s12, 99328
    s_mov_b32 s14, 487680
    buffer_load_dwordx4 v9, s[64:67], s14 offen lds
    s_mov_b32 s14, 458752
    buffer_load_dwordx4 v[64:67], v11, s[68:71], s14 offen
    s_add_u32 m0, s12, 100352
    s_mov_b32 s14, 516352
    buffer_load_dwordx4 v9, s[64:67], s14 offen lds
    s_waitcnt vmcnt(4)
    s_add_u32 m0, s12, 101376
    s_mov_b32 s14, 545024
    buffer_load_dwordx4 v9, s[64:67], s14 offen lds
    s_mov_b32 s14, 466944
    buffer_load_dwordx4 v[68:71], v11, s[68:71], s14 offen
    s_add_u32 m0, s12, 102400
    s_mov_b32 s14, 573696
    buffer_load_dwordx4 v9, s[64:67], s14 offen lds
    s_waitcnt vmcnt(4)
    s_add_u32 m0, s12, 103424
    s_mov_b32 s14, 602368
    buffer_load_dwordx4 v9, s[64:67], s14 offen lds
    s_waitcnt vmcnt(8)
    v_mov_b32 v24, 11
    s_mov_b64 exec, s[90:91]
    ds_write_b32 v22, v24 offset:32
    s_mov_b64 exec, -1
    s_mov_b32 s14, 475136
    buffer_load_dwordx4 v[72:75], v11, s[68:71], s14 offen
    s_add_u32 m0, s12, 104448
    s_mov_b32 s14, 631040
    buffer_load_dwordx4 v9, s[64:67], s14 offen lds
    ds_read_b32 v23, v22 offset:48
    s_waitcnt vmcnt(4)
    s_add_u32 m0, s12, 105472
    s_mov_b32 s14, 659712
    buffer_load_dwordx4 v9, s[64:67], s14 offen lds
    s_mov_b32 s14, 483328
    buffer_load_dwordx4 v[76:79], v11, s[68:71], s14 offen
    s_waitcnt lgkmcnt(0)
    v_cmp_gt_u32 vcc, 9, v23
    s_cbranch_vccnz Lslow_54
Lfok_52:
    s_add_u32 m0, s12, 0
    s_mov_b32 s14, 0
    buffer_load_dwordx4 v10, s[64:67], s14 offen lds
    s_waitcnt vmcnt(4)
    s_add_u32 m0, s12, 1024
    s_mov_b32 s14, 28672
    buffer_load_dwordx4 v10, s[64:67], s14 offen lds
    s_waitcnt vmcnt(4)
    s_add_u32 m0, s12, 2048
    s_mov_b32 s14, 57344
    buffer_load_dwordx4 v10, s[64:67], s14 offen lds
    s_waitcnt vmcnt(4)
    s_add_u32 m0, s12, 3072
    s_mov_b32 s14, 86016
    buffer_load_dwordx4 v10, s[64:67], s14 offen lds
    s_waitcnt vmcnt(4)
    s_add_u32 m0, s12, 4096
    s_mov_b32 s14, 114688
    buffer_load_dwordx4 v10, s[64:67], s14 offen lds
    s_waitcnt vmcnt(4)
    s_add_u32 m0, s12, 5120
    s_mov_b32 s14, 143360
    buffer_load_dwordx4 v10, s[64:67], s14 offen lds
    s_waitcnt vmcnt(4)
    s_add_u32 m0, s12, 6144
    s_mov_b32 s14, 172032
    buffer_load_dwordx4 v10, s[64:67], s14 offen lds
    ds_read_b32 v23, v22 offset:48
    s_waitcnt vmcnt(4)
    s_add_u32 m0, s12, 7168
    s_mov_b32 s14, 200704
    buffer_load_dwordx4 v10, s[64:67], s14 offen lds
    s_waitcnt vmcnt(9)
    v_mov_b32 v24, 12
    s_mov_b64 exec, s[90:91]
    ds_write_b32 v22, v24 offset:32
    s_mov_b64 exec, -1
    s_waitcnt vmcnt(4)
    s_waitcnt lgkmcnt(1)
    v_cmp_gt_u32 vcc, 10, v23
    s_cbranch_vccnz Lslow_57
Lfok_55:
    s_add_u32 m0, s12, 32768
    s_mov_b32 s14, 0
    s_nop 0
    buffer_load_dwordx4 v11, s[68:71], s14 offen lds
    s_mov_b32 s14, 491520
    buffer_load_dwordx4 v[80:83], v11, s[68:71], s14 offen
    s_mov_b32 s14, 499712
    buffer_load_dwordx4 v[84:87], v11, s[68:71], s14 offen
    s_add_u32 m0, s12, 33792
    s_mov_b32 s14, 8192
    buffer_load_dwordx4 v11, s[68:71], s14 offen lds
    s_mov_b32 s14, 507904
    buffer_load_dwordx4 v[88:91], v11, s[68:71], s14 offen
    s_mov_b32 s14, 516096
    buffer_load_dwordx4 v[92:95], v11, s[68:71], s14 offen
    s_add_u32 m0, s12, 34816
    s_mov_b32 s14, 16384
    buffer_load_dwordx4 v11, s[68:71], s14 offen lds
    s_mov_b32 s14, 65536
    buffer_load_dwordx4 v[192:195], v11, s[68:71], s14 offen
    s_waitcnt vmcnt(8)
    v_mov_b32 v24, 13
    s_mov_b64 exec, s[90:91]
    ds_write_b32 v22, v24 offset:32
    s_mov_b64 exec, -1
    s_mov_b32 s14, 73728
    buffer_load_dwordx4 v[196:199], v11, s[68:71], s14 offen
    s_add_u32 m0, s12, 35840
    s_mov_b32 s14, 24576
    buffer_load_dwordx4 v11, s[68:71], s14 offen lds
    s_mov_b32 s14, 81920
    buffer_load_dwordx4 v[200:203], v11, s[68:71], s14 offen
    s_mov_b32 s14, 90112
    buffer_load_dwordx4 v[204:207], v11, s[68:71], s14 offen
    s_add_u32 m0, s12, 36864
    s_mov_b32 s14, 32768
    buffer_load_dwordx4 v11, s[68:71], s14 offen lds
    s_mov_b32 s14, 98304
    buffer_load_dwordx4 v[208:211], v11, s[68:71], s14 offen
    s_mov_b32 s14, 106496
    buffer_load_dwordx4 v[212:215], v11, s[68:71], s14 offen
    s_add_u32 m0, s12, 37888
    s_mov_b32 s14, 40960
    buffer_load_dwordx4 v11, s[68:71], s14 offen lds
    s_mov_b32 s14, 114688
    buffer_load_dwordx4 v[216:219], v11, s[68:71], s14 offen
    s_mov_b32 s14, 122880
    buffer_load_dwordx4 v[220:223], v11, s[68:71], s14 offen
    s_add_u32 m0, s12, 38912
    s_mov_b32 s14, 49152
    buffer_load_dwordx4 v11, s[68:71], s14 offen lds
    ds_read_b32 v23, v22 offset:48
    s_mov_b32 s14, 524288
    buffer_load_dwordx4 v[96:99], v11, s[68:71], s14 offen
    s_mov_b32 s14, 532480
    buffer_load_dwordx4 v[100:103], v11, s[68:71], s14 offen
    s_add_u32 m0, s12, 39936
    s_mov_b32 s14, 57344
    buffer_load_dwordx4 v11, s[68:71], s14 offen lds
    s_mov_b32 s14, 540672
    buffer_load_dwordx4 v[104:107], v11, s[68:71], s14 offen
    s_mov_b32 s14, 548864
    buffer_load_dwordx4 v[108:111], v11, s[68:71], s14 offen
    s_waitcnt vmcnt(2)
    v_mov_b32 v24, 14
    s_mov_b64 exec, s[90:91]
    ds_write_b32 v22, v24 offset:32
    s_mov_b64 exec, -1
    s_mov_b32 s0, 0x40000
Lfsp_59:
    s_sleep 1
    ds_read_b32 v23, v22 offset:48
    s_sub_u32 s0, s0, 1
    s_cbranch_scc1 Lfok_58
    s_waitcnt lgkmcnt(0)
    v_cmp_gt_u32 vcc, 11, v23
    s_cbranch_vccnz Lfsp_59
Lfok_58:
    ds_write_b128 v13, v[64:67] offset:0
    ds_write_b128 v13, v[68:71] offset:1024
    ds_write_b128 v13, v[72:75] offset:2048
    ds_write_b128 v13, v[76:79] offset:3072
    ds_write_b128 v13, v[80:83] offset:4096
    ds_write_b128 v13, v[84:87] offset:5120
    ds_write_b128 v13, v[88:91] offset:6144
    ds_write_b128 v13, v[92:95] offset:7168
    v_mov_b32 v24, 15
    s_mov_b64 exec, s[90:91]
    ds_write_b32 v22, v24 offset:32
    s_mov_b64 exec, -1
    s_mov_b32 s14, 557056
    buffer_load_dwordx4 v[112:115], v11, s[68:71], s14 offen
    s_mov_b32 s14, 565248
    buffer_load_dwordx4 v[116:119], v11, s[68:71], s14 offen
    s_mov_b32 s14, 573440
    buffer_load_dwordx4 v[120:123], v11, s[68:71], s14 offen
    s_mov_b32 s14, 581632
    buffer_load_dwordx4 v[124:127], v11, s[68:71], s14 offen
    s_mov_b32 s0, 0x40000
Lfsp_61:
    s_sleep 1
    ds_read_b32 v23, v22 offset:48
    s_sub_u32 s0, s0, 1
    s_cbranch_scc1 Lfok_60
    s_waitcnt lgkmcnt(0)
    v_cmp_gt_u32 vcc, 12, v23
    s_cbranch_vccnz Lfsp_61
Lfok_60:
    s_nop 0
    ds_write_b128 v13, v[192:195] offset:32768
    ds_write_b128 v13, v[196:199] offset:33792
    ds_write_b128 v13, v[200:203] offset:34816
    ds_write_b128 v13, v[204:207] offset:35840
    ds_write_b128 v13, v[208:211] offset:36864
    ds_write_b128 v13, v[212:215] offset:37888
    ds_write_b128 v13, v[216:219] offset:38912
    ds_write_b128 v13, v[220:223] offset:39936
    v_mov_b32 v24, 16
    s_mov_b64 exec, s[90:91]
    ds_write_b32 v22, v24 offset:32
    s_mov_b64 exec, -1
    s_nop 0
    s_mov_b32 s14, 131072
    buffer_load_dwordx4 v[128:131], v11, s[68:71], s14 offen
    s_mov_b32 s14, 139264
    buffer_load_dwordx4 v[132:135], v11, s[68:71], s14 offen
    s_mov_b32 s14, 147456
    buffer_load_dwordx4 v[136:139], v11, s[68:71], s14 offen
    s_mov_b32 s14, 155648
    buffer_load_dwordx4 v[140:143], v11, s[68:71], s14 offen
    s_mov_b32 s14, 163840
    buffer_load_dwordx4 v[144:147], v11, s[68:71], s14 offen
    s_mov_b32 s14, 172032
    buffer_load_dwordx4 v[148:151], v11, s[68:71], s14 offen
    s_mov_b32 s14, 180224
    buffer_load_dwordx4 v[152:155], v11, s[68:71], s14 offen
    s_mov_b32 s14, 188416
    buffer_load_dwordx4 v[156:159], v11, s[68:71], s14 offen
    s_mov_b32 s0, 0x40000
Lfsp_63:
    s_sleep 1
    ds_read_b32 v23, v22 offset:48
    s_sub_u32 s0, s0, 1
    s_cbranch_scc1 Lfok_62
    s_waitcnt lgkmcnt(0)
    v_cmp_gt_u32 vcc, 13, v23
    s_cbranch_vccnz Lfsp_63
Lfok_62:
    s_waitcnt vmcnt(8)
    s_nop 0
    ds_write_b128 v12, v[96:99] offset:0
    ds_write_b128 v12, v[100:103] offset:1024
    ds_write_b128 v12, v[104:107] offset:2048
    ds_write_b128 v12, v[108:111] offset:3072
    ds_write_b128 v12, v[112:115] offset:4096
    ds_write_b128 v12, v[116:119] offset:5120
    ds_write_b128 v12, v[120:123] offset:6144
    ds_write_b128 v12, v[124:127] offset:7168
    v_mov_b32 v24, 17
    s_mov_b64 exec, s[90:91]
    ds_write_b32 v22, v24 offset:32
    s_mov_b64 exec, -1
    s_nop 0
    s_mov_b32 s14, 589824
    buffer_load_dwordx4 v[160:163], v11, s[68:71], s14 offen
    s_mov_b32 s14, 598016
    buffer_load_dwordx4 v[164:167], v11, s[68:71], s14 offen
    s_mov_b32 s14, 606208
    buffer_load_dwordx4 v[168:171], v11, s[68:71], s14 offen
    s_mov_b32 s14, 614400
    buffer_load_dwordx4 v[172:175], v11, s[68:71], s14 offen
    s_mov_b32 s14, 622592
    buffer_load_dwordx4 v[176:179], v11, s[68:71], s14 offen
    s_mov_b32 s14, 630784
    buffer_load_dwordx4 v[180:183], v11, s[68:71], s14 offen
    s_mov_b32 s14, 638976
    buffer_load_dwordx4 v[184:187], v11, s[68:71], s14 offen
    s_mov_b32 s14, 647168
    buffer_load_dwordx4 v[188:191], v11, s[68:71], s14 offen
    s_mov_b32 s0, 0x40000
Lfsp_65:
    s_sleep 1
    ds_read_b32 v23, v22 offset:48
    s_sub_u32 s0, s0, 1
    s_cbranch_scc1 Lfok_64
    s_waitcnt lgkmcnt(0)
    v_cmp_gt_u32 vcc, 14, v23
    s_cbranch_vccnz Lfsp_65
Lfok_64:
    s_waitcnt vmcnt(8)
    s_nop 0
    ds_write_b128 v12, v[128:131] offset:32768
    ds_write_b128 v12, v[132:135] offset:33792
    ds_write_b128 v12, v[136:139] offset:34816
    ds_write_b128 v12, v[140:143] offset:35840
    ds_write_b128 v12, v[144:147] offset:36864
    ds_write_b128 v12, v[148:151] offset:37888
    ds_write_b128 v12, v[152:155] offset:38912
    ds_write_b128 v12, v[156:159] offset:39936
    v_mov_b32 v24, 18
    s_mov_b64 exec, s[90:91]
    ds_write_b32 v22, v24 offset:32
    s_mov_b64 exec, -1
    s_nop 0
    s_add_u32 s14, s15, 196608
    buffer_load_dwordx4 v[224:227], v11, s[68:71], s14 offen
    s_add_u32 s14, s15, 204800
    buffer_load_dwordx4 v[228:231], v11, s[68:71], s14 offen
    s_add_u32 s14, s15, 212992
    buffer_load_dwordx4 v[232:235], v11, s[68:71], s14 offen
    s_add_u32 s14, s15, 221184
    buffer_load_dwordx4 v[236:239], v11, s[68:71], s14 offen
    s_add_u32 s14, s15, 229376
    buffer_load_dwordx4 v[240:243], v11, s[68:71], s14 offen
    s_add_u32 s14, s15, 237568
    buffer_load_dwordx4 v[244:247], v11, s[68:71], s14 offen
    s_add_u32 s14, s15, 245760
    buffer_load_dwordx4 v[248:251], v11, s[68:71], s14 offen
    s_add_u32 s14, s15, 253952
    buffer_load_dwordx4 v[252:255], v11, s[68:71], s14 offen
    s_mov_b32 s0, 0x40000
Lfsp_67:
    s_sleep 1
    ds_read_b32 v23, v22 offset:48
    s_sub_u32 s0, s0, 1
    s_cbranch_scc1 Lfok_66
    s_waitcnt lgkmcnt(0)
    v_cmp_gt_u32 vcc, 15, v23
    s_cbranch_vccnz Lfsp_67
Lfok_66:
    s_waitcnt vmcnt(8)
    s_nop 0
    ds_write_b128 v13, v[160:163] offset:0
    ds_write_b128 v13, v[164:167] offset:1024
    ds_write_b128 v13, v[168:171] offset:2048
    ds_write_b128 v13, v[172:175] offset:3072
    ds_write_b128 v13, v[176:179] offset:4096
    ds_write_b128 v13, v[180:183] offset:5120
    ds_write_b128 v13, v[184:187] offset:6144
    ds_write_b128 v13, v[188:191] offset:7168
    v_mov_b32 v24, 19
    s_mov_b64 exec, s[90:91]
    ds_write_b32 v22, v24 offset:32
    s_mov_b64 exec, -1
    s_mov_b32 s0, 0x40000
Lfsp_69:
    s_sleep 1
    ds_read_b32 v23, v22 offset:48
    s_sub_u32 s0, s0, 1
    s_cbranch_scc1 Lfok_68
    s_waitcnt lgkmcnt(0)
    v_cmp_gt_u32 vcc, 16, v23
    s_cbranch_vccnz Lfsp_69
Lfok_68:
    s_waitcnt vmcnt(0)
    ds_write_b128 v13, v[224:227] offset:32768
    ds_write_b128 v13, v[228:231] offset:33792
    ds_write_b128 v13, v[232:235] offset:34816
    ds_write_b128 v13, v[236:239] offset:35840
    ds_write_b128 v13, v[240:243] offset:36864
    ds_write_b128 v13, v[244:247] offset:37888
    ds_write_b128 v13, v[248:251] offset:38912
    ds_write_b128 v13, v[252:255] offset:39936
    v_mov_b32 v24, 20
    s_mov_b64 exec, s[90:91]
    ds_write_b32 v22, v24 offset:32
    s_mov_b64 exec, -1
    s_lshl_b32 s3, s2, 3
    s_add_u32 s3, s3, s6
    s_cmp_lg_u32 s3, 4
    s_cbranch_scc1 Lfin_70
    s_movk_i32 s11, 0x1000
    s_movk_i32 s0, 20000
Lspin_72:
    buffer_load_dwordx4 v[32:35], v1, s[84:87], s11 offen sc1
    s_sub_u32 s0, s0, 1
    s_cbranch_scc1 Lok_71
    s_waitcnt vmcnt(0)
    v_cmp_ne_u32 vcc, s7, v32
    v_cmp_ne_u32 s[8:9], s7, v33
    s_nop 0
    s_or_b64 vcc, vcc, s[8:9]
    v_cmp_ne_u32 s[8:9], s7, v34
    s_nop 0
    s_or_b64 vcc, vcc, s[8:9]
    v_cmp_ne_u32 s[8:9], s7, v35
    s_nop 0
    s_or_b64 vcc, vcc, s[8:9]
    s_cmp_eq_u64 vcc, 0
    s_cbranch_scc0 Lspin_72
Lok_71:
    buffer_store_dword v6, v16, s[84:87], 0 offen sc1
Lfin_70:
    s_endpgm
Lslow_3:
    s_nop 7
    s_movk_i32 s0, 20000
Lspin_2:
    buffer_load_dwordx2 v[70:71], v69, s[84:87], s94 offen sc1
    s_sub_u32 s0, s0, 1
    s_cbranch_scc1 Lok_1
    s_waitcnt vmcnt(0)
    v_cmp_ne_u32 vcc, s7, v70
    s_nop 0
    s_cmp_eq_u64 vcc, 0
    s_cbranch_scc0 Lspin_2
    s_branch Lok_1
Lslow_6:
    s_nop 7
    s_movk_i32 s0, 20000
Lspin_5:
    s_sleep 8
    buffer_load_dwordx4 v[192:195], v72, s[84:87], s92 offen sc1
    buffer_load_dwordx4 v[196:199], v72, s[84:87], s93 offen sc1
    buffer_load_dwordx4 v[200:203], v72, s[84:87], s92 offen offset:2048 sc1
    buffer_load_dwordx4 v[204:207], v72, s[84:87], s93 offen offset:2048 sc1
    buffer_load_dwordx4 v[208:211], v73, s[84:87], s94 offen sc1
    buffer_load_dwordx4 v[212:215], v74, s[84:87], s95 offen sc1
    s_sub_u32 s0, s0, 1
    s_cbranch_scc1 Lok_4
    s_waitcnt vmcnt(0)
    v_xor_b32 v192, s97, v192
    v_xor_b32 v193, s88, v193
    v_xor_b32 v194, s89, v194
    v_xor_b32 v195, s96, v195
    v_xor_b32 v196, s97, v196
    v_xor_b32 v197, s88, v197
    v_xor_b32 v198, s89, v198
    v_xor_b32 v199, s96, v199
    v_xor_b32 v200, s97, v200
    v_xor_b32 v201, s88, v201
    v_xor_b32 v202, s89, v202
    v_xor_b32 v203, s96, v203
    v_xor_b32 v204, s97, v204
    v_xor_b32 v205, s88, v205
    v_xor_b32 v206, s89, v206
    v_xor_b32 v207, s96, v207
    v_xor_b32 v208, s97, v208
    v_xor_b32 v209, s88, v209
    v_xor_b32 v210, s89, v210
    v_xor_b32 v211, s96, v211
    v_xor_b32 v212, s97, v212
    v_xor_b32 v213, s88, v213
    v_xor_b32 v214, s89, v214
    v_xor_b32 v215, s96, v215
    v_or_b32_e64 v2, v192, v193
    v_or3_b32 v2, v2, v194, v195
    v_or3_b32 v2, v2, v196, v197
    v_or3_b32 v2, v2, v198, v199
    v_or3_b32 v2, v2, v200, v201
    v_or3_b32 v2, v2, v202, v203
    v_or3_b32 v2, v2, v204, v205
    v_or3_b32 v2, v2, v206, v207
    v_or3_b32 v2, v2, v208, v209
    v_or3_b32 v2, v2, v210, v211
    v_or3_b32 v2, v2, v212, v213
    v_or3_b32 v2, v2, v214, v215
    v_and_b32 v2, 0xff, v2
    v_cmp_ne_u32 vcc, 0, v2
    s_nop 0
    s_cmp_eq_u64 vcc, 0
    s_cbranch_scc0 Lspin_5
    s_branch Lok_4
Lslow_18:
    buffer_store_dwordx4 v[80:83], v1, s[76:79], s99 offen sc1
    s_waitcnt vmcnt(0)
    s_branch Lfs_17
Lslow_41:
    buffer_store_dwordx4 v[32:35], v1, s[76:79], s101 offen sc1
    s_waitcnt vmcnt(0)
    s_branch Lfs_40
Lslow_51:
    s_nop 7
    s_mov_b32 s0, 0x40000
Lfsp_50:
    s_sleep 1
    ds_read_b32 v23, v22 offset:48
    s_sub_u32 s0, s0, 1
    s_cbranch_scc1 Lfok_49
    s_waitcnt lgkmcnt(0)
    v_cmp_gt_u32 vcc, 8, v23
    s_cbranch_vccnz Lfsp_50
    s_branch Lfok_49
Lslow_54:
    s_nop 7
    s_mov_b32 s0, 0x40000
Lfsp_53:
    s_sleep 1
    ds_read_b32 v23, v22 offset:48
    s_sub_u32 s0, s0, 1
    s_cbranch_scc1 Lfok_52
    s_waitcnt lgkmcnt(0)
    v_cmp_gt_u32 vcc, 9, v23
    s_cbranch_vccnz Lfsp_53
    s_branch Lfok_52
Lslow_57:
    s_nop 7
    s_mov_b32 s0, 0x40000
Lfsp_56:
    s_sleep 1
    ds_read_b32 v23, v22 offset:48
    s_sub_u32 s0, s0, 1
    s_cbranch_scc1 Lfok_55
    s_waitcnt lgkmcnt(0)
    v_cmp_gt_u32 vcc, 10, v23
    s_cbranch_vccnz Lfsp_56
    s_branch Lfok_55
Lslow_80:
    s_nop 7
    s_movk_i32 s0, 20000
Lspin_79:
    s_sleep 2
    buffer_load_dword v173, v172, s[84:87], s100 offen sc1
    s_sub_u32 s0, s0, 1
    s_cbranch_scc1 Lok_78
    s_waitcnt vmcnt(0)
    v_cmp_ne_u32 vcc, s7, v173
    s_nop 0
    s_cmp_eq_u64 vcc, 0
    s_cbranch_scc0 Lspin_79
    s_branch Lok_78
Lslow_84:
    s_nop 7
    s_movk_i32 s0, 20000
Lspin_83:
    buffer_load_dwordx4 v[24:27], v1, s[84:87], s11 offen sc1
    buffer_load_dwordx4 v[28:31], v175, s[84:87], s11 offen sc1
    buffer_load_dwordx4 v[32:35], v1, s[84:87], s93 offen sc1
    buffer_load_dwordx4 v[36:39], v175, s[84:87], s93 offen sc1
    s_sub_u32 s0, s0, 1
    s_cbranch_scc1 Lok_82
    s_waitcnt vmcnt(0)
    v_xor_b32 v24, s1, v24
    v_xor_b32 v25, s47, v25
    v_xor_b32 v26, s66, v26
    v_xor_b32 v27, s67, v27
    v_xor_b32 v28, s1, v28
    v_xor_b32 v29, s47, v29
    v_xor_b32 v30, s66, v30
    v_xor_b32 v31, s67, v31
    v_xor_b32 v32, s1, v32
    v_xor_b32 v33, s47, v33
    v_xor_b32 v34, s66, v34
    v_xor_b32 v35, s67, v35
    v_xor_b32 v36, s1, v36
    v_xor_b32 v37, s47, v37
    v_xor_b32 v38, s66, v38
    v_xor_b32 v39, s67, v39
    v_or_b32 v2, v24, v25
    v_or3_b32 v2, v2, v26, v27
    v_or3_b32 v2, v2, v28, v29
    v_or3_b32 v2, v2, v30, v31
    v_or3_b32 v2, v2, v32, v33
    v_or3_b32 v2, v2, v34, v35
    v_or3_b32 v2, v2, v36, v37
    v_or3_b32 v2, v2, v38, v39
    v_and_b32 v2, 0xff, v2
    v_cmp_ne_u32 vcc, 0, v2
    s_nop 0
    s_cmp_eq_u64 vcc, 0
    s_cbranch_scc0 Lspin_83
    s_branch Lok_82
Lslow_87:
    buffer_store_dwordx4 v[24:27], v1, s[76:79], s99 offen sc1
    s_waitcnt vmcnt(0)
    s_branch Lfs_86
Lslow_89:
    buffer_store_dwordx4 v[28:31], v1, s[76:79], s11 offen sc1
    s_waitcnt vmcnt(0)
    s_branch Lfs_88
Lslow_91:
    buffer_store_dword v6, v7, s[76:79], s10 offen sc1
    s_waitcnt vmcnt(0)
    s_branch Lfs_90
Lslow_94:
    s_nop 7
    s_mov_b32 s0, 0x40000
Lfsp_93:
    ds_read_b32 v10, v9 offset:32
    s_sub_u32 s0, s0, 1
    s_cbranch_scc1 Lfok_92
    s_waitcnt lgkmcnt(0)
    v_cmp_gt_u32 vcc, 1, v10
    s_cbranch_vccnz Lfsp_93
    s_branch Lfok_92
Lslow_97:
    s_nop 7
    s_movk_i32 s0, 20000
Lspin_96:
    buffer_load_dword v2, v11, s[84:87], s11 offen sc1
    s_sub_u32 s0, s0, 1
    s_cbranch_scc1 Lok_95
    s_waitcnt vmcnt(0)
    v_cmp_ne_u32 vcc, s7, v2
    s_nop 0
    s_cmp_eq_u64 vcc, 0
    s_cbranch_scc0 Lspin_96
    s_branch Lok_95
Lslow_100:
    s_nop 7
    s_mov_b32 s0, 0x40000
Lfsp_99:
    ds_read_b32 v10, v9 offset:32
    s_sub_u32 s0, s0, 1
    s_cbranch_scc1 Lfok_98
    s_waitcnt lgkmcnt(0)
    v_cmp_gt_u32 vcc, 2, v10
    s_cbranch_vccnz Lfsp_99
    s_branch Lfok_98
Lslow_103:
    s_nop 7
    s_mov_b32 s0, 0x40000
Lfsp_102:
    ds_read_b32 v10, v9 offset:80
    s_sub_u32 s0, s0, 1
    s_cbranch_scc1 Lfok_101
    s_waitcnt lgkmcnt(0)
    v_cmp_gt_u32 vcc, 1, v10
    s_nop 0
    s_and_b64 vcc, vcc, s[50:51]
    s_cbranch_scc1 Lfsp_102
    s_branch Lfok_101
Lslow_106:
    s_nop 7
    s_mov_b32 s0, 0x40000
Lfsp_105:
    ds_read_b32 v10, v9 offset:64
    ds_read_b128 v[216:219], v23 offset:0
    ds_read_b128 v[220:223], v23 offset:1024
    ds_read_b128 v[224:227], v23 offset:2048
    ds_read_b128 v[228:231], v23 offset:3072
    s_sub_u32 s0, s0, 1
    s_cbranch_scc1 Lfok_104
    s_waitcnt lgkmcnt(0)
    v_cmp_gt_u32 vcc, 2, v10
    s_nop 0
    s_and_b64 vcc, vcc, s[50:51]
    s_cbranch_scc1 Lfsp_105
    s_branch Lfok_104
Lslow_108:
    buffer_store_dwordx4 v[248:251], v1, s[76:79], s12 offen sc1
    s_waitcnt vmcnt(0)
    s_branch Lfs_107
Lslow_110:
    buffer_store_dwordx4 v[252:255], v1, s[76:79], s12 offen offset:1024 sc1
    s_waitcnt vmcnt(0)
    s_branch Lfs_109
Lslow_112:
    buffer_store_dword v6, v7, s[76:79], s97 offen offset:256 sc1
    s_waitcnt vmcnt(0)
    s_branch Lfs_111
Lslow_115:
    s_nop 7
    s_mov_b32 s0, 0x40000
Lfsp_114:
    ds_read_b32 v10, v9 offset:32
    s_sub_u32 s0, s0, 1
    s_cbranch_scc1 Lfok_113
    s_waitcnt lgkmcnt(0)
    v_cmp_gt_u32 vcc, 3, v10
    s_cbranch_vccnz Lfsp_114
    s_branch Lfok_113
Lslow_120:
    s_nop 7
    s_mov_b32 s0, 0x40000
Lfsp_119:
    ds_read_b32 v10, v9 offset:32
    s_sub_u32 s0, s0, 1
    s_cbranch_scc1 Lfok_118
    s_waitcnt lgkmcnt(0)
    v_cmp_gt_u32 vcc, 4, v10
    s_cbranch_vccnz Lfsp_119
    s_branch Lfok_118
Lslow_123:
    s_nop 7
    s_mov_b32 s0, 0x40000
Lfsp_122:
    ds_read_b32 v10, v9 offset:80
    s_sub_u32 s0, s0, 1
    s_cbranch_scc1 Lfok_121
    s_waitcnt lgkmcnt(0)
    v_cmp_gt_u32 vcc, 2, v10
    s_nop 0
    s_and_b64 vcc, vcc, s[50:51]
    s_cbranch_scc1 Lfsp_122
    s_branch Lfok_121
Lslow_126:
    s_nop 7
    s_mov_b32 s0, 0x40000
Lfsp_125:
    ds_read_b32 v234, v9 offset:96
    s_sub_u32 s0, s0, 1
    s_cbranch_scc1 Lfok_124
    s_waitcnt lgkmcnt(0)
    v_cmp_gt_u32 vcc, 4, v234
    s_cbranch_vccnz Lfsp_125
    s_branch Lfok_124
Lslow_129:
    s_nop 7
    s_movk_i32 s0, 20000
Lspin_128:
    buffer_load_dword v203, v202, s[84:87], s100 offen offset:256 sc1
    s_sub_u32 s0, s0, 1
    s_cbranch_scc1 Lok_127
    s_waitcnt vmcnt(0)
    v_cmp_ne_u32 vcc, s7, v203
    s_nop 0
    s_cmp_eq_u64 vcc, 0
    s_cbranch_scc0 Lspin_128
    s_branch Lok_127
Lslow_132:
    s_nop 7
    s_mov_b32 s0, 0x40000
Lfsp_131:
    ds_read_b32 v10, v9 offset:64
    ds_read_b128 v[216:219], v23 offset:0
    ds_read_b128 v[220:223], v23 offset:1024
    ds_read_b128 v[224:227], v23 offset:2048
    ds_read_b128 v[228:231], v23 offset:3072
    s_sub_u32 s0, s0, 1
    s_cbranch_scc1 Lfok_130
    s_waitcnt lgkmcnt(0)
    v_cmp_gt_u32 vcc, 3, v10
    s_nop 0
    s_and_b64 vcc, vcc, s[50:51]
    s_cbranch_scc1 Lfsp_131
    s_branch Lfok_130
Lslow_134:
    buffer_store_dwordx4 v[248:251], v200, s[76:79], s12 offen sc1
    buffer_store_dwordx4 v[252:255], v200, s[76:79], s12 offen offset:1024 sc1
    s_waitcnt vmcnt(0)
    s_branch Lfs_133
Lslow_137:
    buffer_store_dword v6, v7, s[76:79], s97 offen offset:512 sc1
    s_waitcnt vmcnt(0)
    s_branch Lfs_136
Lslow_140:
    s_nop 7
    s_mov_b32 s0, 0x40000
Lfsp_139:
    ds_read_b32 v10, v9 offset:32
    s_sub_u32 s0, s0, 1
    s_cbranch_scc1 Lfok_138
    s_waitcnt lgkmcnt(0)
    v_cmp_gt_u32 vcc, 6, v10
    s_cbranch_vccnz Lfsp_139
    s_branch Lfok_138
Lslow_145:
    s_nop 7
    s_mov_b32 s0, 0x40000
Lfsp_144:
    ds_read_b32 v10, v9 offset:96
    s_sub_u32 s0, s0, 1
    s_cbranch_scc1 Lfok_143
    s_waitcnt lgkmcnt(0)
    v_cmp_gt_u32 vcc, 5, v10
    s_nop 0
    s_and_b64 vcc, vcc, s[56:57]
    s_cbranch_scc1 Lfsp_144
    s_branch Lfok_143
Lslow_148:
    s_nop 7
    s_mov_b32 s0, 0x40000
Lfsp_147:
    ds_read_b32 v10, v9 offset:80
    s_sub_u32 s0, s0, 1
    s_cbranch_scc1 Lfok_146
    s_waitcnt lgkmcnt(0)
    v_cmp_gt_u32 vcc, 3, v10
    s_nop 0
    s_and_b64 vcc, vcc, s[50:51]
    s_cbranch_scc1 Lfsp_147
    s_branch Lfok_146
Lslow_151:
    s_nop 7
    s_mov_b32 s0, 0x40000
Lfsp_150:
    ds_read_b32 v10, v9 offset:64
    ds_read_b128 v[216:219], v23 offset:0
    ds_read_b128 v[220:223], v23 offset:1024
    ds_read_b128 v[224:227], v23 offset:2048
    ds_read_b128 v[228:231], v23 offset:3072
    s_sub_u32 s0, s0, 1
    s_cbranch_scc1 Lfok_149
    s_waitcnt lgkmcnt(0)
    v_cmp_gt_u32 vcc, 4, v10
    s_nop 0
    s_and_b64 vcc, vcc, s[50:51]
    s_cbranch_scc1 Lfsp_150
    s_branch Lfok_149
Lslow_153:
    buffer_store_dwordx4 v[248:251], v1, s[76:79], s12 offen sc1
    s_waitcnt vmcnt(0)
    s_branch Lfs_152
Lslow_155:
    buffer_store_dwordx4 v[252:255], v1, s[76:79], s12 offen offset:1024 sc1
    s_waitcnt vmcnt(0)
    s_branch Lfs_154
Lslow_157:
    buffer_store_dword v6, v7, s[76:79], s97 offen offset:768 sc1
    s_waitcnt vmcnt(0)
    s_branch Lfs_156
Lslow_160:
    s_nop 7
    s_mov_b32 s0, 0x40000
Lfsp_159:
    ds_read_b32 v10, v9 offset:32
    s_sub_u32 s0, s0, 1
    s_cbranch_scc1 Lfok_158
    s_waitcnt lgkmcnt(0)
    v_cmp_gt_u32 vcc, 7, v10
    s_cbranch_vccnz Lfsp_159
    s_branch Lfok_158
Lslow_165:
    s_nop 7
    s_mov_b32 s0, 0x40000
Lfsp_164:
    ds_read_b32 v10, v9 offset:32
    s_sub_u32 s0, s0, 1
    s_cbranch_scc1 Lfok_163
    s_waitcnt lgkmcnt(0)
    v_cmp_gt_u32 vcc, 8, v10
    s_cbranch_vccnz Lfsp_164
    s_branch Lfok_163
Lslow_168:
    s_nop 7
    s_mov_b32 s0, 0x40000
Lfsp_167:
    ds_read_b32 v10, v9 offset:80
    s_sub_u32 s0, s0, 1
    s_cbranch_scc1 Lfok_166
    s_waitcnt lgkmcnt(0)
    v_cmp_gt_u32 vcc, 4, v10
    s_nop 0
    s_and_b64 vcc, vcc, s[50:51]
    s_cbranch_scc1 Lfsp_167
    s_branch Lfok_166
Lslow_171:
    s_nop 7
    s_mov_b32 s0, 0x40000
Lfsp_170:
    ds_read_b32 v10, v9 offset:32
    s_sub_u32 s0, s0, 1
    s_cbranch_scc1 Lfok_169
    s_waitcnt lgkmcnt(0)
    v_cmp_gt_u32 vcc, 9, v10
    s_cbranch_vccnz Lfsp_170
    s_branch Lfok_169
Lslow_174:
    s_nop 7
    s_mov_b32 s0, 0x40000
Lfsp_173:
    ds_read_b32 v17, v9 offset:96
    s_sub_u32 s0, s0, 1
    s_cbranch_scc1 Lfok_172
    s_waitcnt lgkmcnt(0)
    v_cmp_gt_u32 vcc, 6, v17
    s_cbranch_vccnz Lfsp_173
    s_branch Lfok_172
Lslow_177:
    s_nop 7
    s_mov_b32 s0, 0x40000
Lfsp_176:
    ds_read_b32 v17, v9 offset:64
    ds_read_b128 v[216:219], v23 offset:0
    ds_read_b128 v[220:223], v23 offset:1024
    ds_read_b128 v[224:227], v23 offset:2048
    ds_read_b128 v[228:231], v23 offset:3072
    s_sub_u32 s0, s0, 1
    s_cbranch_scc1 Lfok_175
    s_waitcnt lgkmcnt(0)
    v_cmp_gt_u32 vcc, 5, v17
    s_nop 0
    s_and_b64 vcc, vcc, s[50:51]
    s_cbranch_scc1 Lfsp_176
    s_branch Lfok_175
Lslow_180:
    s_nop 7
    s_mov_b32 s0, 0x40000
Lfsp_179:
    ds_read_b32 v10, v9 offset:32
    s_sub_u32 s0, s0, 1
    s_cbranch_scc1 Lfok_178
    s_waitcnt lgkmcnt(0)
    v_cmp_gt_u32 vcc, 10, v10
    s_cbranch_vccnz Lfsp_179
    s_branch Lfok_178
Lslow_183:
    s_nop 7
    s_mov_b32 s0, 0x40000
Lfsp_182:
    ds_read_b32 v10, v9 offset:80
    s_sub_u32 s0, s0, 1
    s_cbranch_scc1 Lfok_181
    s_waitcnt lgkmcnt(0)
    v_cmp_gt_u32 vcc, 5, v10
    s_nop 0
    s_and_b64 vcc, vcc, s[50:51]
    s_cbranch_scc1 Lfsp_182
    s_branch Lfok_181
Lslow_185:
    buffer_store_dwordx4 v[200:203], v1, s[76:79], s96 offen sc1
    buffer_store_dwordx4 v[204:207], v1, s[76:79], s96 offen offset:1024 sc1
    s_waitcnt vmcnt(0)
    s_branch Lfs_184
Lslow_188:
    s_nop 7
    s_mov_b32 s0, 0x40000
Lfsp_187:
    ds_read_b32 v10, v9 offset:32
    s_sub_u32 s0, s0, 1
    s_cbranch_scc1 Lfok_186
    s_waitcnt lgkmcnt(0)
    v_cmp_gt_u32 vcc, 11, v10
    s_cbranch_vccnz Lfsp_187
    s_branch Lfok_186
Lslow_191:
    s_nop 7
    s_mov_b32 s0, 0x40000
Lfsp_190:
    ds_read_b32 v17, v9 offset:64
    ds_read_b128 v[216:219], v23 offset:0
    ds_read_b128 v[220:223], v23 offset:1024
    ds_read_b128 v[224:227], v23 offset:2048
    ds_read_b128 v[228:231], v23 offset:3072
    s_sub_u32 s0, s0, 1
    s_cbranch_scc1 Lfok_189
    s_waitcnt lgkmcnt(0)
    v_cmp_gt_u32 vcc, 6, v17
    s_nop 0
    s_and_b64 vcc, vcc, s[50:51]
    s_cbranch_scc1 Lfsp_190
    s_branch Lfok_189
Lslow_193:
    buffer_store_dword v6, v7, s[76:79], s97 offen offset:1024 sc1
    s_waitcnt vmcnt(0)
    s_branch Lfs_192
Lslow_196:
    s_nop 7
    s_mov_b32 s0, 0x40000
Lfsp_195:
    ds_read_b32 v10, v9 offset:32
    s_sub_u32 s0, s0, 1
    s_cbranch_scc1 Lfok_194
    s_waitcnt lgkmcnt(0)
    v_cmp_gt_u32 vcc, 12, v10
    s_cbranch_vccnz Lfsp_195
    s_branch Lfok_194
Lslow_199:
    s_nop 7
    s_mov_b32 s0, 0x40000
Lfsp_198:
    ds_read_b32 v10, v9 offset:80
    s_sub_u32 s0, s0, 1
    s_cbranch_scc1 Lfok_197
    s_waitcnt lgkmcnt(0)
    v_cmp_gt_u32 vcc, 6, v10
    s_nop 0
    s_and_b64 vcc, vcc, s[50:51]
    s_cbranch_scc1 Lfsp_198
    s_branch Lfok_197
Lslow_202:
    s_nop 7
    s_movk_i32 s0, 20000
Lspin_201:
    buffer_load_dword v2, v3, s[84:87], s98 offen offset:1024 sc1
    s_sub_u32 s0, s0, 1
    s_cbranch_scc1 Lok_200
    s_waitcnt vmcnt(0)
    v_cmp_ne_u32 vcc, s7, v2
    s_nop 0
    s_cmp_eq_u64 vcc, 0
    s_cbranch_scc0 Lspin_201
    s_branch Lok_200
Lslow_204:
    buffer_store_dwordx4 v[200:203], v1, s[76:79], s88 offen sc1
    buffer_store_dwordx4 v[204:207], v1, s[76:79], s88 offen offset:1024 sc1
    s_waitcnt vmcnt(0)
    s_branch Lfs_203
Lslow_207:
    s_nop 7
    s_mov_b32 s0, 0x40000
Lfsp_206:
    ds_read_b32 v10, v9 offset:32
    s_sub_u32 s0, s0, 1
    s_cbranch_scc1 Lfok_205
    s_waitcnt lgkmcnt(0)
    v_cmp_gt_u32 vcc, 13, v10
    s_cbranch_vccnz Lfsp_206
    s_branch Lfok_205
Lslow_209:
    buffer_store_dword v6, v7, s[76:79], s97 offen offset:1280 sc1
    s_waitcnt vmcnt(0)
    s_branch Lfs_208
Lslow_212:
    s_nop 7
    s_mov_b32 s0, 0x40000
Lfsp_211:
    ds_read_b32 v17, v9 offset:64
    ds_read_b128 v[216:219], v23 offset:0
    ds_read_b128 v[220:223], v23 offset:1024
    ds_read_b128 v[224:227], v23 offset:2048
    ds_read_b128 v[228:231], v23 offset:3072
    s_sub_u32 s0, s0, 1
    s_cbranch_scc1 Lfok_210
    s_waitcnt lgkmcnt(0)
    v_cmp_gt_u32 vcc, 7, v17
    s_nop 0
    s_and_b64 vcc, vcc, s[50:51]
    s_cbranch_scc1 Lfsp_211
    s_branch Lfok_210
Lslow_215:
    s_nop 7
    s_mov_b32 s0, 0x40000
Lfsp_214:
    ds_read_b32 v10, v9 offset:32
    s_sub_u32 s0, s0, 1
    s_cbranch_scc1 Lfok_213
    s_waitcnt lgkmcnt(0)
    v_cmp_gt_u32 vcc, 14, v10
    s_cbranch_vccnz Lfsp_214
    s_branch Lfok_213
Lslow_218:
    s_nop 7
    s_mov_b32 s0, 0x40000
Lfsp_217:
    ds_read_b32 v10, v9 offset:80
    s_sub_u32 s0, s0, 1
    s_cbranch_scc1 Lfok_216
    s_waitcnt lgkmcnt(0)
    v_cmp_gt_u32 vcc, 7, v10
    s_nop 0
    s_and_b64 vcc, vcc, s[50:51]
    s_cbranch_scc1 Lfsp_217
    s_branch Lfok_216
Lslow_220:
    buffer_store_dwordx4 v[200:203], v1, s[76:79], s89 offen sc1
    buffer_store_dwordx4 v[204:207], v1, s[76:79], s89 offen offset:1024 sc1
    s_waitcnt vmcnt(0)
    s_branch Lfs_219
Lslow_223:
    s_nop 7
    s_mov_b32 s0, 0x40000
Lfsp_222:
    ds_read_b32 v10, v9 offset:32
    s_sub_u32 s0, s0, 1
    s_cbranch_scc1 Lfok_221
    s_waitcnt lgkmcnt(0)
    v_cmp_gt_u32 vcc, 15, v10
    s_cbranch_vccnz Lfsp_222
    s_branch Lfok_221
Lslow_226:
    s_nop 7
    s_mov_b32 s0, 0x40000
Lfsp_225:
    ds_read_b32 v17, v9 offset:64
    ds_read_b128 v[216:219], v23 offset:0
    ds_read_b128 v[220:223], v23 offset:1024
    s_sub_u32 s0, s0, 1
    s_cbranch_scc1 Lfok_224
    s_waitcnt lgkmcnt(0)
    v_cmp_gt_u32 vcc, 8, v17
    s_nop 0
    s_and_b64 vcc, vcc, s[50:51]
    s_cbranch_scc1 Lfsp_225
    s_branch Lfok_224
Lslow_229:
    s_nop 7
    s_movk_i32 s0, 20000
Lspin_228:
    buffer_load_dword v3, v11, s[84:87], s98 offen offset:1280 sc1
    s_sub_u32 s0, s0, 1
    s_cbranch_scc1 Lok_227
    s_waitcnt vmcnt(0)
    v_cmp_ne_u32 vcc, s7, v3
    s_nop 0
    s_cmp_eq_u64 vcc, 0
    s_cbranch_scc0 Lspin_228
    s_branch Lok_227
Lslow_231:
    buffer_store_dword v6, v7, s[76:79], s97 offen offset:1536 sc1
    s_waitcnt vmcnt(0)
    s_branch Lfs_230
Lslow_233:
    buffer_store_dwordx4 v[200:203], v1, s[76:79], s90 offen sc1
    s_waitcnt vmcnt(0)
    s_branch Lfs_232
Lslow_236:
    s_nop 7
    s_mov_b32 s0, 0x40000
Lfsp_235:
    ds_read_b32 v10, v9 offset:32
    s_sub_u32 s0, s0, 1
    s_cbranch_scc1 Lfok_234
    s_waitcnt lgkmcnt(0)
    v_cmp_gt_u32 vcc, 16, v10
    s_cbranch_vccnz Lfsp_235
    s_branch Lfok_234
Lslow_238:
    buffer_store_dword v6, v7, s[76:79], s97 offen offset:1792 sc1
    s_waitcnt vmcnt(0)
    s_branch Lfs_237
Lslow_241:
    s_nop 7
    s_mov_b32 s0, 0x40000
Lfsp_240:
    ds_read_b32 v10, v9 offset:32
    s_sub_u32 s0, s0, 1
    s_cbranch_scc1 Lfok_239
    s_waitcnt lgkmcnt(0)
    v_cmp_gt_u32 vcc, 17, v10
    s_cbranch_vccnz Lfsp_240
    s_branch Lfok_239
Lslow_244:
    s_nop 7
    s_movk_i32 s0, 20000
Lspin_243:
    buffer_load_dword v2, v11, s[84:87], s98 offen offset:1536 sc1
    s_sub_u32 s0, s0, 1
    s_cbranch_scc1 Lok_242
    s_waitcnt vmcnt(0)
    v_cmp_ne_u32 vcc, s7, v2
    s_nop 0
    s_cmp_eq_u64 vcc, 0
    s_cbranch_scc0 Lspin_243
    s_branch Lok_242
Lslow_247:
    s_nop 7
    s_mov_b32 s0, 0x40000
Lfsp_246:
    ds_read_b32 v10, v9 offset:32
    s_sub_u32 s0, s0, 1
    s_cbranch_scc1 Lfok_245
    s_waitcnt lgkmcnt(0)
    v_cmp_gt_u32 vcc, 18, v10
    s_cbranch_vccnz Lfsp_246
    s_branch Lfok_245
Lslow_250:
    s_nop 7
    s_mov_b32 s0, 0x40000
Lfsp_249:
    ds_read_b32 v10, v9 offset:32
    s_sub_u32 s0, s0, 1
    s_cbranch_scc1 Lfok_248
    s_waitcnt lgkmcnt(0)
    v_cmp_gt_u32 vcc, 19, v10
    s_cbranch_vccnz Lfsp_249
    s_branch Lfok_248
Lslow_253:
    s_nop 7
    s_movk_i32 s0, 20000
Lspin_252:
    buffer_load_dword v3, v11, s[84:87], s98 offen offset:1792 sc1
    s_sub_u32 s0, s0, 1
    s_cbranch_scc1 Lok_251
    s_waitcnt vmcnt(0)
    v_cmp_ne_u32 vcc, s7, v3
    s_nop 0
    s_cmp_eq_u64 vcc, 0
    s_cbranch_scc0 Lspin_252
    s_branch Lok_251
Lslow_256:
    s_nop 7
    s_mov_b32 s0, 0x40000
Lfsp_255:
    ds_read_b32 v10, v9 offset:32
    s_sub_u32 s0, s0, 1
    s_cbranch_scc1 Lfok_254
    s_waitcnt lgkmcnt(0)
    v_cmp_gt_u32 vcc, 20, v10
    s_cbranch_vccnz Lfsp_255
    s_branch Lfok_254
Lslow_259:
    s_nop 7
    s_mov_b32 s0, 0x40000
Lfsp_258:
    ds_read_b32 v10, v9 offset:80
    s_sub_u32 s0, s0, 1
    s_cbranch_scc1 Lfok_257
    s_waitcnt lgkmcnt(0)
    v_cmp_gt_u32 vcc, 8, v10
    s_nop 0
    s_and_b64 vcc, vcc, s[50:51]
    s_cbranch_scc1 Lfsp_258
    s_branch Lfok_257
Lslow_262:
    s_nop 7
    s_mov_b32 s0, 0x40000
Lfsp_261:
    ds_read_b32 v10, v9 offset:64
    ds_read_b128 v[152:155], v23 offset:0
    ds_read_b128 v[156:159], v23 offset:1024
    ds_read_b128 v[160:163], v23 offset:2048
    ds_read_b128 v[164:167], v23 offset:3072
    s_sub_u32 s0, s0, 1
    s_cbranch_scc1 Lfok_260
    s_waitcnt lgkmcnt(0)
    v_cmp_gt_u32 vcc, 9, v10
    s_nop 0
    s_and_b64 vcc, vcc, s[50:51]
    s_cbranch_scc1 Lfsp_261
    s_branch Lfok_260
L_exit:
    s_endpgm
L_code_end:

.section .rodata,"a"
.p2align 6
.amdhsa_kernel adaLN_cond__sliding_local_dilated__mixer_s_mlp__prompt_kernel
  .amdhsa_next_free_vgpr 256
  .amdhsa_next_free_sgpr 102
  .amdhsa_accum_offset 256
  .amdhsa_group_segment_fixed_size 0
  .amdhsa_kernarg_size 104
  .amdhsa_user_sgpr_count 2
  .amdhsa_user_sgpr_kernarg_segment_ptr 1
  .amdhsa_system_sgpr_workgroup_id_x 1
.end_amdhsa_kernel
```
